```python
import torch

def _softmax(x, axis=-1):
    return torch.softmax(x, dim=axis)
def _gelu(x):
    return torch.nn.functional.gelu(x, approximate="tanh")
def _silu(x):
    return torch.nn.functional.silu(x)
def _sigmoid(x):
    return torch.sigmoid(x)
def _layernorm(x, axis=-1, eps=1e-5):
    m = x.mean(dim=axis, keepdim=True)
    v = x.var(dim=axis, keepdim=True, unbiased=False)
    return (x - m) / torch.sqrt(v + eps)
def _scatter_add(tgt, idx, src, axis=0):
    return tgt.clone().index_add_(axis, idx, src)
def _segment_sum(src, seg, n):
    out = torch.zeros((n,) + src.shape[1:], dtype=src.dtype)
    return out.index_add_(0, seg, src)
def _pad(x, pw):
    flat = tuple(v for pair in reversed(pw) for v in pair)
    return torch.nn.functional.pad(x, flat)

kernel_name = 'standalone__gqa_softmax__prompt'

def setup_inputs():

    _w = (lambda a: (lambda t: t.to(torch.bfloat16) if t.is_floating_point() else t)(torch.as_tensor(a)))
    B, Hq, Hkv, Sq, Sk, D = 1, 32, 32, 2048, 2048, 128
    return {
        "q": _w((lambda *s: torch.randn(*s, dtype=torch.bfloat16) * 0.8)(B, Hq, Sq, D)),
        "k": _w((lambda *s: torch.randn(*s, dtype=torch.bfloat16) * 0.8)(B, Hkv, Sk, D)),
        "v": _w((lambda *s: torch.randn(*s, dtype=torch.bfloat16) * 0.05)(B, Hkv, Sk, D)),
    }

def reference(q, k, v):
    B, Hq, Sq, D = q.shape
    Hkv = k.shape[1]
    rep = Hq // Hkv
    k = (lambda x, n, axis: torch.repeat_interleave(x, n, dim=axis))(k, rep, axis=1)
    v = (lambda x, n, axis: torch.repeat_interleave(x, n, dim=axis))(v, rep, axis=1)
    scale = D ** -0.5
    scores = torch.einsum("bhqd,bhkd->bhqk", q, k) * scale
    p = _softmax(scores, axis=-1)
    return torch.einsum("bhqk,bhkd->bhqd", p, v)
```

```asm
; @launch grid=(256,1,1) block=(256,1,1) lds=163840
.amdgcn_target "amdgcn-amd-amdhsa--gfx950"
.text
.globl standalone__gqa_softmax__prompt_kernel
.p2align 8
.type standalone__gqa_softmax__prompt_kernel,@function
standalone__gqa_softmax__prompt_kernel:
    s_cmp_ge_u32 s2, 256
    s_cbranch_scc1 L_end
    s_load_dwordx8 s[20:27], s[0:1], 0
    v_and_b32 v246, 63, v0
    v_lshrrev_b32 v254, 6, v0
    v_and_b32 v247, 31, v0
    v_readfirstlane_b32 s28, v254
    v_lshrrev_b32 v248, 5, v246
    v_and_b32 v249, 15, v247
    v_lshlrev_b32 v250, 8, v247
    v_add_u32 v254, 0, v248
    v_xor_b32 v254, v254, v249
    v_lshl_add_u32 v224, v254, 4, v250
    v_add_u32 v254, 2, v248
    v_xor_b32 v254, v254, v249
    v_lshl_add_u32 v225, v254, 4, v250
    v_add_u32 v254, 4, v248
    v_xor_b32 v254, v254, v249
    v_lshl_add_u32 v226, v254, 4, v250
    v_add_u32 v254, 6, v248
    v_xor_b32 v254, v254, v249
    v_lshl_add_u32 v227, v254, 4, v250
    v_add_u32 v254, 8, v248
    v_xor_b32 v254, v254, v249
    v_lshl_add_u32 v228, v254, 4, v250
    v_add_u32 v254, 10, v248
    v_xor_b32 v254, v254, v249
    v_lshl_add_u32 v229, v254, 4, v250
    v_add_u32 v254, 12, v248
    v_xor_b32 v254, v254, v249
    v_lshl_add_u32 v230, v254, 4, v250
    v_add_u32 v254, 14, v248
    v_xor_b32 v254, v254, v249
    v_lshl_add_u32 v231, v254, 4, v250
    v_lshl_add_u32 v245, v248, 4, v250
    v_and_b32 v254, 15, v246
    v_lshrrev_b32 v251, 2, v254
    v_lshlrev_b32 v254, 2, v248
    v_add_u32 v254, v254, v251
    v_lshlrev_b32 v254, 8, v254
    v_lshrrev_b32 v255, 4, v246
    v_and_b32 v255, 1, v255
    v_lshl_add_u32 v254, v255, 5, v254
    v_and_b32 v255, 3, v246
    v_lshl_add_u32 v254, v255, 3, v254
    v_add_u32 v254, 49152, v254
    v_xor_b32 v255, 0, v251
    v_lshl_add_u32 v232, v255, 6, v254
    v_xor_b32 v255, 1, v251
    v_lshl_add_u32 v233, v255, 6, v254
    v_xor_b32 v255, 2, v251
    v_lshl_add_u32 v234, v255, 6, v254
    v_xor_b32 v255, 3, v251
    v_lshl_add_u32 v235, v255, 6, v254
    v_lshrrev_b32 v252, 4, v246
    v_and_b32 v253, 15, v246
    v_lshlrev_b32 v254, 8, v252
    v_lshrrev_b32 v255, 6, v0
    v_lshl_add_u32 v254, v255, 12, v254
    v_add_u32 v255, 0, v252
    v_xor_b32 v255, v255, v253
    v_lshl_add_u32 v236, v255, 4, v254
    v_add_u32 v255, 4, v252
    v_xor_b32 v255, v255, v253
    v_lshl_add_u32 v237, v255, 4, v254
    v_add_u32 v255, 8, v252
    v_xor_b32 v255, v255, v253
    v_lshl_add_u32 v238, v255, 4, v254
    v_add_u32 v255, 12, v252
    v_xor_b32 v255, v255, v253
    v_lshl_add_u32 v239, v255, 4, v254
    v_lshlrev_b32 v255, 2, v252
    v_xor_b32 v255, v255, v253
    v_lshl_add_u32 v240, v255, 4, v254
    s_and_b32 s29, s2, 7
    s_lshl_b32 s29, s29, 2
    s_lshr_b32 s30, s2, 6
    s_add_u32 s29, s29, s30
    s_lshr_b32 s30, s2, 3
    s_and_b32 s30, s30, 7
    s_lshl_b32 s32, s29, 19
    s_lshl_b32 s31, s30, 16
    s_add_u32 s31, s31, s32
    s_lshl_b32 s45, s28, 14
    s_add_u32 s31, s31, s45
    s_add_u32 s48, s31, 8192
    s_lshl_b32 s45, s28, 12
    s_add_u32 s36, s45, 0
    s_add_u32 s39, s45, 49152
    s_add_u32 s37, s45, 16384
    s_add_u32 s40, s45, 65536
    s_add_u32 s38, s45, 32768
    s_add_u32 s41, s45, 81920
    s_mov_b32 s43, 0x44800000
    s_mov_b32 s44, 0x3e0293ee
    s_waitcnt lgkmcnt(0)
    s_mov_b32 s4, s20
    s_mov_b32 s5, s21
    s_mov_b32 s6, 0x1000000
    s_mov_b32 s7, 0x00020000
    s_mov_b32 s8, s22
    s_mov_b32 s9, s23
    s_mov_b32 s10, 0x1000000
    s_mov_b32 s11, 0x00020000
    s_mov_b32 s12, s24
    s_mov_b32 s13, s25
    s_mov_b32 s14, 0x1000000
    s_mov_b32 s15, 0x00020000
    s_mov_b32 s16, s26
    s_mov_b32 s17, s27
    s_mov_b32 s18, 0x1000000
    s_mov_b32 s19, 0x00020000
    s_mov_b32 s33, s32
    s_mov_b32 s34, s32
    s_mov_b32 m0, s36
    s_nop 0
    buffer_load_dwordx4 v236, s[8:11], s33 offen lds
    buffer_load_dwordx4 v237, s[8:11], s33 offen offset:1024 lds
    buffer_load_dwordx4 v238, s[8:11], s33 offen offset:2048 lds
    buffer_load_dwordx4 v239, s[8:11], s33 offen offset:3072 lds
    s_add_u32 s33, s33, 16384
    v_lshrrev_b32 v255, 6, v0
    v_lshlrev_b32 v255, 12, v255
    v_sub_u32 v72, v236, v255
    v_sub_u32 v73, v237, v255
    v_sub_u32 v74, v238, v255
    v_sub_u32 v75, v239, v255
    s_lshl_b32 s45, s28, 14
    s_add_u32 s45, s45, 98304
    s_add_u32 s46, s45, 0
    s_mov_b32 m0, s46
    s_add_u32 s47, s31, 0
    buffer_load_dwordx4 v72, s[4:7], s47 offen lds
    buffer_load_dwordx4 v73, s[4:7], s47 offen offset:1024 lds
    buffer_load_dwordx4 v74, s[4:7], s47 offen offset:2048 lds
    buffer_load_dwordx4 v75, s[4:7], s47 offen offset:3072 lds
    s_add_u32 s46, s45, 4096
    s_mov_b32 m0, s46
    s_add_u32 s47, s31, 4096
    buffer_load_dwordx4 v72, s[4:7], s47 offen lds
    buffer_load_dwordx4 v73, s[4:7], s47 offen offset:1024 lds
    buffer_load_dwordx4 v74, s[4:7], s47 offen offset:2048 lds
    buffer_load_dwordx4 v75, s[4:7], s47 offen offset:3072 lds
    s_add_u32 s46, s45, 8192
    s_mov_b32 m0, s46
    s_add_u32 s47, s31, 8192
    buffer_load_dwordx4 v72, s[4:7], s47 offen lds
    buffer_load_dwordx4 v73, s[4:7], s47 offen offset:1024 lds
    buffer_load_dwordx4 v74, s[4:7], s47 offen offset:2048 lds
    buffer_load_dwordx4 v75, s[4:7], s47 offen offset:3072 lds
    s_add_u32 s46, s45, 12288
    s_mov_b32 m0, s46
    s_add_u32 s47, s31, 12288
    buffer_load_dwordx4 v72, s[4:7], s47 offen lds
    buffer_load_dwordx4 v73, s[4:7], s47 offen offset:1024 lds
    buffer_load_dwordx4 v74, s[4:7], s47 offen offset:2048 lds
    buffer_load_dwordx4 v75, s[4:7], s47 offen offset:3072 lds
    v_add_u32 v64, s45, v224
    v_add_u32 v65, s45, v225
    v_add_u32 v66, s45, v226
    v_add_u32 v67, s45, v227
    v_add_u32 v68, s45, v228
    v_add_u32 v69, s45, v229
    v_add_u32 v70, s45, v230
    v_add_u32 v71, s45, v231
    v_accvgpr_write_b32 a0, 0
    v_accvgpr_write_b32 a1, 0
    v_accvgpr_write_b32 a2, 0
    v_accvgpr_write_b32 a3, 0
    v_accvgpr_write_b32 a4, 0
    v_accvgpr_write_b32 a5, 0
    v_accvgpr_write_b32 a6, 0
    v_accvgpr_write_b32 a7, 0
    v_accvgpr_write_b32 a8, 0
    v_accvgpr_write_b32 a9, 0
    v_accvgpr_write_b32 a10, 0
    v_accvgpr_write_b32 a11, 0
    v_accvgpr_write_b32 a12, 0
    v_accvgpr_write_b32 a13, 0
    v_accvgpr_write_b32 a14, 0
    v_accvgpr_write_b32 a15, 0
    v_accvgpr_write_b32 a16, 0
    v_accvgpr_write_b32 a17, 0
    v_accvgpr_write_b32 a18, 0
    v_accvgpr_write_b32 a19, 0
    v_accvgpr_write_b32 a20, 0
    v_accvgpr_write_b32 a21, 0
    v_accvgpr_write_b32 a22, 0
    v_accvgpr_write_b32 a23, 0
    v_accvgpr_write_b32 a24, 0
    v_accvgpr_write_b32 a25, 0
    v_accvgpr_write_b32 a26, 0
    v_accvgpr_write_b32 a27, 0
    v_accvgpr_write_b32 a28, 0
    v_accvgpr_write_b32 a29, 0
    v_accvgpr_write_b32 a30, 0
    v_accvgpr_write_b32 a31, 0
    v_accvgpr_write_b32 a32, 0
    v_accvgpr_write_b32 a33, 0
    v_accvgpr_write_b32 a34, 0
    v_accvgpr_write_b32 a35, 0
    v_accvgpr_write_b32 a36, 0
    v_accvgpr_write_b32 a37, 0
    v_accvgpr_write_b32 a38, 0
    v_accvgpr_write_b32 a39, 0
    v_accvgpr_write_b32 a40, 0
    v_accvgpr_write_b32 a41, 0
    v_accvgpr_write_b32 a42, 0
    v_accvgpr_write_b32 a43, 0
    v_accvgpr_write_b32 a44, 0
    v_accvgpr_write_b32 a45, 0
    v_accvgpr_write_b32 a46, 0
    v_accvgpr_write_b32 a47, 0
    v_accvgpr_write_b32 a48, 0
    v_accvgpr_write_b32 a49, 0
    v_accvgpr_write_b32 a50, 0
    v_accvgpr_write_b32 a51, 0
    v_accvgpr_write_b32 a52, 0
    v_accvgpr_write_b32 a53, 0
    v_accvgpr_write_b32 a54, 0
    v_accvgpr_write_b32 a55, 0
    v_accvgpr_write_b32 a56, 0
    v_accvgpr_write_b32 a57, 0
    v_accvgpr_write_b32 a58, 0
    v_accvgpr_write_b32 a59, 0
    v_accvgpr_write_b32 a60, 0
    v_accvgpr_write_b32 a61, 0
    v_accvgpr_write_b32 a62, 0
    v_accvgpr_write_b32 a63, 0
    v_accvgpr_write_b32 a64, 0
    v_accvgpr_write_b32 a65, 0
    v_accvgpr_write_b32 a66, 0
    v_accvgpr_write_b32 a67, 0
    v_accvgpr_write_b32 a68, 0
    v_accvgpr_write_b32 a69, 0
    v_accvgpr_write_b32 a70, 0
    v_accvgpr_write_b32 a71, 0
    v_accvgpr_write_b32 a72, 0
    v_accvgpr_write_b32 a73, 0
    v_accvgpr_write_b32 a74, 0
    v_accvgpr_write_b32 a75, 0
    v_accvgpr_write_b32 a76, 0
    v_accvgpr_write_b32 a77, 0
    v_accvgpr_write_b32 a78, 0
    v_accvgpr_write_b32 a79, 0
    v_accvgpr_write_b32 a80, 0
    v_accvgpr_write_b32 a81, 0
    v_accvgpr_write_b32 a82, 0
    v_accvgpr_write_b32 a83, 0
    v_accvgpr_write_b32 a84, 0
    v_accvgpr_write_b32 a85, 0
    v_accvgpr_write_b32 a86, 0
    v_accvgpr_write_b32 a87, 0
    v_accvgpr_write_b32 a88, 0
    v_accvgpr_write_b32 a89, 0
    v_accvgpr_write_b32 a90, 0
    v_accvgpr_write_b32 a91, 0
    v_accvgpr_write_b32 a92, 0
    v_accvgpr_write_b32 a93, 0
    v_accvgpr_write_b32 a94, 0
    v_accvgpr_write_b32 a95, 0
    v_accvgpr_write_b32 a96, 0
    v_accvgpr_write_b32 a97, 0
    v_accvgpr_write_b32 a98, 0
    v_accvgpr_write_b32 a99, 0
    v_accvgpr_write_b32 a100, 0
    v_accvgpr_write_b32 a101, 0
    v_accvgpr_write_b32 a102, 0
    v_accvgpr_write_b32 a103, 0
    v_accvgpr_write_b32 a104, 0
    v_accvgpr_write_b32 a105, 0
    v_accvgpr_write_b32 a106, 0
    v_accvgpr_write_b32 a107, 0
    v_accvgpr_write_b32 a108, 0
    v_accvgpr_write_b32 a109, 0
    v_accvgpr_write_b32 a110, 0
    v_accvgpr_write_b32 a111, 0
    v_accvgpr_write_b32 a112, 0
    v_accvgpr_write_b32 a113, 0
    v_accvgpr_write_b32 a114, 0
    v_accvgpr_write_b32 a115, 0
    v_accvgpr_write_b32 a116, 0
    v_accvgpr_write_b32 a117, 0
    v_accvgpr_write_b32 a118, 0
    v_accvgpr_write_b32 a119, 0
    v_accvgpr_write_b32 a120, 0
    v_accvgpr_write_b32 a121, 0
    v_accvgpr_write_b32 a122, 0
    v_accvgpr_write_b32 a123, 0
    v_accvgpr_write_b32 a124, 0
    v_accvgpr_write_b32 a125, 0
    v_accvgpr_write_b32 a126, 0
    v_accvgpr_write_b32 a127, 0
    v_mov_b32 v241, 0
    v_mov_b32 v242, 0
    s_mov_b32 s35, s32
    s_mov_b32 m0, s37
    s_nop 0
    buffer_load_dwordx4 v236, s[8:11], s33 offen lds
    buffer_load_dwordx4 v237, s[8:11], s33 offen offset:1024 lds
    buffer_load_dwordx4 v238, s[8:11], s33 offen offset:2048 lds
    buffer_load_dwordx4 v239, s[8:11], s33 offen offset:3072 lds
    s_add_u32 s33, s33, 16384
    s_waitcnt vmcnt(4)
    ds_read_b128 v[0:3], v64 offset:0
    ds_read_b128 v[4:7], v65 offset:0
    ds_read_b128 v[8:11], v66 offset:0
    ds_read_b128 v[12:15], v67 offset:0
    ds_read_b128 v[16:19], v68 offset:0
    ds_read_b128 v[20:23], v69 offset:0
    ds_read_b128 v[24:27], v70 offset:0
    ds_read_b128 v[28:31], v71 offset:0
    ds_read_b128 v[32:35], v64 offset:8192
    ds_read_b128 v[36:39], v65 offset:8192
    ds_read_b128 v[40:43], v66 offset:8192
    ds_read_b128 v[44:47], v67 offset:8192
    ds_read_b128 v[48:51], v68 offset:8192
    ds_read_b128 v[52:55], v69 offset:8192
    ds_read_b128 v[56:59], v70 offset:8192
    ds_read_b128 v[60:63], v71 offset:8192
    s_waitcnt lgkmcnt(15)
    v_lshlrev_b32 v246, 16, v0
    v_and_b32 v247, 0xffff0000, v0
    v_mul_f32 v246, s44, v246
    v_mul_f32 v247, s44, v247
    v_cvt_pk_bf16_f32 v248, v246, v247
    v_accvgpr_write_b32 a128, v248
    v_lshlrev_b32 v249, 16, v1
    v_and_b32 v250, 0xffff0000, v1
    v_mul_f32 v249, s44, v249
    v_mul_f32 v250, s44, v250
    v_cvt_pk_bf16_f32 v251, v249, v250
    v_accvgpr_write_b32 a129, v251
    v_lshlrev_b32 v252, 16, v2
    v_and_b32 v253, 0xffff0000, v2
    v_mul_f32 v252, s44, v252
    v_mul_f32 v253, s44, v253
    v_cvt_pk_bf16_f32 v254, v252, v253
    v_accvgpr_write_b32 a130, v254
    v_lshlrev_b32 v246, 16, v3
    v_and_b32 v247, 0xffff0000, v3
    v_mul_f32 v246, s44, v246
    v_mul_f32 v247, s44, v247
    v_cvt_pk_bf16_f32 v248, v246, v247
    v_accvgpr_write_b32 a131, v248
    s_waitcnt lgkmcnt(14)
    v_lshlrev_b32 v249, 16, v4
    v_and_b32 v250, 0xffff0000, v4
    v_mul_f32 v249, s44, v249
    v_mul_f32 v250, s44, v250
    v_cvt_pk_bf16_f32 v251, v249, v250
    v_accvgpr_write_b32 a132, v251
    v_lshlrev_b32 v252, 16, v5
    v_and_b32 v253, 0xffff0000, v5
    v_mul_f32 v252, s44, v252
    v_mul_f32 v253, s44, v253
    v_cvt_pk_bf16_f32 v254, v252, v253
    v_accvgpr_write_b32 a133, v254
    v_lshlrev_b32 v246, 16, v6
    v_and_b32 v247, 0xffff0000, v6
    v_mul_f32 v246, s44, v246
    v_mul_f32 v247, s44, v247
    v_cvt_pk_bf16_f32 v248, v246, v247
    v_accvgpr_write_b32 a134, v248
    v_lshlrev_b32 v249, 16, v7
    v_and_b32 v250, 0xffff0000, v7
    v_mul_f32 v249, s44, v249
    v_mul_f32 v250, s44, v250
    v_cvt_pk_bf16_f32 v251, v249, v250
    v_accvgpr_write_b32 a135, v251
    s_waitcnt lgkmcnt(13)
    v_lshlrev_b32 v252, 16, v8
    v_and_b32 v253, 0xffff0000, v8
    v_mul_f32 v252, s44, v252
    v_mul_f32 v253, s44, v253
    v_cvt_pk_bf16_f32 v254, v252, v253
    v_accvgpr_write_b32 a136, v254
    v_lshlrev_b32 v246, 16, v9
    v_and_b32 v247, 0xffff0000, v9
    v_mul_f32 v246, s44, v246
    v_mul_f32 v247, s44, v247
    v_cvt_pk_bf16_f32 v248, v246, v247
    v_accvgpr_write_b32 a137, v248
    v_lshlrev_b32 v249, 16, v10
    v_and_b32 v250, 0xffff0000, v10
    v_mul_f32 v249, s44, v249
    v_mul_f32 v250, s44, v250
    v_cvt_pk_bf16_f32 v251, v249, v250
    v_accvgpr_write_b32 a138, v251
    v_lshlrev_b32 v252, 16, v11
    v_and_b32 v253, 0xffff0000, v11
    v_mul_f32 v252, s44, v252
    v_mul_f32 v253, s44, v253
    v_cvt_pk_bf16_f32 v254, v252, v253
    v_accvgpr_write_b32 a139, v254
    s_waitcnt lgkmcnt(12)
    v_lshlrev_b32 v246, 16, v12
    v_and_b32 v247, 0xffff0000, v12
    v_mul_f32 v246, s44, v246
    v_mul_f32 v247, s44, v247
    v_cvt_pk_bf16_f32 v248, v246, v247
    v_accvgpr_write_b32 a140, v248
    v_lshlrev_b32 v249, 16, v13
    v_and_b32 v250, 0xffff0000, v13
    v_mul_f32 v249, s44, v249
    v_mul_f32 v250, s44, v250
    v_cvt_pk_bf16_f32 v251, v249, v250
    v_accvgpr_write_b32 a141, v251
    v_lshlrev_b32 v252, 16, v14
    v_and_b32 v253, 0xffff0000, v14
    v_mul_f32 v252, s44, v252
    v_mul_f32 v253, s44, v253
    v_cvt_pk_bf16_f32 v254, v252, v253
    v_accvgpr_write_b32 a142, v254
    v_lshlrev_b32 v246, 16, v15
    v_and_b32 v247, 0xffff0000, v15
    v_mul_f32 v246, s44, v246
    v_mul_f32 v247, s44, v247
    v_cvt_pk_bf16_f32 v248, v246, v247
    v_accvgpr_write_b32 a143, v248
    s_waitcnt lgkmcnt(11)
    v_lshlrev_b32 v249, 16, v16
    v_and_b32 v250, 0xffff0000, v16
    v_mul_f32 v249, s44, v249
    v_mul_f32 v250, s44, v250
    v_cvt_pk_bf16_f32 v251, v249, v250
    v_accvgpr_write_b32 a144, v251
    v_lshlrev_b32 v252, 16, v17
    v_and_b32 v253, 0xffff0000, v17
    v_mul_f32 v252, s44, v252
    v_mul_f32 v253, s44, v253
    v_cvt_pk_bf16_f32 v254, v252, v253
    v_accvgpr_write_b32 a145, v254
    v_lshlrev_b32 v246, 16, v18
    v_and_b32 v247, 0xffff0000, v18
    v_mul_f32 v246, s44, v246
    v_mul_f32 v247, s44, v247
    v_cvt_pk_bf16_f32 v248, v246, v247
    v_accvgpr_write_b32 a146, v248
    v_lshlrev_b32 v249, 16, v19
    v_and_b32 v250, 0xffff0000, v19
    v_mul_f32 v249, s44, v249
    v_mul_f32 v250, s44, v250
    v_cvt_pk_bf16_f32 v251, v249, v250
    v_accvgpr_write_b32 a147, v251
    s_waitcnt lgkmcnt(10)
    v_lshlrev_b32 v252, 16, v20
    v_and_b32 v253, 0xffff0000, v20
    v_mul_f32 v252, s44, v252
    v_mul_f32 v253, s44, v253
    v_cvt_pk_bf16_f32 v254, v252, v253
    v_accvgpr_write_b32 a148, v254
    v_lshlrev_b32 v246, 16, v21
    v_and_b32 v247, 0xffff0000, v21
    v_mul_f32 v246, s44, v246
    v_mul_f32 v247, s44, v247
    v_cvt_pk_bf16_f32 v248, v246, v247
    v_accvgpr_write_b32 a149, v248
    v_lshlrev_b32 v249, 16, v22
    v_and_b32 v250, 0xffff0000, v22
    v_mul_f32 v249, s44, v249
    v_mul_f32 v250, s44, v250
    v_cvt_pk_bf16_f32 v251, v249, v250
    v_accvgpr_write_b32 a150, v251
    v_lshlrev_b32 v252, 16, v23
    v_and_b32 v253, 0xffff0000, v23
    v_mul_f32 v252, s44, v252
    v_mul_f32 v253, s44, v253
    v_cvt_pk_bf16_f32 v254, v252, v253
    v_accvgpr_write_b32 a151, v254
    s_waitcnt lgkmcnt(9)
    v_lshlrev_b32 v246, 16, v24
    v_and_b32 v247, 0xffff0000, v24
    v_mul_f32 v246, s44, v246
    v_mul_f32 v247, s44, v247
    v_cvt_pk_bf16_f32 v248, v246, v247
    v_accvgpr_write_b32 a152, v248
    v_lshlrev_b32 v249, 16, v25
    v_and_b32 v250, 0xffff0000, v25
    v_mul_f32 v249, s44, v249
    v_mul_f32 v250, s44, v250
    v_cvt_pk_bf16_f32 v251, v249, v250
    v_accvgpr_write_b32 a153, v251
    v_lshlrev_b32 v252, 16, v26
    v_and_b32 v253, 0xffff0000, v26
    v_mul_f32 v252, s44, v252
    v_mul_f32 v253, s44, v253
    v_cvt_pk_bf16_f32 v254, v252, v253
    v_accvgpr_write_b32 a154, v254
    v_lshlrev_b32 v246, 16, v27
    v_and_b32 v247, 0xffff0000, v27
    v_mul_f32 v246, s44, v246
    v_mul_f32 v247, s44, v247
    v_cvt_pk_bf16_f32 v248, v246, v247
    v_accvgpr_write_b32 a155, v248
    s_waitcnt lgkmcnt(8)
    v_lshlrev_b32 v249, 16, v28
    v_and_b32 v250, 0xffff0000, v28
    v_mul_f32 v249, s44, v249
    v_mul_f32 v250, s44, v250
    v_cvt_pk_bf16_f32 v251, v249, v250
    v_accvgpr_write_b32 a156, v251
    v_lshlrev_b32 v252, 16, v29
    v_and_b32 v253, 0xffff0000, v29
    v_mul_f32 v252, s44, v252
    v_mul_f32 v253, s44, v253
    v_cvt_pk_bf16_f32 v254, v252, v253
    v_accvgpr_write_b32 a157, v254
    v_lshlrev_b32 v246, 16, v30
    v_and_b32 v247, 0xffff0000, v30
    v_mul_f32 v246, s44, v246
    v_mul_f32 v247, s44, v247
    v_cvt_pk_bf16_f32 v248, v246, v247
    v_accvgpr_write_b32 a158, v248
    v_lshlrev_b32 v249, 16, v31
    v_and_b32 v250, 0xffff0000, v31
    v_mul_f32 v249, s44, v249
    v_mul_f32 v250, s44, v250
    v_cvt_pk_bf16_f32 v251, v249, v250
    v_accvgpr_write_b32 a159, v251
    s_waitcnt lgkmcnt(7)
    s_mov_b32 m0, s39
    s_nop 0
    buffer_load_dwordx4 v240, s[12:15], s34 offen lds
    buffer_load_dwordx4 v240, s[12:15], s34 offen offset:1024 lds
    buffer_load_dwordx4 v240, s[12:15], s34 offen offset:2048 lds
    buffer_load_dwordx4 v240, s[12:15], s34 offen offset:3072 lds
    s_add_u32 s34, s34, 16384
    v_lshlrev_b32 v252, 16, v32
    v_and_b32 v253, 0xffff0000, v32
    v_mul_f32 v252, s44, v252
    v_mul_f32 v253, s44, v253
    v_cvt_pk_bf16_f32 v254, v252, v253
    v_accvgpr_write_b32 a160, v254
    v_lshlrev_b32 v246, 16, v33
    v_and_b32 v247, 0xffff0000, v33
    v_mul_f32 v246, s44, v246
    v_mul_f32 v247, s44, v247
    v_cvt_pk_bf16_f32 v248, v246, v247
    v_accvgpr_write_b32 a161, v248
    v_lshlrev_b32 v249, 16, v34
    v_and_b32 v250, 0xffff0000, v34
    v_mul_f32 v249, s44, v249
    v_mul_f32 v250, s44, v250
    v_cvt_pk_bf16_f32 v251, v249, v250
    v_accvgpr_write_b32 a162, v251
    v_lshlrev_b32 v252, 16, v35
    v_and_b32 v253, 0xffff0000, v35
    v_mul_f32 v252, s44, v252
    v_mul_f32 v253, s44, v253
    v_cvt_pk_bf16_f32 v254, v252, v253
    v_accvgpr_write_b32 a163, v254
    s_waitcnt lgkmcnt(6)
    v_lshlrev_b32 v246, 16, v36
    v_and_b32 v247, 0xffff0000, v36
    v_mul_f32 v246, s44, v246
    v_mul_f32 v247, s44, v247
    v_cvt_pk_bf16_f32 v248, v246, v247
    v_accvgpr_write_b32 a164, v248
    v_lshlrev_b32 v249, 16, v37
    v_and_b32 v250, 0xffff0000, v37
    v_mul_f32 v249, s44, v249
    v_mul_f32 v250, s44, v250
    v_cvt_pk_bf16_f32 v251, v249, v250
    v_accvgpr_write_b32 a165, v251
    v_lshlrev_b32 v252, 16, v38
    v_and_b32 v253, 0xffff0000, v38
    v_mul_f32 v252, s44, v252
    v_mul_f32 v253, s44, v253
    v_cvt_pk_bf16_f32 v254, v252, v253
    v_accvgpr_write_b32 a166, v254
    v_lshlrev_b32 v246, 16, v39
    v_and_b32 v247, 0xffff0000, v39
    v_mul_f32 v246, s44, v246
    v_mul_f32 v247, s44, v247
    v_cvt_pk_bf16_f32 v248, v246, v247
    v_accvgpr_write_b32 a167, v248
    s_waitcnt lgkmcnt(5)
    v_lshlrev_b32 v249, 16, v40
    v_and_b32 v250, 0xffff0000, v40
    v_mul_f32 v249, s44, v249
    v_mul_f32 v250, s44, v250
    v_cvt_pk_bf16_f32 v251, v249, v250
    v_accvgpr_write_b32 a168, v251
    v_lshlrev_b32 v252, 16, v41
    v_and_b32 v253, 0xffff0000, v41
    v_mul_f32 v252, s44, v252
    v_mul_f32 v253, s44, v253
    v_cvt_pk_bf16_f32 v254, v252, v253
    v_accvgpr_write_b32 a169, v254
    v_lshlrev_b32 v246, 16, v42
    v_and_b32 v247, 0xffff0000, v42
    v_mul_f32 v246, s44, v246
    v_mul_f32 v247, s44, v247
    v_cvt_pk_bf16_f32 v248, v246, v247
    v_accvgpr_write_b32 a170, v248
    v_lshlrev_b32 v249, 16, v43
    v_and_b32 v250, 0xffff0000, v43
    v_mul_f32 v249, s44, v249
    v_mul_f32 v250, s44, v250
    v_cvt_pk_bf16_f32 v251, v249, v250
    v_accvgpr_write_b32 a171, v251
    s_waitcnt lgkmcnt(4)
    v_lshlrev_b32 v252, 16, v44
    v_and_b32 v253, 0xffff0000, v44
    v_mul_f32 v252, s44, v252
    v_mul_f32 v253, s44, v253
    v_cvt_pk_bf16_f32 v254, v252, v253
    v_accvgpr_write_b32 a172, v254
    v_lshlrev_b32 v246, 16, v45
    v_and_b32 v247, 0xffff0000, v45
    v_mul_f32 v246, s44, v246
    v_mul_f32 v247, s44, v247
    v_cvt_pk_bf16_f32 v248, v246, v247
    v_accvgpr_write_b32 a173, v248
    v_lshlrev_b32 v249, 16, v46
    v_and_b32 v250, 0xffff0000, v46
    v_mul_f32 v249, s44, v249
    v_mul_f32 v250, s44, v250
    v_cvt_pk_bf16_f32 v251, v249, v250
    v_accvgpr_write_b32 a174, v251
    v_lshlrev_b32 v252, 16, v47
    v_and_b32 v253, 0xffff0000, v47
    v_mul_f32 v252, s44, v252
    v_mul_f32 v253, s44, v253
    v_cvt_pk_bf16_f32 v254, v252, v253
    v_accvgpr_write_b32 a175, v254
    s_waitcnt lgkmcnt(3)
    v_lshlrev_b32 v246, 16, v48
    v_and_b32 v247, 0xffff0000, v48
    v_mul_f32 v246, s44, v246
    v_mul_f32 v247, s44, v247
    v_cvt_pk_bf16_f32 v248, v246, v247
    v_accvgpr_write_b32 a176, v248
    v_lshlrev_b32 v249, 16, v49
    v_and_b32 v250, 0xffff0000, v49
    v_mul_f32 v249, s44, v249
    v_mul_f32 v250, s44, v250
    v_cvt_pk_bf16_f32 v251, v249, v250
    v_accvgpr_write_b32 a177, v251
    v_lshlrev_b32 v252, 16, v50
    v_and_b32 v253, 0xffff0000, v50
    v_mul_f32 v252, s44, v252
    v_mul_f32 v253, s44, v253
    v_cvt_pk_bf16_f32 v254, v252, v253
    v_accvgpr_write_b32 a178, v254
    v_lshlrev_b32 v246, 16, v51
    v_and_b32 v247, 0xffff0000, v51
    v_mul_f32 v246, s44, v246
    v_mul_f32 v247, s44, v247
    v_cvt_pk_bf16_f32 v248, v246, v247
    v_accvgpr_write_b32 a179, v248
    s_waitcnt lgkmcnt(2)
    v_lshlrev_b32 v249, 16, v52
    v_and_b32 v250, 0xffff0000, v52
    v_mul_f32 v249, s44, v249
    v_mul_f32 v250, s44, v250
    v_cvt_pk_bf16_f32 v251, v249, v250
    v_accvgpr_write_b32 a180, v251
    v_lshlrev_b32 v252, 16, v53
    v_and_b32 v253, 0xffff0000, v53
    v_mul_f32 v252, s44, v252
    v_mul_f32 v253, s44, v253
    v_cvt_pk_bf16_f32 v254, v252, v253
    v_accvgpr_write_b32 a181, v254
    v_lshlrev_b32 v246, 16, v54
    v_and_b32 v247, 0xffff0000, v54
    v_mul_f32 v246, s44, v246
    v_mul_f32 v247, s44, v247
    v_cvt_pk_bf16_f32 v248, v246, v247
    v_accvgpr_write_b32 a182, v248
    v_lshlrev_b32 v249, 16, v55
    v_and_b32 v250, 0xffff0000, v55
    v_mul_f32 v249, s44, v249
    v_mul_f32 v250, s44, v250
    v_cvt_pk_bf16_f32 v251, v249, v250
    v_accvgpr_write_b32 a183, v251
    s_waitcnt lgkmcnt(1)
    v_lshlrev_b32 v252, 16, v56
    v_and_b32 v253, 0xffff0000, v56
    v_mul_f32 v252, s44, v252
    v_mul_f32 v253, s44, v253
    v_cvt_pk_bf16_f32 v254, v252, v253
    v_accvgpr_write_b32 a184, v254
    v_lshlrev_b32 v246, 16, v57
    v_and_b32 v247, 0xffff0000, v57
    v_mul_f32 v246, s44, v246
    v_mul_f32 v247, s44, v247
    v_cvt_pk_bf16_f32 v248, v246, v247
    v_accvgpr_write_b32 a185, v248
    v_lshlrev_b32 v249, 16, v58
    v_and_b32 v250, 0xffff0000, v58
    v_mul_f32 v249, s44, v249
    v_mul_f32 v250, s44, v250
    v_cvt_pk_bf16_f32 v251, v249, v250
    v_accvgpr_write_b32 a186, v251
    v_lshlrev_b32 v252, 16, v59
    v_and_b32 v253, 0xffff0000, v59
    v_mul_f32 v252, s44, v252
    v_mul_f32 v253, s44, v253
    v_cvt_pk_bf16_f32 v254, v252, v253
    v_accvgpr_write_b32 a187, v254
    s_waitcnt lgkmcnt(0)
    v_lshlrev_b32 v246, 16, v60
    v_and_b32 v247, 0xffff0000, v60
    v_mul_f32 v246, s44, v246
    v_mul_f32 v247, s44, v247
    v_cvt_pk_bf16_f32 v248, v246, v247
    v_accvgpr_write_b32 a188, v248
    v_lshlrev_b32 v249, 16, v61
    v_and_b32 v250, 0xffff0000, v61
    v_mul_f32 v249, s44, v249
    v_mul_f32 v250, s44, v250
    v_cvt_pk_bf16_f32 v251, v249, v250
    v_accvgpr_write_b32 a189, v251
    v_lshlrev_b32 v252, 16, v62
    v_and_b32 v253, 0xffff0000, v62
    v_mul_f32 v252, s44, v252
    v_mul_f32 v253, s44, v253
    v_cvt_pk_bf16_f32 v254, v252, v253
    v_accvgpr_write_b32 a190, v254
    v_lshlrev_b32 v246, 16, v63
    v_and_b32 v247, 0xffff0000, v63
    v_mul_f32 v246, s44, v246
    v_mul_f32 v247, s44, v247
    v_cvt_pk_bf16_f32 v248, v246, v247
    v_accvgpr_write_b32 a191, v248
    s_barrier
    ds_read_b128 a[192:195], v224 offset:0
    ds_read_b128 a[196:199], v225 offset:0
    ds_read_b128 a[200:203], v226 offset:0
    ds_read_b128 a[204:207], v227 offset:0
    s_mov_b32 m0, s38
    s_nop 0
    buffer_load_dwordx4 v236, s[8:11], s33 offen lds
    buffer_load_dwordx4 v237, s[8:11], s33 offen offset:1024 lds
    buffer_load_dwordx4 v238, s[8:11], s33 offen offset:2048 lds
    buffer_load_dwordx4 v239, s[8:11], s33 offen offset:3072 lds
    s_add_u32 s33, s33, 16384
    s_mov_b32 m0, s40
    s_nop 0
    buffer_load_dwordx4 v240, s[12:15], s34 offen lds
    buffer_load_dwordx4 v240, s[12:15], s34 offen offset:1024 lds
    buffer_load_dwordx4 v240, s[12:15], s34 offen offset:2048 lds
    buffer_load_dwordx4 v240, s[12:15], s34 offen offset:3072 lds
    s_add_u32 s34, s34, 16384
    s_waitcnt lgkmcnt(2)
    v_mfma_f32_32x32x16_bf16 v[0:15], a[192:195], a[128:131], 0
    v_mfma_f32_32x32x16_bf16 v[16:31], a[192:195], a[160:163], 0
    ds_read_b128 a[208:211], v228 offset:0
    v_mfma_f32_32x32x16_bf16 v[0:15], a[196:199], a[132:135], v[0:15]
    v_mfma_f32_32x32x16_bf16 v[16:31], a[196:199], a[164:167], v[16:31]
    ds_read_b128 a[212:215], v229 offset:0
    s_waitcnt lgkmcnt(2)
    v_mfma_f32_32x32x16_bf16 v[0:15], a[200:203], a[136:139], v[0:15]
    v_mfma_f32_32x32x16_bf16 v[16:31], a[200:203], a[168:171], v[16:31]
    ds_read_b128 a[216:219], v230 offset:0
    v_mfma_f32_32x32x16_bf16 v[0:15], a[204:207], a[140:143], v[0:15]
    v_mfma_f32_32x32x16_bf16 v[16:31], a[204:207], a[172:175], v[16:31]
    ds_read_b128 a[220:223], v231 offset:0
    s_waitcnt lgkmcnt(2)
    v_mfma_f32_32x32x16_bf16 v[0:15], a[208:211], a[144:147], v[0:15]
    v_mfma_f32_32x32x16_bf16 v[16:31], a[208:211], a[176:179], v[16:31]
    ds_read_b128 a[192:195], v224 offset:8192
    v_mfma_f32_32x32x16_bf16 v[0:15], a[212:215], a[148:151], v[0:15]
    v_mfma_f32_32x32x16_bf16 v[16:31], a[212:215], a[180:183], v[16:31]
    ds_read_b128 a[196:199], v225 offset:8192
    s_waitcnt lgkmcnt(2)
    v_mfma_f32_32x32x16_bf16 v[0:15], a[216:219], a[152:155], v[0:15]
    v_mfma_f32_32x32x16_bf16 v[16:31], a[216:219], a[184:187], v[16:31]
    ds_read_b128 a[200:203], v226 offset:8192
    v_mfma_f32_32x32x16_bf16 v[0:15], a[220:223], a[156:159], v[0:15]
    v_mfma_f32_32x32x16_bf16 v[16:31], a[220:223], a[188:191], v[16:31]
    ds_read_b128 a[204:207], v227 offset:8192
    s_waitcnt lgkmcnt(2)
    v_mfma_f32_32x32x16_bf16 v[32:47], a[192:195], a[128:131], 0
    v_mfma_f32_32x32x16_bf16 v[48:63], a[192:195], a[160:163], 0
    ds_read_b128 a[208:211], v228 offset:8192
    v_mfma_f32_32x32x16_bf16 v[32:47], a[196:199], a[132:135], v[32:47]
    v_mfma_f32_32x32x16_bf16 v[48:63], a[196:199], a[164:167], v[48:63]
    ds_read_b128 a[212:215], v229 offset:8192
    s_waitcnt lgkmcnt(2)
    v_mfma_f32_32x32x16_bf16 v[32:47], a[200:203], a[136:139], v[32:47]
    v_mfma_f32_32x32x16_bf16 v[48:63], a[200:203], a[168:171], v[48:63]
    ds_read_b128 a[216:219], v230 offset:8192
    v_mfma_f32_32x32x16_bf16 v[32:47], a[204:207], a[140:143], v[32:47]
    v_mfma_f32_32x32x16_bf16 v[48:63], a[204:207], a[172:175], v[48:63]
    ds_read_b128 a[220:223], v231 offset:8192
    s_waitcnt lgkmcnt(2)
    v_mfma_f32_32x32x16_bf16 v[32:47], a[208:211], a[144:147], v[32:47]
    v_mfma_f32_32x32x16_bf16 v[48:63], a[208:211], a[176:179], v[48:63]
    v_mfma_f32_32x32x16_bf16 v[32:47], a[212:215], a[148:151], v[32:47]
    v_mfma_f32_32x32x16_bf16 v[48:63], a[212:215], a[180:183], v[48:63]
    s_waitcnt lgkmcnt(0)
    v_mfma_f32_32x32x16_bf16 v[32:47], a[216:219], a[152:155], v[32:47]
    v_mfma_f32_32x32x16_bf16 v[48:63], a[216:219], a[184:187], v[48:63]
    v_mfma_f32_32x32x16_bf16 v[32:47], a[220:223], a[156:159], v[32:47]
    v_mfma_f32_32x32x16_bf16 v[48:63], a[220:223], a[188:191], v[48:63]
    s_waitcnt vmcnt(12)
    s_barrier
    s_mov_b32 m0, s36
    s_nop 0
    buffer_load_dwordx4 v236, s[8:11], s33 offen lds
    buffer_load_dwordx4 v237, s[8:11], s33 offen offset:1024 lds
    buffer_load_dwordx4 v238, s[8:11], s33 offen offset:2048 lds
    buffer_load_dwordx4 v239, s[8:11], s33 offen offset:3072 lds
    s_add_u32 s33, s33, 16384
    ds_read_b128 a[192:195], v224 offset:16384
    ds_read_b128 a[196:199], v225 offset:16384
    ds_read_b128 a[200:203], v226 offset:16384
    ds_read_b128 a[204:207], v227 offset:16384
    s_nop 7
    v_max3_f32 v246, v0, v1, v2
    v_max3_f32 v246, v246, v3, v4
    v_max3_f32 v246, v246, v5, v6
    v_max3_f32 v246, v246, v7, v8
    v_max3_f32 v246, v246, v9, v10
    v_max3_f32 v246, v246, v11, v12
    v_max3_f32 v246, v246, v13, v14
    v_max3_f32 v246, v246, v15, v32
    v_max3_f32 v246, v246, v33, v34
    v_max3_f32 v246, v246, v35, v36
    v_max3_f32 v246, v246, v37, v38
    v_max3_f32 v246, v246, v39, v40
    v_max3_f32 v246, v246, v41, v42
    v_max3_f32 v246, v246, v43, v44
    v_max3_f32 v246, v246, v45, v46
    v_max_f32 v246, v246, v47
    v_mov_b32 v248, v246
    v_mov_b32 v249, v246
    s_nop 1
    v_permlane32_swap_b32 v248, v249
    s_nop 1
    v_max_f32 v246, v248, v249
    v_max3_f32 v247, v16, v17, v18
    v_max3_f32 v247, v247, v19, v20
    v_max3_f32 v247, v247, v21, v22
    v_max3_f32 v247, v247, v23, v24
    v_max3_f32 v247, v247, v25, v26
    v_max3_f32 v247, v247, v27, v28
    v_max3_f32 v247, v247, v29, v30
    v_max3_f32 v247, v247, v31, v48
    v_max3_f32 v247, v247, v49, v50
    v_max3_f32 v247, v247, v51, v52
    v_max3_f32 v247, v247, v53, v54
    v_max3_f32 v247, v247, v55, v56
    v_max3_f32 v247, v247, v57, v58
    v_max3_f32 v247, v247, v59, v60
    v_max3_f32 v247, v247, v61, v62
    v_max_f32 v247, v247, v63
    v_mov_b32 v248, v247
    v_mov_b32 v249, v247
    s_nop 1
    v_permlane32_swap_b32 v248, v249
    s_nop 1
    v_max_f32 v247, v248, v249
    v_sub_f32 v192, 0, v246
    v_sub_f32 v193, 0, v246
    v_sub_f32 v194, 0, v246
    v_sub_f32 v195, 0, v246
    v_sub_f32 v196, 0, v246
    v_sub_f32 v197, 0, v246
    v_sub_f32 v198, 0, v246
    v_sub_f32 v199, 0, v246
    v_sub_f32 v200, 0, v246
    v_sub_f32 v201, 0, v246
    v_sub_f32 v202, 0, v246
    v_sub_f32 v203, 0, v246
    v_sub_f32 v204, 0, v246
    v_sub_f32 v205, 0, v246
    v_sub_f32 v206, 0, v246
    v_sub_f32 v207, 0, v246
    v_sub_f32 v208, 0, v247
    v_sub_f32 v209, 0, v247
    v_sub_f32 v210, 0, v247
    v_sub_f32 v211, 0, v247
    v_sub_f32 v212, 0, v247
    v_sub_f32 v213, 0, v247
    v_sub_f32 v214, 0, v247
    v_sub_f32 v215, 0, v247
    v_sub_f32 v216, 0, v247
    v_sub_f32 v217, 0, v247
    v_sub_f32 v218, 0, v247
    v_sub_f32 v219, 0, v247
    v_sub_f32 v220, 0, v247
    v_sub_f32 v221, 0, v247
    v_sub_f32 v222, 0, v247
    v_sub_f32 v223, 0, v247
    v_sub_f32 v0, v0, v246
    v_sub_f32 v1, v1, v246
    v_sub_f32 v2, v2, v246
    v_sub_f32 v3, v3, v246
    v_sub_f32 v4, v4, v246
    v_sub_f32 v5, v5, v246
    v_sub_f32 v6, v6, v246
    v_sub_f32 v7, v7, v246
    v_sub_f32 v8, v8, v246
    v_sub_f32 v9, v9, v246
    v_sub_f32 v10, v10, v246
    v_sub_f32 v11, v11, v246
    v_sub_f32 v12, v12, v246
    v_sub_f32 v13, v13, v246
    v_sub_f32 v14, v14, v246
    v_sub_f32 v15, v15, v246
    v_sub_f32 v16, v16, v247
    v_sub_f32 v17, v17, v247
    v_sub_f32 v18, v18, v247
    v_sub_f32 v19, v19, v247
    v_sub_f32 v20, v20, v247
    v_sub_f32 v21, v21, v247
    v_sub_f32 v22, v22, v247
    v_sub_f32 v23, v23, v247
    v_sub_f32 v24, v24, v247
    v_sub_f32 v25, v25, v247
    v_sub_f32 v26, v26, v247
    v_sub_f32 v27, v27, v247
    v_sub_f32 v28, v28, v247
    v_sub_f32 v29, v29, v247
    v_sub_f32 v30, v30, v247
    v_sub_f32 v31, v31, v247
    v_sub_f32 v32, v32, v246
    v_sub_f32 v33, v33, v246
    v_sub_f32 v34, v34, v246
    v_sub_f32 v35, v35, v246
    v_sub_f32 v36, v36, v246
    v_sub_f32 v37, v37, v246
    v_sub_f32 v38, v38, v246
    v_sub_f32 v39, v39, v246
    v_sub_f32 v40, v40, v246
    v_sub_f32 v41, v41, v246
    v_sub_f32 v42, v42, v246
    v_sub_f32 v43, v43, v246
    v_sub_f32 v44, v44, v246
    v_sub_f32 v45, v45, v246
    v_sub_f32 v46, v46, v246
    v_sub_f32 v47, v47, v246
    v_sub_f32 v48, v48, v247
    v_sub_f32 v49, v49, v247
    v_sub_f32 v50, v50, v247
    v_sub_f32 v51, v51, v247
    v_sub_f32 v52, v52, v247
    v_sub_f32 v53, v53, v247
    v_sub_f32 v54, v54, v247
    v_sub_f32 v55, v55, v247
    v_sub_f32 v56, v56, v247
    v_sub_f32 v57, v57, v247
    v_sub_f32 v58, v58, v247
    v_sub_f32 v59, v59, v247
    v_sub_f32 v60, v60, v247
    v_sub_f32 v61, v61, v247
    v_sub_f32 v62, v62, v247
    v_sub_f32 v63, v63, v247
    s_waitcnt lgkmcnt(2)
    v_mfma_f32_32x32x16_bf16 v[64:79], a[192:195], a[128:131], v[192:207]
    v_exp_f32 v0, v0
    v_exp_f32 v16, v16
    v_exp_f32 v1, v1
    v_mfma_f32_32x32x16_bf16 v[80:95], a[192:195], a[160:163], v[208:223]
    ds_read_b128 a[208:211], v228 offset:16384
    v_exp_f32 v17, v17
    v_add_f32 v243, v0, v1
    v_cvt_pk_bf16_f32 v128, v0, v1
    v_mfma_f32_32x32x16_bf16 v[64:79], a[196:199], a[132:135], v[64:79]
    v_exp_f32 v2, v2
    v_add_f32 v244, v16, v17
    v_cvt_pk_bf16_f32 v132, v16, v17
    v_exp_f32 v18, v18
    v_mfma_f32_32x32x16_bf16 v[80:95], a[196:199], a[164:167], v[80:95]
    ds_read_b128 a[212:215], v229 offset:16384
    v_add_f32 v243, v243, v2
    v_exp_f32 v3, v3
    v_add_f32 v244, v244, v18
    s_waitcnt lgkmcnt(2)
    v_mfma_f32_32x32x16_bf16 v[64:79], a[200:203], a[136:139], v[64:79]
    v_exp_f32 v19, v19
    v_add_f32 v243, v243, v3
    v_cvt_pk_bf16_f32 v129, v2, v3
    v_exp_f32 v4, v4
    v_mfma_f32_32x32x16_bf16 v[80:95], a[200:203], a[168:171], v[80:95]
    ds_read_b128 a[216:219], v230 offset:16384
    v_add_f32 v244, v244, v19
    v_cvt_pk_bf16_f32 v133, v18, v19
    v_exp_f32 v20, v20
    v_add_f32 v243, v243, v4
    v_mfma_f32_32x32x16_bf16 v[64:79], a[204:207], a[140:143], v[64:79]
    v_exp_f32 v5, v5
    v_add_f32 v244, v244, v20
    v_exp_f32 v21, v21
    v_add_f32 v243, v243, v5
    v_mfma_f32_32x32x16_bf16 v[80:95], a[204:207], a[172:175], v[80:95]
    ds_read_b128 a[220:223], v231 offset:16384
    v_cvt_pk_bf16_f32 v130, v4, v5
    v_exp_f32 v6, v6
    v_add_f32 v244, v244, v21
    s_waitcnt lgkmcnt(2)
    v_mfma_f32_32x32x16_bf16 v[64:79], a[208:211], a[144:147], v[64:79]
    v_cvt_pk_bf16_f32 v134, v20, v21
    v_exp_f32 v22, v22
    v_add_f32 v243, v243, v6
    v_exp_f32 v7, v7
    v_mfma_f32_32x32x16_bf16 v[80:95], a[208:211], a[176:179], v[80:95]
    ds_read_b128 a[192:195], v224 offset:24576
    v_add_f32 v244, v244, v22
    v_exp_f32 v23, v23
    v_add_f32 v243, v243, v7
    v_cvt_pk_bf16_f32 v131, v6, v7
    v_mfma_f32_32x32x16_bf16 v[64:79], a[212:215], a[148:151], v[64:79]
    v_exp_f32 v8, v8
    v_add_f32 v244, v244, v23
    v_cvt_pk_bf16_f32 v135, v22, v23
    v_exp_f32 v24, v24
    v_mfma_f32_32x32x16_bf16 v[80:95], a[212:215], a[180:183], v[80:95]
    ds_read_b128 a[196:199], v225 offset:24576
    v_add_f32 v243, v243, v8
    v_exp_f32 v9, v9
    v_add_f32 v244, v244, v24
    s_waitcnt lgkmcnt(2)
    v_mfma_f32_32x32x16_bf16 v[64:79], a[216:219], a[152:155], v[64:79]
    v_exp_f32 v25, v25
    v_add_f32 v243, v243, v9
    v_cvt_pk_bf16_f32 v136, v8, v9
    v_exp_f32 v10, v10
    v_mfma_f32_32x32x16_bf16 v[80:95], a[216:219], a[184:187], v[80:95]
    ds_read_b128 a[200:203], v226 offset:24576
    v_add_f32 v244, v244, v25
    v_cvt_pk_bf16_f32 v140, v24, v25
    v_exp_f32 v26, v26
    v_add_f32 v243, v243, v10
    v_mfma_f32_32x32x16_bf16 v[64:79], a[220:223], a[156:159], v[64:79]
    v_exp_f32 v11, v11
    v_add_f32 v244, v244, v26
    v_exp_f32 v27, v27
    v_add_f32 v243, v243, v11
    v_mfma_f32_32x32x16_bf16 v[80:95], a[220:223], a[188:191], v[80:95]
    ds_read_b128 a[204:207], v227 offset:24576
    v_cvt_pk_bf16_f32 v137, v10, v11
    v_exp_f32 v12, v12
    v_add_f32 v244, v244, v27
    s_waitcnt lgkmcnt(2)
    v_mfma_f32_32x32x16_bf16 v[96:111], a[192:195], a[128:131], v[192:207]
    v_cvt_pk_bf16_f32 v141, v26, v27
    v_exp_f32 v28, v28
    v_add_f32 v243, v243, v12
    v_exp_f32 v13, v13
    v_mfma_f32_32x32x16_bf16 v[112:127], a[192:195], a[160:163], v[208:223]
    ds_read_b128 a[208:211], v228 offset:24576
    v_add_f32 v244, v244, v28
    v_exp_f32 v29, v29
    v_add_f32 v243, v243, v13
    v_cvt_pk_bf16_f32 v138, v12, v13
    v_mfma_f32_32x32x16_bf16 v[96:111], a[196:199], a[132:135], v[96:111]
    v_exp_f32 v14, v14
    v_add_f32 v244, v244, v29
    v_cvt_pk_bf16_f32 v142, v28, v29
    v_exp_f32 v30, v30
    v_mfma_f32_32x32x16_bf16 v[112:127], a[196:199], a[164:167], v[112:127]
    ds_read_b128 a[212:215], v229 offset:24576
    v_add_f32 v243, v243, v14
    v_exp_f32 v15, v15
    v_add_f32 v244, v244, v30
    s_waitcnt lgkmcnt(2)
    v_mfma_f32_32x32x16_bf16 v[96:111], a[200:203], a[136:139], v[96:111]
    v_exp_f32 v31, v31
    v_add_f32 v243, v243, v15
    v_cvt_pk_bf16_f32 v139, v14, v15
    v_exp_f32 v32, v32
    v_mfma_f32_32x32x16_bf16 v[112:127], a[200:203], a[168:171], v[112:127]
    ds_read_b128 a[216:219], v230 offset:24576
    v_add_f32 v244, v244, v31
    v_cvt_pk_bf16_f32 v143, v30, v31
    v_exp_f32 v48, v48
    v_add_f32 v243, v243, v32
    v_mfma_f32_32x32x16_bf16 v[96:111], a[204:207], a[140:143], v[96:111]
    v_exp_f32 v33, v33
    v_add_f32 v244, v244, v48
    v_exp_f32 v49, v49
    v_add_f32 v243, v243, v33
    v_mfma_f32_32x32x16_bf16 v[112:127], a[204:207], a[172:175], v[112:127]
    ds_read_b128 a[220:223], v231 offset:24576
    v_cvt_pk_bf16_f32 v144, v32, v33
    v_exp_f32 v34, v34
    v_add_f32 v244, v244, v49
    s_waitcnt lgkmcnt(2)
    v_mfma_f32_32x32x16_bf16 v[96:111], a[208:211], a[144:147], v[96:111]
    s_waitcnt vmcnt(4) lgkmcnt(0)
    s_barrier
    v_cvt_pk_bf16_f32 v148, v48, v49
    v_exp_f32 v50, v50
    v_add_f32 v243, v243, v34
    v_mfma_f32_32x32x16_bf16 v[112:127], a[208:211], a[176:179], v[112:127]
    ds_read_b128 a[192:195], v224 offset:32768
    v_exp_f32 v35, v35
    v_add_f32 v244, v244, v50
    v_exp_f32 v51, v51
    v_mfma_f32_32x32x16_bf16 v[96:111], a[212:215], a[148:151], v[96:111]
    ds_read_b128 a[196:199], v225 offset:32768
    v_add_f32 v243, v243, v35
    v_cvt_pk_bf16_f32 v145, v34, v35
    v_exp_f32 v36, v36
    v_add_f32 v244, v244, v51
    v_mfma_f32_32x32x16_bf16 v[112:127], a[212:215], a[180:183], v[112:127]
    ds_read_b128 a[200:203], v226 offset:32768
    v_cvt_pk_bf16_f32 v149, v50, v51
    v_exp_f32 v52, v52
    v_add_f32 v243, v243, v36
    v_mfma_f32_32x32x16_bf16 v[96:111], a[216:219], a[152:155], v[96:111]
    ds_read_b128 a[204:207], v227 offset:32768
    v_exp_f32 v37, v37
    v_add_f32 v244, v244, v52
    v_exp_f32 v53, v53
    v_mfma_f32_32x32x16_bf16 v[112:127], a[216:219], a[184:187], v[112:127]
    v_add_f32 v243, v243, v37
    v_cvt_pk_bf16_f32 v146, v36, v37
    v_exp_f32 v38, v38
    v_add_f32 v244, v244, v53
    v_cvt_pk_bf16_f32 v150, v52, v53
    v_mfma_f32_32x32x16_bf16 v[96:111], a[220:223], a[156:159], v[96:111]
    v_exp_f32 v54, v54
    v_add_f32 v243, v243, v38
    v_exp_f32 v39, v39
    v_add_f32 v244, v244, v54
    v_mfma_f32_32x32x16_bf16 v[112:127], a[220:223], a[188:191], v[112:127]
    v_exp_f32 v55, v55
    v_add_f32 v243, v243, v39
    v_cvt_pk_bf16_f32 v147, v38, v39
    v_exp_f32 v40, v40
    v_add_f32 v244, v244, v55
    v_cvt_pk_bf16_f32 v151, v54, v55
    v_exp_f32 v56, v56
    v_add_f32 v243, v243, v40
    v_exp_f32 v41, v41
    v_add_f32 v244, v244, v56
    v_exp_f32 v57, v57
    v_add_f32 v243, v243, v41
    v_cvt_pk_bf16_f32 v152, v40, v41
    v_exp_f32 v42, v42
    v_add_f32 v244, v244, v57
    v_cvt_pk_bf16_f32 v156, v56, v57
    v_exp_f32 v58, v58
    v_add_f32 v243, v243, v42
    v_exp_f32 v43, v43
    v_add_f32 v244, v244, v58
    v_exp_f32 v59, v59
    v_add_f32 v243, v243, v43
    v_cvt_pk_bf16_f32 v153, v42, v43
    v_exp_f32 v44, v44
    v_add_f32 v244, v244, v59
    v_cvt_pk_bf16_f32 v157, v58, v59
    v_exp_f32 v60, v60
    v_add_f32 v243, v243, v44
    v_exp_f32 v45, v45
    v_add_f32 v244, v244, v60
    v_exp_f32 v61, v61
    v_add_f32 v243, v243, v45
    v_cvt_pk_bf16_f32 v154, v44, v45
    v_exp_f32 v46, v46
    v_add_f32 v244, v244, v61
    v_cvt_pk_bf16_f32 v158, v60, v61
    v_exp_f32 v62, v62
    v_add_f32 v243, v243, v46
    v_exp_f32 v47, v47
    v_add_f32 v244, v244, v62
    v_exp_f32 v63, v63
    v_add_f32 v243, v243, v47
    v_cvt_pk_bf16_f32 v155, v46, v47
    v_add_f32 v244, v244, v63
    v_cvt_pk_bf16_f32 v159, v62, v63
    v_add_f32 v241, v241, v243
    v_add_f32 v242, v242, v244
    s_add_u32 s35, s35, 16384
    s_mov_b32 s42, 0
L_loop:
    s_waitcnt lgkmcnt(2)
    v_mfma_f32_32x32x16_bf16 v[0:15], a[192:195], a[128:131], v[192:207]
    v_exp_f32 v64, v64
    v_exp_f32 v80, v80
    v_exp_f32 v65, v65
    v_mfma_f32_32x32x16_bf16 v[16:31], a[192:195], a[160:163], v[208:223]
    ds_read_b128 a[208:211], v228 offset:32768
    s_mov_b32 m0, s37
    v_exp_f32 v81, v81
    v_add_f32 v243, v64, v65
    v_cvt_pk_bf16_f32 v160, v64, v65
    v_mfma_f32_32x32x16_bf16 v[0:15], a[196:199], a[132:135], v[0:15]
    buffer_load_dwordx4 v236, s[8:11], s33 offen lds
    v_exp_f32 v66, v66
    v_add_f32 v244, v80, v81
    v_cvt_pk_bf16_f32 v164, v80, v81
    v_mfma_f32_32x32x16_bf16 v[16:31], a[196:199], a[164:167], v[16:31]
    ds_read_b128 a[212:215], v229 offset:32768
    v_exp_f32 v82, v82
    v_add_f32 v243, v243, v66
    s_waitcnt lgkmcnt(2)
    v_mfma_f32_32x32x16_bf16 v[0:15], a[200:203], a[136:139], v[0:15]
    buffer_load_dwordx4 v237, s[8:11], s33 offen offset:1024 lds
    v_exp_f32 v67, v67
    v_add_f32 v244, v244, v82
    v_exp_f32 v83, v83
    v_mfma_f32_32x32x16_bf16 v[16:31], a[200:203], a[168:171], v[16:31]
    ds_read_b128 a[216:219], v230 offset:32768
    v_add_f32 v243, v243, v67
    v_cvt_pk_bf16_f32 v161, v66, v67
    v_exp_f32 v68, v68
    v_add_f32 v244, v244, v83
    v_mfma_f32_32x32x16_bf16 v[0:15], a[204:207], a[140:143], v[0:15]
    buffer_load_dwordx4 v238, s[8:11], s33 offen offset:2048 lds
    v_cvt_pk_bf16_f32 v165, v82, v83
    v_exp_f32 v84, v84
    v_add_f32 v243, v243, v68
    v_mfma_f32_32x32x16_bf16 v[16:31], a[204:207], a[172:175], v[16:31]
    ds_read_b128 a[220:223], v231 offset:32768
    v_exp_f32 v69, v69
    v_add_f32 v244, v244, v84
    s_waitcnt lgkmcnt(2)
    v_mfma_f32_32x32x16_bf16 v[0:15], a[208:211], a[144:147], v[0:15]
    buffer_load_dwordx4 v239, s[8:11], s33 offen offset:3072 lds
    v_exp_f32 v85, v85
    v_add_f32 v243, v243, v69
    v_cvt_pk_bf16_f32 v162, v68, v69
    v_mfma_f32_32x32x16_bf16 v[16:31], a[208:211], a[176:179], v[16:31]
    ds_read_b128 a[192:195], v224 offset:40960
    s_mov_b32 m0, s41
    v_exp_f32 v70, v70
    v_add_f32 v244, v244, v85
    v_cvt_pk_bf16_f32 v166, v84, v85
    v_mfma_f32_32x32x16_bf16 v[0:15], a[212:215], a[148:151], v[0:15]
    buffer_load_dwordx4 v240, s[12:15], s34 offen lds
    v_exp_f32 v86, v86
    v_add_f32 v243, v243, v70
    v_exp_f32 v71, v71
    v_mfma_f32_32x32x16_bf16 v[16:31], a[212:215], a[180:183], v[16:31]
    ds_read_b128 a[196:199], v225 offset:40960
    v_add_f32 v244, v244, v86
    v_exp_f32 v87, v87
    v_add_f32 v243, v243, v71
    s_waitcnt lgkmcnt(2)
    v_mfma_f32_32x32x16_bf16 v[0:15], a[216:219], a[152:155], v[0:15]
    buffer_load_dwordx4 v240, s[12:15], s34 offen offset:1024 lds
    v_cvt_pk_bf16_f32 v163, v70, v71
    v_exp_f32 v72, v72
    v_add_f32 v244, v244, v87
    v_cvt_pk_bf16_f32 v167, v86, v87
    v_mfma_f32_32x32x16_bf16 v[16:31], a[216:219], a[184:187], v[16:31]
    ds_read_b128 a[200:203], v226 offset:40960
    v_exp_f32 v88, v88
    v_add_f32 v243, v243, v72
    v_exp_f32 v73, v73
    v_mfma_f32_32x32x16_bf16 v[0:15], a[220:223], a[156:159], v[0:15]
    buffer_load_dwordx4 v240, s[12:15], s34 offen offset:2048 lds
    v_add_f32 v244, v244, v88
    v_exp_f32 v89, v89
    v_add_f32 v243, v243, v73
    v_cvt_pk_bf16_f32 v168, v72, v73
    v_mfma_f32_32x32x16_bf16 v[16:31], a[220:223], a[188:191], v[16:31]
    ds_read_b128 a[204:207], v227 offset:40960
    v_exp_f32 v74, v74
    v_add_f32 v244, v244, v89
    v_cvt_pk_bf16_f32 v172, v88, v89
    s_waitcnt lgkmcnt(2)
    v_mfma_f32_32x32x16_bf16 v[32:47], a[192:195], a[128:131], v[192:207]
    buffer_load_dwordx4 v240, s[12:15], s34 offen offset:3072 lds
    v_exp_f32 v90, v90
    v_add_f32 v243, v243, v74
    v_exp_f32 v75, v75
    v_mfma_f32_32x32x16_bf16 v[48:63], a[192:195], a[160:163], v[208:223]
    ds_read_b128 a[208:211], v228 offset:40960
    v_add_f32 v244, v244, v90
    v_exp_f32 v91, v91
    v_add_f32 v243, v243, v75
    v_cvt_pk_bf16_f32 v169, v74, v75
    v_mfma_f32_32x32x16_bf16 v[32:47], a[196:199], a[132:135], v[32:47]
    s_add_u32 s33, s33, 16384
    v_exp_f32 v76, v76
    v_add_f32 v244, v244, v91
    v_cvt_pk_bf16_f32 v173, v90, v91
    v_mfma_f32_32x32x16_bf16 v[48:63], a[196:199], a[164:167], v[48:63]
    ds_read_b128 a[212:215], v229 offset:40960
    s_add_u32 s34, s34, 16384
    v_exp_f32 v92, v92
    v_add_f32 v243, v243, v76
    s_waitcnt lgkmcnt(2)
    v_mfma_f32_32x32x16_bf16 v[32:47], a[200:203], a[136:139], v[32:47]
    v_exp_f32 v77, v77
    v_add_f32 v244, v244, v92
    v_exp_f32 v93, v93
    v_add_f32 v243, v243, v77
    v_mfma_f32_32x32x16_bf16 v[48:63], a[200:203], a[168:171], v[48:63]
    ds_read_b128 a[216:219], v230 offset:40960
    ds_read_b64_tr_b16 a[224:225], v232 offset:0
    v_cvt_pk_bf16_f32 v170, v76, v77
    v_exp_f32 v78, v78
    v_add_f32 v244, v244, v93
    v_mfma_f32_32x32x16_bf16 v[32:47], a[204:207], a[140:143], v[32:47]
    ds_read_b64_tr_b16 a[226:227], v232 offset:2048
    v_cvt_pk_bf16_f32 v174, v92, v93
    v_exp_f32 v94, v94
    v_add_f32 v243, v243, v78
    v_mfma_f32_32x32x16_bf16 v[48:63], a[204:207], a[172:175], v[48:63]
    ds_read_b128 a[220:223], v231 offset:40960
    ds_read_b64_tr_b16 a[228:229], v233 offset:0
    v_exp_f32 v79, v79
    v_add_f32 v244, v244, v94
    s_waitcnt lgkmcnt(5)
    v_mfma_f32_32x32x16_bf16 v[32:47], a[208:211], a[144:147], v[32:47]
    ds_read_b64_tr_b16 a[230:231], v233 offset:2048
    v_exp_f32 v95, v95
    v_add_f32 v243, v243, v79
    v_cvt_pk_bf16_f32 v171, v78, v79
    v_mfma_f32_32x32x16_bf16 v[48:63], a[208:211], a[176:179], v[48:63]
    ds_read_b64_tr_b16 a[232:233], v234 offset:0
    v_exp_f32 v96, v96
    v_add_f32 v244, v244, v95
    v_cvt_pk_bf16_f32 v175, v94, v95
    v_mfma_f32_32x32x16_bf16 v[32:47], a[212:215], a[148:151], v[32:47]
    ds_read_b64_tr_b16 a[234:235], v234 offset:2048
    v_exp_f32 v112, v112
    v_add_f32 v243, v243, v96
    v_exp_f32 v97, v97
    v_mfma_f32_32x32x16_bf16 v[48:63], a[212:215], a[180:183], v[48:63]
    ds_read_b64_tr_b16 a[236:237], v235 offset:0
    v_add_f32 v244, v244, v112
    v_exp_f32 v113, v113
    v_add_f32 v243, v243, v97
    s_waitcnt lgkmcnt(5)
    v_mfma_f32_32x32x16_bf16 v[32:47], a[216:219], a[152:155], v[32:47]
    ds_read_b64_tr_b16 a[238:239], v235 offset:2048
    v_cvt_pk_bf16_f32 v176, v96, v97
    v_exp_f32 v98, v98
    v_add_f32 v244, v244, v113
    v_cvt_pk_bf16_f32 v180, v112, v113
    v_mfma_f32_32x32x16_bf16 v[48:63], a[216:219], a[184:187], v[48:63]
    ds_read_b64_tr_b16 a[240:241], v232 offset:4096
    v_exp_f32 v114, v114
    v_add_f32 v243, v243, v98
    v_exp_f32 v99, v99
    v_mfma_f32_32x32x16_bf16 v[32:47], a[220:223], a[156:159], v[32:47]
    ds_read_b64_tr_b16 a[242:243], v232 offset:6144
    v_add_f32 v244, v244, v114
    v_exp_f32 v115, v115
    v_add_f32 v243, v243, v99
    v_cvt_pk_bf16_f32 v177, v98, v99
    v_mfma_f32_32x32x16_bf16 v[48:63], a[220:223], a[188:191], v[48:63]
    ds_read_b64_tr_b16 a[244:245], v233 offset:4096
    v_exp_f32 v100, v100
    v_add_f32 v244, v244, v115
    v_cvt_pk_bf16_f32 v181, v114, v115
    s_waitcnt lgkmcnt(7)
    v_mfma_f32_32x32x16_bf16 a[0:15], a[224:227], v[128:131], a[0:15]
    ds_read_b64_tr_b16 a[246:247], v233 offset:6144
    v_exp_f32 v116, v116
    v_add_f32 v243, v243, v100
    v_exp_f32 v101, v101
    v_mfma_f32_32x32x16_bf16 a[16:31], a[224:227], v[132:135], a[16:31]
    ds_read_b64_tr_b16 a[248:249], v234 offset:4096
    v_add_f32 v244, v244, v116
    v_exp_f32 v117, v117
    v_add_f32 v243, v243, v101
    v_cvt_pk_bf16_f32 v178, v100, v101
    v_mfma_f32_32x32x16_bf16 a[32:47], a[228:231], v[128:131], a[32:47]
    ds_read_b64_tr_b16 a[250:251], v234 offset:6144
    v_exp_f32 v102, v102
    v_add_f32 v244, v244, v117
    v_cvt_pk_bf16_f32 v182, v116, v117
    v_mfma_f32_32x32x16_bf16 a[48:63], a[228:231], v[132:135], a[48:63]
    ds_read_b64_tr_b16 a[252:253], v235 offset:4096
    v_exp_f32 v118, v118
    v_add_f32 v243, v243, v102
    s_waitcnt lgkmcnt(7)
    v_mfma_f32_32x32x16_bf16 a[64:79], a[232:235], v[128:131], a[64:79]
    ds_read_b64_tr_b16 a[254:255], v235 offset:6144
    v_exp_f32 v103, v103
    v_add_f32 v244, v244, v118
    v_exp_f32 v119, v119
    v_mfma_f32_32x32x16_bf16 a[80:95], a[232:235], v[132:135], a[80:95]
    ds_read_b64_tr_b16 a[224:225], v232 offset:8192
    v_add_f32 v243, v243, v103
    v_cvt_pk_bf16_f32 v179, v102, v103
    v_exp_f32 v104, v104
    v_add_f32 v244, v244, v119
    v_mfma_f32_32x32x16_bf16 a[96:111], a[236:239], v[128:131], a[96:111]
    ds_read_b64_tr_b16 a[226:227], v232 offset:10240
    v_cvt_pk_bf16_f32 v183, v118, v119
    v_exp_f32 v120, v120
    v_add_f32 v243, v243, v104
    v_mfma_f32_32x32x16_bf16 a[112:127], a[236:239], v[132:135], a[112:127]
    ds_read_b64_tr_b16 a[228:229], v233 offset:8192
    v_exp_f32 v105, v105
    v_add_f32 v244, v244, v120
    s_waitcnt lgkmcnt(7)
    v_mfma_f32_32x32x16_bf16 a[0:15], a[240:243], v[136:139], a[0:15]
    ds_read_b64_tr_b16 a[230:231], v233 offset:10240
    v_exp_f32 v121, v121
    v_add_f32 v243, v243, v105
    v_cvt_pk_bf16_f32 v184, v104, v105
    v_mfma_f32_32x32x16_bf16 a[16:31], a[240:243], v[140:143], a[16:31]
    ds_read_b64_tr_b16 a[232:233], v234 offset:8192
    v_exp_f32 v106, v106
    v_add_f32 v244, v244, v121
    v_cvt_pk_bf16_f32 v188, v120, v121
    v_mfma_f32_32x32x16_bf16 a[32:47], a[244:247], v[136:139], a[32:47]
    ds_read_b64_tr_b16 a[234:235], v234 offset:10240
    v_exp_f32 v122, v122
    v_add_f32 v243, v243, v106
    v_exp_f32 v107, v107
    v_mfma_f32_32x32x16_bf16 a[48:63], a[244:247], v[140:143], a[48:63]
    ds_read_b64_tr_b16 a[236:237], v235 offset:8192
    v_add_f32 v244, v244, v122
    v_exp_f32 v123, v123
    v_add_f32 v243, v243, v107
    s_waitcnt lgkmcnt(7)
    v_mfma_f32_32x32x16_bf16 a[64:79], a[248:251], v[136:139], a[64:79]
    ds_read_b64_tr_b16 a[238:239], v235 offset:10240
    v_cvt_pk_bf16_f32 v185, v106, v107
    v_exp_f32 v108, v108
    v_add_f32 v244, v244, v123
    v_cvt_pk_bf16_f32 v189, v122, v123
    v_mfma_f32_32x32x16_bf16 a[80:95], a[248:251], v[140:143], a[80:95]
    ds_read_b64_tr_b16 a[240:241], v232 offset:12288
    v_exp_f32 v124, v124
    v_add_f32 v243, v243, v108
    v_exp_f32 v109, v109
    v_mfma_f32_32x32x16_bf16 a[96:111], a[252:255], v[136:139], a[96:111]
    ds_read_b64_tr_b16 a[242:243], v232 offset:14336
    v_add_f32 v244, v244, v124
    v_exp_f32 v125, v125
    v_add_f32 v243, v243, v109
    v_cvt_pk_bf16_f32 v186, v108, v109
    v_mfma_f32_32x32x16_bf16 a[112:127], a[252:255], v[140:143], a[112:127]
    ds_read_b64_tr_b16 a[244:245], v233 offset:12288
    v_exp_f32 v110, v110
    v_add_f32 v244, v244, v125
    v_cvt_pk_bf16_f32 v190, v124, v125
    s_waitcnt lgkmcnt(7)
    v_mfma_f32_32x32x16_bf16 a[0:15], a[224:227], v[144:147], a[0:15]
    ds_read_b64_tr_b16 a[246:247], v233 offset:14336
    v_exp_f32 v126, v126
    v_add_f32 v243, v243, v110
    v_exp_f32 v111, v111
    v_mfma_f32_32x32x16_bf16 a[16:31], a[224:227], v[148:151], a[16:31]
    ds_read_b64_tr_b16 a[248:249], v234 offset:12288
    v_add_f32 v244, v244, v126
    v_exp_f32 v127, v127
    v_add_f32 v243, v243, v111
    v_cvt_pk_bf16_f32 v187, v110, v111
    v_mfma_f32_32x32x16_bf16 a[32:47], a[228:231], v[144:147], a[32:47]
    ds_read_b64_tr_b16 a[250:251], v234 offset:14336
    v_add_f32 v244, v244, v127
    v_cvt_pk_bf16_f32 v191, v126, v127
    v_max_f32 v246, v243, v244
    v_cmp_lt_f32 vcc, s43, v246
    v_mfma_f32_32x32x16_bf16 a[48:63], a[228:231], v[148:151], a[48:63]
    ds_read_b64_tr_b16 a[252:253], v235 offset:12288
    s_waitcnt lgkmcnt(7)
    v_mfma_f32_32x32x16_bf16 a[64:79], a[232:235], v[144:147], a[64:79]
    ds_read_b64_tr_b16 a[254:255], v235 offset:14336
    v_mfma_f32_32x32x16_bf16 a[80:95], a[232:235], v[148:151], a[80:95]
    v_mfma_f32_32x32x16_bf16 a[96:111], a[236:239], v[144:147], a[96:111]
    v_mfma_f32_32x32x16_bf16 a[112:127], a[236:239], v[148:151], a[112:127]
    s_waitcnt lgkmcnt(4)
    v_mfma_f32_32x32x16_bf16 a[0:15], a[240:243], v[152:155], a[0:15]
    s_waitcnt vmcnt(8) lgkmcnt(0)
    s_barrier
    v_mfma_f32_32x32x16_bf16 a[16:31], a[240:243], v[156:159], a[16:31]
    ds_read_b128 a[192:195], v224 offset:0
    v_mfma_f32_32x32x16_bf16 a[32:47], a[244:247], v[152:155], a[32:47]
    ds_read_b128 a[196:199], v225 offset:0
    v_mfma_f32_32x32x16_bf16 a[48:63], a[244:247], v[156:159], a[48:63]
    ds_read_b128 a[200:203], v226 offset:0
    v_mfma_f32_32x32x16_bf16 a[64:79], a[248:251], v[152:155], a[64:79]
    ds_read_b128 a[204:207], v227 offset:0
    v_mfma_f32_32x32x16_bf16 a[80:95], a[248:251], v[156:159], a[80:95]
    v_mfma_f32_32x32x16_bf16 a[96:111], a[252:255], v[152:155], a[96:111]
    v_mfma_f32_32x32x16_bf16 a[112:127], a[252:255], v[156:159], a[112:127]
    s_cbranch_vccnz L_rare0
L_ret0:
    v_add_f32 v241, v241, v243
    v_add_f32 v242, v242, v244
    s_add_u32 s35, s35, 16384
    s_waitcnt lgkmcnt(2)
    v_mfma_f32_32x32x16_bf16 v[64:79], a[192:195], a[128:131], v[192:207]
    v_exp_f32 v0, v0
    v_exp_f32 v16, v16
    v_exp_f32 v1, v1
    v_mfma_f32_32x32x16_bf16 v[80:95], a[192:195], a[160:163], v[208:223]
    ds_read_b128 a[208:211], v228 offset:0
    s_mov_b32 m0, s38
    v_exp_f32 v17, v17
    v_add_f32 v243, v0, v1
    v_cvt_pk_bf16_f32 v128, v0, v1
    v_mfma_f32_32x32x16_bf16 v[64:79], a[196:199], a[132:135], v[64:79]
    buffer_load_dwordx4 v236, s[8:11], s33 offen lds
    v_exp_f32 v2, v2
    v_add_f32 v244, v16, v17
    v_cvt_pk_bf16_f32 v132, v16, v17
    v_mfma_f32_32x32x16_bf16 v[80:95], a[196:199], a[164:167], v[80:95]
    ds_read_b128 a[212:215], v229 offset:0
    v_exp_f32 v18, v18
    v_add_f32 v243, v243, v2
    s_waitcnt lgkmcnt(2)
    v_mfma_f32_32x32x16_bf16 v[64:79], a[200:203], a[136:139], v[64:79]
    buffer_load_dwordx4 v237, s[8:11], s33 offen offset:1024 lds
    v_exp_f32 v3, v3
    v_add_f32 v244, v244, v18
    v_exp_f32 v19, v19
    v_mfma_f32_32x32x16_bf16 v[80:95], a[200:203], a[168:171], v[80:95]
    ds_read_b128 a[216:219], v230 offset:0
    v_add_f32 v243, v243, v3
    v_cvt_pk_bf16_f32 v129, v2, v3
    v_exp_f32 v4, v4
    v_add_f32 v244, v244, v19
    v_mfma_f32_32x32x16_bf16 v[64:79], a[204:207], a[140:143], v[64:79]
    buffer_load_dwordx4 v238, s[8:11], s33 offen offset:2048 lds
    v_cvt_pk_bf16_f32 v133, v18, v19
    v_exp_f32 v20, v20
    v_add_f32 v243, v243, v4
    v_mfma_f32_32x32x16_bf16 v[80:95], a[204:207], a[172:175], v[80:95]
    ds_read_b128 a[220:223], v231 offset:0
    v_exp_f32 v5, v5
    v_add_f32 v244, v244, v20
    s_waitcnt lgkmcnt(2)
    v_mfma_f32_32x32x16_bf16 v[64:79], a[208:211], a[144:147], v[64:79]
    buffer_load_dwordx4 v239, s[8:11], s33 offen offset:3072 lds
    v_exp_f32 v21, v21
    v_add_f32 v243, v243, v5
    v_cvt_pk_bf16_f32 v130, v4, v5
    v_mfma_f32_32x32x16_bf16 v[80:95], a[208:211], a[176:179], v[80:95]
    ds_read_b128 a[192:195], v224 offset:8192
    s_mov_b32 m0, s39
    v_exp_f32 v6, v6
    v_add_f32 v244, v244, v21
    v_cvt_pk_bf16_f32 v134, v20, v21
    v_mfma_f32_32x32x16_bf16 v[64:79], a[212:215], a[148:151], v[64:79]
    buffer_load_dwordx4 v240, s[12:15], s34 offen lds
    v_exp_f32 v22, v22
    v_add_f32 v243, v243, v6
    v_exp_f32 v7, v7
    v_mfma_f32_32x32x16_bf16 v[80:95], a[212:215], a[180:183], v[80:95]
    ds_read_b128 a[196:199], v225 offset:8192
    v_add_f32 v244, v244, v22
    v_exp_f32 v23, v23
    v_add_f32 v243, v243, v7
    s_waitcnt lgkmcnt(2)
    v_mfma_f32_32x32x16_bf16 v[64:79], a[216:219], a[152:155], v[64:79]
    buffer_load_dwordx4 v240, s[12:15], s34 offen offset:1024 lds
    v_cvt_pk_bf16_f32 v131, v6, v7
    v_exp_f32 v8, v8
    v_add_f32 v244, v244, v23
    v_cvt_pk_bf16_f32 v135, v22, v23
    v_mfma_f32_32x32x16_bf16 v[80:95], a[216:219], a[184:187], v[80:95]
    ds_read_b128 a[200:203], v226 offset:8192
    v_exp_f32 v24, v24
    v_add_f32 v243, v243, v8
    v_exp_f32 v9, v9
    v_mfma_f32_32x32x16_bf16 v[64:79], a[220:223], a[156:159], v[64:79]
    buffer_load_dwordx4 v240, s[12:15], s34 offen offset:2048 lds
    v_add_f32 v244, v244, v24
    v_exp_f32 v25, v25
    v_add_f32 v243, v243, v9
    v_cvt_pk_bf16_f32 v136, v8, v9
    v_mfma_f32_32x32x16_bf16 v[80:95], a[220:223], a[188:191], v[80:95]
    ds_read_b128 a[204:207], v227 offset:8192
    v_exp_f32 v10, v10
    v_add_f32 v244, v244, v25
    v_cvt_pk_bf16_f32 v140, v24, v25
    s_waitcnt lgkmcnt(2)
    v_mfma_f32_32x32x16_bf16 v[96:111], a[192:195], a[128:131], v[192:207]
    buffer_load_dwordx4 v240, s[12:15], s34 offen offset:3072 lds
    v_exp_f32 v26, v26
    v_add_f32 v243, v243, v10
    v_exp_f32 v11, v11
    v_mfma_f32_32x32x16_bf16 v[112:127], a[192:195], a[160:163], v[208:223]
    ds_read_b128 a[208:211], v228 offset:8192
    v_add_f32 v244, v244, v26
    v_exp_f32 v27, v27
    v_add_f32 v243, v243, v11
    v_cvt_pk_bf16_f32 v137, v10, v11
    v_mfma_f32_32x32x16_bf16 v[96:111], a[196:199], a[132:135], v[96:111]
    s_add_u32 s33, s33, 16384
    v_exp_f32 v12, v12
    v_add_f32 v244, v244, v27
    v_cvt_pk_bf16_f32 v141, v26, v27
    v_mfma_f32_32x32x16_bf16 v[112:127], a[196:199], a[164:167], v[112:127]
    ds_read_b128 a[212:215], v229 offset:8192
    s_add_u32 s34, s34, 16384
    v_exp_f32 v28, v28
    v_add_f32 v243, v243, v12
    s_waitcnt lgkmcnt(2)
    v_mfma_f32_32x32x16_bf16 v[96:111], a[200:203], a[136:139], v[96:111]
    v_exp_f32 v13, v13
    v_add_f32 v244, v244, v28
    v_exp_f32 v29, v29
    v_add_f32 v243, v243, v13
    v_mfma_f32_32x32x16_bf16 v[112:127], a[200:203], a[168:171], v[112:127]
    ds_read_b128 a[216:219], v230 offset:8192
    ds_read_b64_tr_b16 a[224:225], v232 offset:16384
    v_cvt_pk_bf16_f32 v138, v12, v13
    v_exp_f32 v14, v14
    v_add_f32 v244, v244, v29
    v_mfma_f32_32x32x16_bf16 v[96:111], a[204:207], a[140:143], v[96:111]
    ds_read_b64_tr_b16 a[226:227], v232 offset:18432
    v_cvt_pk_bf16_f32 v142, v28, v29
    v_exp_f32 v30, v30
    v_add_f32 v243, v243, v14
    v_mfma_f32_32x32x16_bf16 v[112:127], a[204:207], a[172:175], v[112:127]
    ds_read_b128 a[220:223], v231 offset:8192
    ds_read_b64_tr_b16 a[228:229], v233 offset:16384
    v_exp_f32 v15, v15
    v_add_f32 v244, v244, v30
    s_waitcnt lgkmcnt(5)
    v_mfma_f32_32x32x16_bf16 v[96:111], a[208:211], a[144:147], v[96:111]
    ds_read_b64_tr_b16 a[230:231], v233 offset:18432
    v_exp_f32 v31, v31
    v_add_f32 v243, v243, v15
    v_cvt_pk_bf16_f32 v139, v14, v15
    v_mfma_f32_32x32x16_bf16 v[112:127], a[208:211], a[176:179], v[112:127]
    ds_read_b64_tr_b16 a[232:233], v234 offset:16384
    v_exp_f32 v32, v32
    v_add_f32 v244, v244, v31
    v_cvt_pk_bf16_f32 v143, v30, v31
    v_mfma_f32_32x32x16_bf16 v[96:111], a[212:215], a[148:151], v[96:111]
    ds_read_b64_tr_b16 a[234:235], v234 offset:18432
    v_exp_f32 v48, v48
    v_add_f32 v243, v243, v32
    v_exp_f32 v33, v33
    v_mfma_f32_32x32x16_bf16 v[112:127], a[212:215], a[180:183], v[112:127]
    ds_read_b64_tr_b16 a[236:237], v235 offset:16384
    v_add_f32 v244, v244, v48
    v_exp_f32 v49, v49
    v_add_f32 v243, v243, v33
    s_waitcnt lgkmcnt(5)
    v_mfma_f32_32x32x16_bf16 v[96:111], a[216:219], a[152:155], v[96:111]
    ds_read_b64_tr_b16 a[238:239], v235 offset:18432
    v_cvt_pk_bf16_f32 v144, v32, v33
    v_exp_f32 v34, v34
    v_add_f32 v244, v244, v49
    v_cvt_pk_bf16_f32 v148, v48, v49
    v_mfma_f32_32x32x16_bf16 v[112:127], a[216:219], a[184:187], v[112:127]
    ds_read_b64_tr_b16 a[240:241], v232 offset:20480
    v_exp_f32 v50, v50
    v_add_f32 v243, v243, v34
    v_exp_f32 v35, v35
    v_mfma_f32_32x32x16_bf16 v[96:111], a[220:223], a[156:159], v[96:111]
    ds_read_b64_tr_b16 a[242:243], v232 offset:22528
    v_add_f32 v244, v244, v50
    v_exp_f32 v51, v51
    v_add_f32 v243, v243, v35
    v_cvt_pk_bf16_f32 v145, v34, v35
    v_mfma_f32_32x32x16_bf16 v[112:127], a[220:223], a[188:191], v[112:127]
    ds_read_b64_tr_b16 a[244:245], v233 offset:20480
    v_exp_f32 v36, v36
    v_add_f32 v244, v244, v51
    v_cvt_pk_bf16_f32 v149, v50, v51
    s_waitcnt lgkmcnt(7)
    v_mfma_f32_32x32x16_bf16 a[0:15], a[224:227], v[160:163], a[0:15]
    ds_read_b64_tr_b16 a[246:247], v233 offset:22528
    v_exp_f32 v52, v52
    v_add_f32 v243, v243, v36
    v_exp_f32 v37, v37
    v_mfma_f32_32x32x16_bf16 a[16:31], a[224:227], v[164:167], a[16:31]
    ds_read_b64_tr_b16 a[248:249], v234 offset:20480
    v_add_f32 v244, v244, v52
    v_exp_f32 v53, v53
    v_add_f32 v243, v243, v37
    v_cvt_pk_bf16_f32 v146, v36, v37
    v_mfma_f32_32x32x16_bf16 a[32:47], a[228:231], v[160:163], a[32:47]
    ds_read_b64_tr_b16 a[250:251], v234 offset:22528
    v_exp_f32 v38, v38
    v_add_f32 v244, v244, v53
    v_cvt_pk_bf16_f32 v150, v52, v53
    v_mfma_f32_32x32x16_bf16 a[48:63], a[228:231], v[164:167], a[48:63]
    ds_read_b64_tr_b16 a[252:253], v235 offset:20480
    v_exp_f32 v54, v54
    v_add_f32 v243, v243, v38
    s_waitcnt lgkmcnt(7)
    v_mfma_f32_32x32x16_bf16 a[64:79], a[232:235], v[160:163], a[64:79]
    ds_read_b64_tr_b16 a[254:255], v235 offset:22528
    v_exp_f32 v39, v39
    v_add_f32 v244, v244, v54
    v_exp_f32 v55, v55
    v_mfma_f32_32x32x16_bf16 a[80:95], a[232:235], v[164:167], a[80:95]
    ds_read_b64_tr_b16 a[224:225], v232 offset:24576
    v_add_f32 v243, v243, v39
    v_cvt_pk_bf16_f32 v147, v38, v39
    v_exp_f32 v40, v40
    v_add_f32 v244, v244, v55
    v_mfma_f32_32x32x16_bf16 a[96:111], a[236:239], v[160:163], a[96:111]
    ds_read_b64_tr_b16 a[226:227], v232 offset:26624
    v_cvt_pk_bf16_f32 v151, v54, v55
    v_exp_f32 v56, v56
    v_add_f32 v243, v243, v40
    v_mfma_f32_32x32x16_bf16 a[112:127], a[236:239], v[164:167], a[112:127]
    ds_read_b64_tr_b16 a[228:229], v233 offset:24576
    v_exp_f32 v41, v41
    v_add_f32 v244, v244, v56
    s_waitcnt lgkmcnt(7)
    v_mfma_f32_32x32x16_bf16 a[0:15], a[240:243], v[168:171], a[0:15]
    ds_read_b64_tr_b16 a[230:231], v233 offset:26624
    v_exp_f32 v57, v57
    v_add_f32 v243, v243, v41
    v_cvt_pk_bf16_f32 v152, v40, v41
    v_mfma_f32_32x32x16_bf16 a[16:31], a[240:243], v[172:175], a[16:31]
    ds_read_b64_tr_b16 a[232:233], v234 offset:24576
    v_exp_f32 v42, v42
    v_add_f32 v244, v244, v57
    v_cvt_pk_bf16_f32 v156, v56, v57
    v_mfma_f32_32x32x16_bf16 a[32:47], a[244:247], v[168:171], a[32:47]
    ds_read_b64_tr_b16 a[234:235], v234 offset:26624
    v_exp_f32 v58, v58
    v_add_f32 v243, v243, v42
    v_exp_f32 v43, v43
    v_mfma_f32_32x32x16_bf16 a[48:63], a[244:247], v[172:175], a[48:63]
    ds_read_b64_tr_b16 a[236:237], v235 offset:24576
    v_add_f32 v244, v244, v58
    v_exp_f32 v59, v59
    v_add_f32 v243, v243, v43
    s_waitcnt lgkmcnt(7)
    v_mfma_f32_32x32x16_bf16 a[64:79], a[248:251], v[168:171], a[64:79]
    ds_read_b64_tr_b16 a[238:239], v235 offset:26624
    v_cvt_pk_bf16_f32 v153, v42, v43
    v_exp_f32 v44, v44
    v_add_f32 v244, v244, v59
    v_cvt_pk_bf16_f32 v157, v58, v59
    v_mfma_f32_32x32x16_bf16 a[80:95], a[248:251], v[172:175], a[80:95]
    ds_read_b64_tr_b16 a[240:241], v232 offset:28672
    v_exp_f32 v60, v60
    v_add_f32 v243, v243, v44
    v_exp_f32 v45, v45
    v_mfma_f32_32x32x16_bf16 a[96:111], a[252:255], v[168:171], a[96:111]
    ds_read_b64_tr_b16 a[242:243], v232 offset:30720
    v_add_f32 v244, v244, v60
    v_exp_f32 v61, v61
    v_add_f32 v243, v243, v45
    v_cvt_pk_bf16_f32 v154, v44, v45
    v_mfma_f32_32x32x16_bf16 a[112:127], a[252:255], v[172:175], a[112:127]
    ds_read_b64_tr_b16 a[244:245], v233 offset:28672
    v_exp_f32 v46, v46
    v_add_f32 v244, v244, v61
    v_cvt_pk_bf16_f32 v158, v60, v61
    s_waitcnt lgkmcnt(7)
    v_mfma_f32_32x32x16_bf16 a[0:15], a[224:227], v[176:179], a[0:15]
    ds_read_b64_tr_b16 a[246:247], v233 offset:30720
    v_exp_f32 v62, v62
    v_add_f32 v243, v243, v46
    v_exp_f32 v47, v47
    v_mfma_f32_32x32x16_bf16 a[16:31], a[224:227], v[180:183], a[16:31]
    ds_read_b64_tr_b16 a[248:249], v234 offset:28672
    v_add_f32 v244, v244, v62
    v_exp_f32 v63, v63
    v_add_f32 v243, v243, v47
    v_cvt_pk_bf16_f32 v155, v46, v47
    v_mfma_f32_32x32x16_bf16 a[32:47], a[228:231], v[176:179], a[32:47]
    ds_read_b64_tr_b16 a[250:251], v234 offset:30720
    v_add_f32 v244, v244, v63
    v_cvt_pk_bf16_f32 v159, v62, v63
    v_max_f32 v246, v243, v244
    v_cmp_lt_f32 vcc, s43, v246
    v_mfma_f32_32x32x16_bf16 a[48:63], a[228:231], v[180:183], a[48:63]
    ds_read_b64_tr_b16 a[252:253], v235 offset:28672
    s_waitcnt lgkmcnt(7)
    v_mfma_f32_32x32x16_bf16 a[64:79], a[232:235], v[176:179], a[64:79]
    ds_read_b64_tr_b16 a[254:255], v235 offset:30720
    v_mfma_f32_32x32x16_bf16 a[80:95], a[232:235], v[180:183], a[80:95]
    v_mfma_f32_32x32x16_bf16 a[96:111], a[236:239], v[176:179], a[96:111]
    v_mfma_f32_32x32x16_bf16 a[112:127], a[236:239], v[180:183], a[112:127]
    s_waitcnt lgkmcnt(4)
    v_mfma_f32_32x32x16_bf16 a[0:15], a[240:243], v[184:187], a[0:15]
    s_waitcnt vmcnt(8) lgkmcnt(0)
    s_barrier
    v_mfma_f32_32x32x16_bf16 a[16:31], a[240:243], v[188:191], a[16:31]
    ds_read_b128 a[192:195], v224 offset:16384
    v_mfma_f32_32x32x16_bf16 a[32:47], a[244:247], v[184:187], a[32:47]
    ds_read_b128 a[196:199], v225 offset:16384
    v_mfma_f32_32x32x16_bf16 a[48:63], a[244:247], v[188:191], a[48:63]
    ds_read_b128 a[200:203], v226 offset:16384
    v_mfma_f32_32x32x16_bf16 a[64:79], a[248:251], v[184:187], a[64:79]
    ds_read_b128 a[204:207], v227 offset:16384
    v_mfma_f32_32x32x16_bf16 a[80:95], a[248:251], v[188:191], a[80:95]
    v_mfma_f32_32x32x16_bf16 a[96:111], a[252:255], v[184:187], a[96:111]
    v_mfma_f32_32x32x16_bf16 a[112:127], a[252:255], v[188:191], a[112:127]
    s_cbranch_vccnz L_rare1
L_ret1:
    v_add_f32 v241, v241, v243
    v_add_f32 v242, v242, v244
    s_add_u32 s35, s35, 16384
    s_waitcnt lgkmcnt(2)
    v_mfma_f32_32x32x16_bf16 v[0:15], a[192:195], a[128:131], v[192:207]
    v_exp_f32 v64, v64
    v_exp_f32 v80, v80
    v_exp_f32 v65, v65
    v_mfma_f32_32x32x16_bf16 v[16:31], a[192:195], a[160:163], v[208:223]
    ds_read_b128 a[208:211], v228 offset:16384
    s_mov_b32 m0, s36
    v_exp_f32 v81, v81
    v_add_f32 v243, v64, v65
    v_cvt_pk_bf16_f32 v160, v64, v65
    v_mfma_f32_32x32x16_bf16 v[0:15], a[196:199], a[132:135], v[0:15]
    buffer_load_dwordx4 v236, s[8:11], s33 offen lds
    v_exp_f32 v66, v66
    v_add_f32 v244, v80, v81
    v_cvt_pk_bf16_f32 v164, v80, v81
    v_mfma_f32_32x32x16_bf16 v[16:31], a[196:199], a[164:167], v[16:31]
    ds_read_b128 a[212:215], v229 offset:16384
    v_exp_f32 v82, v82
    v_add_f32 v243, v243, v66
    s_waitcnt lgkmcnt(2)
    v_mfma_f32_32x32x16_bf16 v[0:15], a[200:203], a[136:139], v[0:15]
    buffer_load_dwordx4 v237, s[8:11], s33 offen offset:1024 lds
    v_exp_f32 v67, v67
    v_add_f32 v244, v244, v82
    v_exp_f32 v83, v83
    v_mfma_f32_32x32x16_bf16 v[16:31], a[200:203], a[168:171], v[16:31]
    ds_read_b128 a[216:219], v230 offset:16384
    v_add_f32 v243, v243, v67
    v_cvt_pk_bf16_f32 v161, v66, v67
    v_exp_f32 v68, v68
    v_add_f32 v244, v244, v83
    v_mfma_f32_32x32x16_bf16 v[0:15], a[204:207], a[140:143], v[0:15]
    buffer_load_dwordx4 v238, s[8:11], s33 offen offset:2048 lds
    v_cvt_pk_bf16_f32 v165, v82, v83
    v_exp_f32 v84, v84
    v_add_f32 v243, v243, v68
    v_mfma_f32_32x32x16_bf16 v[16:31], a[204:207], a[172:175], v[16:31]
    ds_read_b128 a[220:223], v231 offset:16384
    v_exp_f32 v69, v69
    v_add_f32 v244, v244, v84
    s_waitcnt lgkmcnt(2)
    v_mfma_f32_32x32x16_bf16 v[0:15], a[208:211], a[144:147], v[0:15]
    buffer_load_dwordx4 v239, s[8:11], s33 offen offset:3072 lds
    v_exp_f32 v85, v85
    v_add_f32 v243, v243, v69
    v_cvt_pk_bf16_f32 v162, v68, v69
    v_mfma_f32_32x32x16_bf16 v[16:31], a[208:211], a[176:179], v[16:31]
    ds_read_b128 a[192:195], v224 offset:24576
    s_mov_b32 m0, s40
    v_exp_f32 v70, v70
    v_add_f32 v244, v244, v85
    v_cvt_pk_bf16_f32 v166, v84, v85
    v_mfma_f32_32x32x16_bf16 v[0:15], a[212:215], a[148:151], v[0:15]
    buffer_load_dwordx4 v240, s[12:15], s34 offen lds
    v_exp_f32 v86, v86
    v_add_f32 v243, v243, v70
    v_exp_f32 v71, v71
    v_mfma_f32_32x32x16_bf16 v[16:31], a[212:215], a[180:183], v[16:31]
    ds_read_b128 a[196:199], v225 offset:24576
    v_add_f32 v244, v244, v86
    v_exp_f32 v87, v87
    v_add_f32 v243, v243, v71
    s_waitcnt lgkmcnt(2)
    v_mfma_f32_32x32x16_bf16 v[0:15], a[216:219], a[152:155], v[0:15]
    buffer_load_dwordx4 v240, s[12:15], s34 offen offset:1024 lds
    v_cvt_pk_bf16_f32 v163, v70, v71
    v_exp_f32 v72, v72
    v_add_f32 v244, v244, v87
    v_cvt_pk_bf16_f32 v167, v86, v87
    v_mfma_f32_32x32x16_bf16 v[16:31], a[216:219], a[184:187], v[16:31]
    ds_read_b128 a[200:203], v226 offset:24576
    v_exp_f32 v88, v88
    v_add_f32 v243, v243, v72
    v_exp_f32 v73, v73
    v_mfma_f32_32x32x16_bf16 v[0:15], a[220:223], a[156:159], v[0:15]
    buffer_load_dwordx4 v240, s[12:15], s34 offen offset:2048 lds
    v_add_f32 v244, v244, v88
    v_exp_f32 v89, v89
    v_add_f32 v243, v243, v73
    v_cvt_pk_bf16_f32 v168, v72, v73
    v_mfma_f32_32x32x16_bf16 v[16:31], a[220:223], a[188:191], v[16:31]
    ds_read_b128 a[204:207], v227 offset:24576
    v_exp_f32 v74, v74
    v_add_f32 v244, v244, v89
    v_cvt_pk_bf16_f32 v172, v88, v89
    s_waitcnt lgkmcnt(2)
    v_mfma_f32_32x32x16_bf16 v[32:47], a[192:195], a[128:131], v[192:207]
    buffer_load_dwordx4 v240, s[12:15], s34 offen offset:3072 lds
    v_exp_f32 v90, v90
    v_add_f32 v243, v243, v74
    v_exp_f32 v75, v75
    v_mfma_f32_32x32x16_bf16 v[48:63], a[192:195], a[160:163], v[208:223]
    ds_read_b128 a[208:211], v228 offset:24576
    v_add_f32 v244, v244, v90
    v_exp_f32 v91, v91
    v_add_f32 v243, v243, v75
    v_cvt_pk_bf16_f32 v169, v74, v75
    v_mfma_f32_32x32x16_bf16 v[32:47], a[196:199], a[132:135], v[32:47]
    s_add_u32 s33, s33, 16384
    v_exp_f32 v76, v76
    v_add_f32 v244, v244, v91
    v_cvt_pk_bf16_f32 v173, v90, v91
    v_mfma_f32_32x32x16_bf16 v[48:63], a[196:199], a[164:167], v[48:63]
    ds_read_b128 a[212:215], v229 offset:24576
    s_add_u32 s34, s34, 16384
    v_exp_f32 v92, v92
    v_add_f32 v243, v243, v76
    s_waitcnt lgkmcnt(2)
    v_mfma_f32_32x32x16_bf16 v[32:47], a[200:203], a[136:139], v[32:47]
    v_exp_f32 v77, v77
    v_add_f32 v244, v244, v92
    v_exp_f32 v93, v93
    v_add_f32 v243, v243, v77
    v_mfma_f32_32x32x16_bf16 v[48:63], a[200:203], a[168:171], v[48:63]
    ds_read_b128 a[216:219], v230 offset:24576
    ds_read_b64_tr_b16 a[224:225], v232 offset:32768
    v_cvt_pk_bf16_f32 v170, v76, v77
    v_exp_f32 v78, v78
    v_add_f32 v244, v244, v93
    v_mfma_f32_32x32x16_bf16 v[32:47], a[204:207], a[140:143], v[32:47]
    ds_read_b64_tr_b16 a[226:227], v232 offset:34816
    v_cvt_pk_bf16_f32 v174, v92, v93
    v_exp_f32 v94, v94
    v_add_f32 v243, v243, v78
    v_mfma_f32_32x32x16_bf16 v[48:63], a[204:207], a[172:175], v[48:63]
    ds_read_b128 a[220:223], v231 offset:24576
    ds_read_b64_tr_b16 a[228:229], v233 offset:32768
    v_exp_f32 v79, v79
    v_add_f32 v244, v244, v94
    s_waitcnt lgkmcnt(5)
    v_mfma_f32_32x32x16_bf16 v[32:47], a[208:211], a[144:147], v[32:47]
    ds_read_b64_tr_b16 a[230:231], v233 offset:34816
    v_exp_f32 v95, v95
    v_add_f32 v243, v243, v79
    v_cvt_pk_bf16_f32 v171, v78, v79
    v_mfma_f32_32x32x16_bf16 v[48:63], a[208:211], a[176:179], v[48:63]
    ds_read_b64_tr_b16 a[232:233], v234 offset:32768
    v_exp_f32 v96, v96
    v_add_f32 v244, v244, v95
    v_cvt_pk_bf16_f32 v175, v94, v95
    v_mfma_f32_32x32x16_bf16 v[32:47], a[212:215], a[148:151], v[32:47]
    ds_read_b64_tr_b16 a[234:235], v234 offset:34816
    v_exp_f32 v112, v112
    v_add_f32 v243, v243, v96
    v_exp_f32 v97, v97
    v_mfma_f32_32x32x16_bf16 v[48:63], a[212:215], a[180:183], v[48:63]
    ds_read_b64_tr_b16 a[236:237], v235 offset:32768
    v_add_f32 v244, v244, v112
    v_exp_f32 v113, v113
    v_add_f32 v243, v243, v97
    s_waitcnt lgkmcnt(5)
    v_mfma_f32_32x32x16_bf16 v[32:47], a[216:219], a[152:155], v[32:47]
    ds_read_b64_tr_b16 a[238:239], v235 offset:34816
    v_cvt_pk_bf16_f32 v176, v96, v97
    v_exp_f32 v98, v98
    v_add_f32 v244, v244, v113
    v_cvt_pk_bf16_f32 v180, v112, v113
    v_mfma_f32_32x32x16_bf16 v[48:63], a[216:219], a[184:187], v[48:63]
    ds_read_b64_tr_b16 a[240:241], v232 offset:36864
    v_exp_f32 v114, v114
    v_add_f32 v243, v243, v98
    v_exp_f32 v99, v99
    v_mfma_f32_32x32x16_bf16 v[32:47], a[220:223], a[156:159], v[32:47]
    ds_read_b64_tr_b16 a[242:243], v232 offset:38912
    v_add_f32 v244, v244, v114
    v_exp_f32 v115, v115
    v_add_f32 v243, v243, v99
    v_cvt_pk_bf16_f32 v177, v98, v99
    v_mfma_f32_32x32x16_bf16 v[48:63], a[220:223], a[188:191], v[48:63]
    ds_read_b64_tr_b16 a[244:245], v233 offset:36864
    v_exp_f32 v100, v100
    v_add_f32 v244, v244, v115
    v_cvt_pk_bf16_f32 v181, v114, v115
    s_waitcnt lgkmcnt(7)
    v_mfma_f32_32x32x16_bf16 a[0:15], a[224:227], v[128:131], a[0:15]
    ds_read_b64_tr_b16 a[246:247], v233 offset:38912
    v_exp_f32 v116, v116
    v_add_f32 v243, v243, v100
    v_exp_f32 v101, v101
    v_mfma_f32_32x32x16_bf16 a[16:31], a[224:227], v[132:135], a[16:31]
    ds_read_b64_tr_b16 a[248:249], v234 offset:36864
    v_add_f32 v244, v244, v116
    v_exp_f32 v117, v117
    v_add_f32 v243, v243, v101
    v_cvt_pk_bf16_f32 v178, v100, v101
    v_mfma_f32_32x32x16_bf16 a[32:47], a[228:231], v[128:131], a[32:47]
    ds_read_b64_tr_b16 a[250:251], v234 offset:38912
    v_exp_f32 v102, v102
    v_add_f32 v244, v244, v117
    v_cvt_pk_bf16_f32 v182, v116, v117
    v_mfma_f32_32x32x16_bf16 a[48:63], a[228:231], v[132:135], a[48:63]
    ds_read_b64_tr_b16 a[252:253], v235 offset:36864
    v_exp_f32 v118, v118
    v_add_f32 v243, v243, v102
    s_waitcnt lgkmcnt(7)
    v_mfma_f32_32x32x16_bf16 a[64:79], a[232:235], v[128:131], a[64:79]
    ds_read_b64_tr_b16 a[254:255], v235 offset:38912
    v_exp_f32 v103, v103
    v_add_f32 v244, v244, v118
    v_exp_f32 v119, v119
    v_mfma_f32_32x32x16_bf16 a[80:95], a[232:235], v[132:135], a[80:95]
    ds_read_b64_tr_b16 a[224:225], v232 offset:40960
    v_add_f32 v243, v243, v103
    v_cvt_pk_bf16_f32 v179, v102, v103
    v_exp_f32 v104, v104
    v_add_f32 v244, v244, v119
    v_mfma_f32_32x32x16_bf16 a[96:111], a[236:239], v[128:131], a[96:111]
    ds_read_b64_tr_b16 a[226:227], v232 offset:43008
    v_cvt_pk_bf16_f32 v183, v118, v119
    v_exp_f32 v120, v120
    v_add_f32 v243, v243, v104
    v_mfma_f32_32x32x16_bf16 a[112:127], a[236:239], v[132:135], a[112:127]
    ds_read_b64_tr_b16 a[228:229], v233 offset:40960
    v_exp_f32 v105, v105
    v_add_f32 v244, v244, v120
    s_waitcnt lgkmcnt(7)
    v_mfma_f32_32x32x16_bf16 a[0:15], a[240:243], v[136:139], a[0:15]
    ds_read_b64_tr_b16 a[230:231], v233 offset:43008
    v_exp_f32 v121, v121
    v_add_f32 v243, v243, v105
    v_cvt_pk_bf16_f32 v184, v104, v105
    v_mfma_f32_32x32x16_bf16 a[16:31], a[240:243], v[140:143], a[16:31]
    ds_read_b64_tr_b16 a[232:233], v234 offset:40960
    v_exp_f32 v106, v106
    v_add_f32 v244, v244, v121
    v_cvt_pk_bf16_f32 v188, v120, v121
    v_mfma_f32_32x32x16_bf16 a[32:47], a[244:247], v[136:139], a[32:47]
    ds_read_b64_tr_b16 a[234:235], v234 offset:43008
    v_exp_f32 v122, v122
    v_add_f32 v243, v243, v106
    v_exp_f32 v107, v107
    v_mfma_f32_32x32x16_bf16 a[48:63], a[244:247], v[140:143], a[48:63]
    ds_read_b64_tr_b16 a[236:237], v235 offset:40960
    v_add_f32 v244, v244, v122
    v_exp_f32 v123, v123
    v_add_f32 v243, v243, v107
    s_waitcnt lgkmcnt(7)
    v_mfma_f32_32x32x16_bf16 a[64:79], a[248:251], v[136:139], a[64:79]
    ds_read_b64_tr_b16 a[238:239], v235 offset:43008
    v_cvt_pk_bf16_f32 v185, v106, v107
    v_exp_f32 v108, v108
    v_add_f32 v244, v244, v123
    v_cvt_pk_bf16_f32 v189, v122, v123
    v_mfma_f32_32x32x16_bf16 a[80:95], a[248:251], v[140:143], a[80:95]
    ds_read_b64_tr_b16 a[240:241], v232 offset:45056
    v_exp_f32 v124, v124
    v_add_f32 v243, v243, v108
    v_exp_f32 v109, v109
    v_mfma_f32_32x32x16_bf16 a[96:111], a[252:255], v[136:139], a[96:111]
    ds_read_b64_tr_b16 a[242:243], v232 offset:47104
    v_add_f32 v244, v244, v124
    v_exp_f32 v125, v125
    v_add_f32 v243, v243, v109
    v_cvt_pk_bf16_f32 v186, v108, v109
    v_mfma_f32_32x32x16_bf16 a[112:127], a[252:255], v[140:143], a[112:127]
    ds_read_b64_tr_b16 a[244:245], v233 offset:45056
    v_exp_f32 v110, v110
    v_add_f32 v244, v244, v125
    v_cvt_pk_bf16_f32 v190, v124, v125
    s_waitcnt lgkmcnt(7)
    v_mfma_f32_32x32x16_bf16 a[0:15], a[224:227], v[144:147], a[0:15]
    ds_read_b64_tr_b16 a[246:247], v233 offset:47104
    v_exp_f32 v126, v126
    v_add_f32 v243, v243, v110
    v_exp_f32 v111, v111
    v_mfma_f32_32x32x16_bf16 a[16:31], a[224:227], v[148:151], a[16:31]
    ds_read_b64_tr_b16 a[248:249], v234 offset:45056
    v_add_f32 v244, v244, v126
    v_exp_f32 v127, v127
    v_add_f32 v243, v243, v111
    v_cvt_pk_bf16_f32 v187, v110, v111
    v_mfma_f32_32x32x16_bf16 a[32:47], a[228:231], v[144:147], a[32:47]
    ds_read_b64_tr_b16 a[250:251], v234 offset:47104
    v_add_f32 v244, v244, v127
    v_cvt_pk_bf16_f32 v191, v126, v127
    v_max_f32 v246, v243, v244
    v_cmp_lt_f32 vcc, s43, v246
    v_mfma_f32_32x32x16_bf16 a[48:63], a[228:231], v[148:151], a[48:63]
    ds_read_b64_tr_b16 a[252:253], v235 offset:45056
    s_waitcnt lgkmcnt(7)
    v_mfma_f32_32x32x16_bf16 a[64:79], a[232:235], v[144:147], a[64:79]
    ds_read_b64_tr_b16 a[254:255], v235 offset:47104
    v_mfma_f32_32x32x16_bf16 a[80:95], a[232:235], v[148:151], a[80:95]
    v_mfma_f32_32x32x16_bf16 a[96:111], a[236:239], v[144:147], a[96:111]
    v_mfma_f32_32x32x16_bf16 a[112:127], a[236:239], v[148:151], a[112:127]
    s_waitcnt lgkmcnt(4)
    v_mfma_f32_32x32x16_bf16 a[0:15], a[240:243], v[152:155], a[0:15]
    s_waitcnt vmcnt(8) lgkmcnt(0)
    s_barrier
    v_mfma_f32_32x32x16_bf16 a[16:31], a[240:243], v[156:159], a[16:31]
    ds_read_b128 a[192:195], v224 offset:32768
    v_mfma_f32_32x32x16_bf16 a[32:47], a[244:247], v[152:155], a[32:47]
    ds_read_b128 a[196:199], v225 offset:32768
    v_mfma_f32_32x32x16_bf16 a[48:63], a[244:247], v[156:159], a[48:63]
    ds_read_b128 a[200:203], v226 offset:32768
    v_mfma_f32_32x32x16_bf16 a[64:79], a[248:251], v[152:155], a[64:79]
    ds_read_b128 a[204:207], v227 offset:32768
    v_mfma_f32_32x32x16_bf16 a[80:95], a[248:251], v[156:159], a[80:95]
    v_mfma_f32_32x32x16_bf16 a[96:111], a[252:255], v[152:155], a[96:111]
    v_mfma_f32_32x32x16_bf16 a[112:127], a[252:255], v[156:159], a[112:127]
    s_cbranch_vccnz L_rare2
L_ret2:
    v_add_f32 v241, v241, v243
    v_add_f32 v242, v242, v244
    s_add_u32 s35, s35, 16384
    s_waitcnt lgkmcnt(2)
    v_mfma_f32_32x32x16_bf16 v[64:79], a[192:195], a[128:131], v[192:207]
    v_exp_f32 v0, v0
    v_exp_f32 v16, v16
    v_exp_f32 v1, v1
    v_mfma_f32_32x32x16_bf16 v[80:95], a[192:195], a[160:163], v[208:223]
    ds_read_b128 a[208:211], v228 offset:32768
    s_mov_b32 m0, s37
    v_exp_f32 v17, v17
    v_add_f32 v243, v0, v1
    v_cvt_pk_bf16_f32 v128, v0, v1
    v_mfma_f32_32x32x16_bf16 v[64:79], a[196:199], a[132:135], v[64:79]
    buffer_load_dwordx4 v236, s[8:11], s33 offen lds
    v_exp_f32 v2, v2
    v_add_f32 v244, v16, v17
    v_cvt_pk_bf16_f32 v132, v16, v17
    v_mfma_f32_32x32x16_bf16 v[80:95], a[196:199], a[164:167], v[80:95]
    ds_read_b128 a[212:215], v229 offset:32768
    v_exp_f32 v18, v18
    v_add_f32 v243, v243, v2
    s_waitcnt lgkmcnt(2)
    v_mfma_f32_32x32x16_bf16 v[64:79], a[200:203], a[136:139], v[64:79]
    buffer_load_dwordx4 v237, s[8:11], s33 offen offset:1024 lds
    v_exp_f32 v3, v3
    v_add_f32 v244, v244, v18
    v_exp_f32 v19, v19
    v_mfma_f32_32x32x16_bf16 v[80:95], a[200:203], a[168:171], v[80:95]
    ds_read_b128 a[216:219], v230 offset:32768
    v_add_f32 v243, v243, v3
    v_cvt_pk_bf16_f32 v129, v2, v3
    v_exp_f32 v4, v4
    v_add_f32 v244, v244, v19
    v_mfma_f32_32x32x16_bf16 v[64:79], a[204:207], a[140:143], v[64:79]
    buffer_load_dwordx4 v238, s[8:11], s33 offen offset:2048 lds
    v_cvt_pk_bf16_f32 v133, v18, v19
    v_exp_f32 v20, v20
    v_add_f32 v243, v243, v4
    v_mfma_f32_32x32x16_bf16 v[80:95], a[204:207], a[172:175], v[80:95]
    ds_read_b128 a[220:223], v231 offset:32768
    v_exp_f32 v5, v5
    v_add_f32 v244, v244, v20
    s_waitcnt lgkmcnt(2)
    v_mfma_f32_32x32x16_bf16 v[64:79], a[208:211], a[144:147], v[64:79]
    buffer_load_dwordx4 v239, s[8:11], s33 offen offset:3072 lds
    v_exp_f32 v21, v21
    v_add_f32 v243, v243, v5
    v_cvt_pk_bf16_f32 v130, v4, v5
    v_mfma_f32_32x32x16_bf16 v[80:95], a[208:211], a[176:179], v[80:95]
    ds_read_b128 a[192:195], v224 offset:40960
    s_mov_b32 m0, s41
    v_exp_f32 v6, v6
    v_add_f32 v244, v244, v21
    v_cvt_pk_bf16_f32 v134, v20, v21
    v_mfma_f32_32x32x16_bf16 v[64:79], a[212:215], a[148:151], v[64:79]
    buffer_load_dwordx4 v240, s[12:15], s34 offen lds
    v_exp_f32 v22, v22
    v_add_f32 v243, v243, v6
    v_exp_f32 v7, v7
    v_mfma_f32_32x32x16_bf16 v[80:95], a[212:215], a[180:183], v[80:95]
    ds_read_b128 a[196:199], v225 offset:40960
    v_add_f32 v244, v244, v22
    v_exp_f32 v23, v23
    v_add_f32 v243, v243, v7
    s_waitcnt lgkmcnt(2)
    v_mfma_f32_32x32x16_bf16 v[64:79], a[216:219], a[152:155], v[64:79]
    buffer_load_dwordx4 v240, s[12:15], s34 offen offset:1024 lds
    v_cvt_pk_bf16_f32 v131, v6, v7
    v_exp_f32 v8, v8
    v_add_f32 v244, v244, v23
    v_cvt_pk_bf16_f32 v135, v22, v23
    v_mfma_f32_32x32x16_bf16 v[80:95], a[216:219], a[184:187], v[80:95]
    ds_read_b128 a[200:203], v226 offset:40960
    v_exp_f32 v24, v24
    v_add_f32 v243, v243, v8
    v_exp_f32 v9, v9
    v_mfma_f32_32x32x16_bf16 v[64:79], a[220:223], a[156:159], v[64:79]
    buffer_load_dwordx4 v240, s[12:15], s34 offen offset:2048 lds
    v_add_f32 v244, v244, v24
    v_exp_f32 v25, v25
    v_add_f32 v243, v243, v9
    v_cvt_pk_bf16_f32 v136, v8, v9
    v_mfma_f32_32x32x16_bf16 v[80:95], a[220:223], a[188:191], v[80:95]
    ds_read_b128 a[204:207], v227 offset:40960
    v_exp_f32 v10, v10
    v_add_f32 v244, v244, v25
    v_cvt_pk_bf16_f32 v140, v24, v25
    s_waitcnt lgkmcnt(2)
    v_mfma_f32_32x32x16_bf16 v[96:111], a[192:195], a[128:131], v[192:207]
    buffer_load_dwordx4 v240, s[12:15], s34 offen offset:3072 lds
    v_exp_f32 v26, v26
    v_add_f32 v243, v243, v10
    v_exp_f32 v11, v11
    v_mfma_f32_32x32x16_bf16 v[112:127], a[192:195], a[160:163], v[208:223]
    ds_read_b128 a[208:211], v228 offset:40960
    v_add_f32 v244, v244, v26
    v_exp_f32 v27, v27
    v_add_f32 v243, v243, v11
    v_cvt_pk_bf16_f32 v137, v10, v11
    v_mfma_f32_32x32x16_bf16 v[96:111], a[196:199], a[132:135], v[96:111]
    s_add_u32 s33, s33, 16384
    v_exp_f32 v12, v12
    v_add_f32 v244, v244, v27
    v_cvt_pk_bf16_f32 v141, v26, v27
    v_mfma_f32_32x32x16_bf16 v[112:127], a[196:199], a[164:167], v[112:127]
    ds_read_b128 a[212:215], v229 offset:40960
    s_add_u32 s34, s34, 16384
    v_exp_f32 v28, v28
    v_add_f32 v243, v243, v12
    s_waitcnt lgkmcnt(2)
    v_mfma_f32_32x32x16_bf16 v[96:111], a[200:203], a[136:139], v[96:111]
    v_exp_f32 v13, v13
    v_add_f32 v244, v244, v28
    v_exp_f32 v29, v29
    v_add_f32 v243, v243, v13
    v_mfma_f32_32x32x16_bf16 v[112:127], a[200:203], a[168:171], v[112:127]
    ds_read_b128 a[216:219], v230 offset:40960
    ds_read_b64_tr_b16 a[224:225], v232 offset:0
    v_cvt_pk_bf16_f32 v138, v12, v13
    v_exp_f32 v14, v14
    v_add_f32 v244, v244, v29
    v_mfma_f32_32x32x16_bf16 v[96:111], a[204:207], a[140:143], v[96:111]
    ds_read_b64_tr_b16 a[226:227], v232 offset:2048
    v_cvt_pk_bf16_f32 v142, v28, v29
    v_exp_f32 v30, v30
    v_add_f32 v243, v243, v14
    v_mfma_f32_32x32x16_bf16 v[112:127], a[204:207], a[172:175], v[112:127]
    ds_read_b128 a[220:223], v231 offset:40960
    ds_read_b64_tr_b16 a[228:229], v233 offset:0
    v_exp_f32 v15, v15
    v_add_f32 v244, v244, v30
    s_waitcnt lgkmcnt(5)
    v_mfma_f32_32x32x16_bf16 v[96:111], a[208:211], a[144:147], v[96:111]
    ds_read_b64_tr_b16 a[230:231], v233 offset:2048
    v_exp_f32 v31, v31
    v_add_f32 v243, v243, v15
    v_cvt_pk_bf16_f32 v139, v14, v15
    v_mfma_f32_32x32x16_bf16 v[112:127], a[208:211], a[176:179], v[112:127]
    ds_read_b64_tr_b16 a[232:233], v234 offset:0
    v_exp_f32 v32, v32
    v_add_f32 v244, v244, v31
    v_cvt_pk_bf16_f32 v143, v30, v31
    v_mfma_f32_32x32x16_bf16 v[96:111], a[212:215], a[148:151], v[96:111]
    ds_read_b64_tr_b16 a[234:235], v234 offset:2048
    v_exp_f32 v48, v48
    v_add_f32 v243, v243, v32
    v_exp_f32 v33, v33
    v_mfma_f32_32x32x16_bf16 v[112:127], a[212:215], a[180:183], v[112:127]
    ds_read_b64_tr_b16 a[236:237], v235 offset:0
    v_add_f32 v244, v244, v48
    v_exp_f32 v49, v49
    v_add_f32 v243, v243, v33
    s_waitcnt lgkmcnt(5)
    v_mfma_f32_32x32x16_bf16 v[96:111], a[216:219], a[152:155], v[96:111]
    ds_read_b64_tr_b16 a[238:239], v235 offset:2048
    v_cvt_pk_bf16_f32 v144, v32, v33
    v_exp_f32 v34, v34
    v_add_f32 v244, v244, v49
    v_cvt_pk_bf16_f32 v148, v48, v49
    v_mfma_f32_32x32x16_bf16 v[112:127], a[216:219], a[184:187], v[112:127]
    ds_read_b64_tr_b16 a[240:241], v232 offset:4096
    v_exp_f32 v50, v50
    v_add_f32 v243, v243, v34
    v_exp_f32 v35, v35
    v_mfma_f32_32x32x16_bf16 v[96:111], a[220:223], a[156:159], v[96:111]
    ds_read_b64_tr_b16 a[242:243], v232 offset:6144
    v_add_f32 v244, v244, v50
    v_exp_f32 v51, v51
    v_add_f32 v243, v243, v35
    v_cvt_pk_bf16_f32 v145, v34, v35
    v_mfma_f32_32x32x16_bf16 v[112:127], a[220:223], a[188:191], v[112:127]
    ds_read_b64_tr_b16 a[244:245], v233 offset:4096
    v_exp_f32 v36, v36
    v_add_f32 v244, v244, v51
    v_cvt_pk_bf16_f32 v149, v50, v51
    s_waitcnt lgkmcnt(7)
    v_mfma_f32_32x32x16_bf16 a[0:15], a[224:227], v[160:163], a[0:15]
    ds_read_b64_tr_b16 a[246:247], v233 offset:6144
    v_exp_f32 v52, v52
    v_add_f32 v243, v243, v36
    v_exp_f32 v37, v37
    v_mfma_f32_32x32x16_bf16 a[16:31], a[224:227], v[164:167], a[16:31]
    ds_read_b64_tr_b16 a[248:249], v234 offset:4096
    v_add_f32 v244, v244, v52
    v_exp_f32 v53, v53
    v_add_f32 v243, v243, v37
    v_cvt_pk_bf16_f32 v146, v36, v37
    v_mfma_f32_32x32x16_bf16 a[32:47], a[228:231], v[160:163], a[32:47]
    ds_read_b64_tr_b16 a[250:251], v234 offset:6144
    v_exp_f32 v38, v38
    v_add_f32 v244, v244, v53
    v_cvt_pk_bf16_f32 v150, v52, v53
    v_mfma_f32_32x32x16_bf16 a[48:63], a[228:231], v[164:167], a[48:63]
    ds_read_b64_tr_b16 a[252:253], v235 offset:4096
    v_exp_f32 v54, v54
    v_add_f32 v243, v243, v38
    s_waitcnt lgkmcnt(7)
    v_mfma_f32_32x32x16_bf16 a[64:79], a[232:235], v[160:163], a[64:79]
    ds_read_b64_tr_b16 a[254:255], v235 offset:6144
    v_exp_f32 v39, v39
    v_add_f32 v244, v244, v54
    v_exp_f32 v55, v55
    v_mfma_f32_32x32x16_bf16 a[80:95], a[232:235], v[164:167], a[80:95]
    ds_read_b64_tr_b16 a[224:225], v232 offset:8192
    v_add_f32 v243, v243, v39
    v_cvt_pk_bf16_f32 v147, v38, v39
    v_exp_f32 v40, v40
    v_add_f32 v244, v244, v55
    v_mfma_f32_32x32x16_bf16 a[96:111], a[236:239], v[160:163], a[96:111]
    ds_read_b64_tr_b16 a[226:227], v232 offset:10240
    v_cvt_pk_bf16_f32 v151, v54, v55
    v_exp_f32 v56, v56
    v_add_f32 v243, v243, v40
    v_mfma_f32_32x32x16_bf16 a[112:127], a[236:239], v[164:167], a[112:127]
    ds_read_b64_tr_b16 a[228:229], v233 offset:8192
    v_exp_f32 v41, v41
    v_add_f32 v244, v244, v56
    s_waitcnt lgkmcnt(7)
    v_mfma_f32_32x32x16_bf16 a[0:15], a[240:243], v[168:171], a[0:15]
    ds_read_b64_tr_b16 a[230:231], v233 offset:10240
    v_exp_f32 v57, v57
    v_add_f32 v243, v243, v41
    v_cvt_pk_bf16_f32 v152, v40, v41
    v_mfma_f32_32x32x16_bf16 a[16:31], a[240:243], v[172:175], a[16:31]
    ds_read_b64_tr_b16 a[232:233], v234 offset:8192
    v_exp_f32 v42, v42
    v_add_f32 v244, v244, v57
    v_cvt_pk_bf16_f32 v156, v56, v57
    v_mfma_f32_32x32x16_bf16 a[32:47], a[244:247], v[168:171], a[32:47]
    ds_read_b64_tr_b16 a[234:235], v234 offset:10240
    v_exp_f32 v58, v58
    v_add_f32 v243, v243, v42
    v_exp_f32 v43, v43
    v_mfma_f32_32x32x16_bf16 a[48:63], a[244:247], v[172:175], a[48:63]
    ds_read_b64_tr_b16 a[236:237], v235 offset:8192
    v_add_f32 v244, v244, v58
    v_exp_f32 v59, v59
    v_add_f32 v243, v243, v43
    s_waitcnt lgkmcnt(7)
    v_mfma_f32_32x32x16_bf16 a[64:79], a[248:251], v[168:171], a[64:79]
    ds_read_b64_tr_b16 a[238:239], v235 offset:10240
    v_cvt_pk_bf16_f32 v153, v42, v43
    v_exp_f32 v44, v44
    v_add_f32 v244, v244, v59
    v_cvt_pk_bf16_f32 v157, v58, v59
    v_mfma_f32_32x32x16_bf16 a[80:95], a[248:251], v[172:175], a[80:95]
    ds_read_b64_tr_b16 a[240:241], v232 offset:12288
    v_exp_f32 v60, v60
    v_add_f32 v243, v243, v44
    v_exp_f32 v45, v45
    v_mfma_f32_32x32x16_bf16 a[96:111], a[252:255], v[168:171], a[96:111]
    ds_read_b64_tr_b16 a[242:243], v232 offset:14336
    v_add_f32 v244, v244, v60
    v_exp_f32 v61, v61
    v_add_f32 v243, v243, v45
    v_cvt_pk_bf16_f32 v154, v44, v45
    v_mfma_f32_32x32x16_bf16 a[112:127], a[252:255], v[172:175], a[112:127]
    ds_read_b64_tr_b16 a[244:245], v233 offset:12288
    v_exp_f32 v46, v46
    v_add_f32 v244, v244, v61
    v_cvt_pk_bf16_f32 v158, v60, v61
    s_waitcnt lgkmcnt(7)
    v_mfma_f32_32x32x16_bf16 a[0:15], a[224:227], v[176:179], a[0:15]
    ds_read_b64_tr_b16 a[246:247], v233 offset:14336
    v_exp_f32 v62, v62
    v_add_f32 v243, v243, v46
    v_exp_f32 v47, v47
    v_mfma_f32_32x32x16_bf16 a[16:31], a[224:227], v[180:183], a[16:31]
    ds_read_b64_tr_b16 a[248:249], v234 offset:12288
    v_add_f32 v244, v244, v62
    v_exp_f32 v63, v63
    v_add_f32 v243, v243, v47
    v_cvt_pk_bf16_f32 v155, v46, v47
    v_mfma_f32_32x32x16_bf16 a[32:47], a[228:231], v[176:179], a[32:47]
    ds_read_b64_tr_b16 a[250:251], v234 offset:14336
    v_add_f32 v244, v244, v63
    v_cvt_pk_bf16_f32 v159, v62, v63
    v_max_f32 v246, v243, v244
    v_cmp_lt_f32 vcc, s43, v246
    v_mfma_f32_32x32x16_bf16 a[48:63], a[228:231], v[180:183], a[48:63]
    ds_read_b64_tr_b16 a[252:253], v235 offset:12288
    s_waitcnt lgkmcnt(7)
    v_mfma_f32_32x32x16_bf16 a[64:79], a[232:235], v[176:179], a[64:79]
    ds_read_b64_tr_b16 a[254:255], v235 offset:14336
    v_mfma_f32_32x32x16_bf16 a[80:95], a[232:235], v[180:183], a[80:95]
    v_mfma_f32_32x32x16_bf16 a[96:111], a[236:239], v[176:179], a[96:111]
    v_mfma_f32_32x32x16_bf16 a[112:127], a[236:239], v[180:183], a[112:127]
    s_waitcnt lgkmcnt(4)
    v_mfma_f32_32x32x16_bf16 a[0:15], a[240:243], v[184:187], a[0:15]
    s_waitcnt vmcnt(8) lgkmcnt(0)
    s_barrier
    v_mfma_f32_32x32x16_bf16 a[16:31], a[240:243], v[188:191], a[16:31]
    ds_read_b128 a[192:195], v224 offset:0
    v_mfma_f32_32x32x16_bf16 a[32:47], a[244:247], v[184:187], a[32:47]
    ds_read_b128 a[196:199], v225 offset:0
    v_mfma_f32_32x32x16_bf16 a[48:63], a[244:247], v[188:191], a[48:63]
    ds_read_b128 a[200:203], v226 offset:0
    v_mfma_f32_32x32x16_bf16 a[64:79], a[248:251], v[184:187], a[64:79]
    ds_read_b128 a[204:207], v227 offset:0
    v_mfma_f32_32x32x16_bf16 a[80:95], a[248:251], v[188:191], a[80:95]
    v_mfma_f32_32x32x16_bf16 a[96:111], a[252:255], v[184:187], a[96:111]
    v_mfma_f32_32x32x16_bf16 a[112:127], a[252:255], v[188:191], a[112:127]
    s_cbranch_vccnz L_rare3
L_ret3:
    v_add_f32 v241, v241, v243
    v_add_f32 v242, v242, v244
    s_add_u32 s35, s35, 16384
    s_waitcnt lgkmcnt(2)
    v_mfma_f32_32x32x16_bf16 v[0:15], a[192:195], a[128:131], v[192:207]
    v_exp_f32 v64, v64
    v_exp_f32 v80, v80
    v_exp_f32 v65, v65
    v_mfma_f32_32x32x16_bf16 v[16:31], a[192:195], a[160:163], v[208:223]
    ds_read_b128 a[208:211], v228 offset:0
    s_mov_b32 m0, s38
    v_exp_f32 v81, v81
    v_add_f32 v243, v64, v65
    v_cvt_pk_bf16_f32 v160, v64, v65
    v_mfma_f32_32x32x16_bf16 v[0:15], a[196:199], a[132:135], v[0:15]
    buffer_load_dwordx4 v236, s[8:11], s33 offen lds
    v_exp_f32 v66, v66
    v_add_f32 v244, v80, v81
    v_cvt_pk_bf16_f32 v164, v80, v81
    v_mfma_f32_32x32x16_bf16 v[16:31], a[196:199], a[164:167], v[16:31]
    ds_read_b128 a[212:215], v229 offset:0
    v_exp_f32 v82, v82
    v_add_f32 v243, v243, v66
    s_waitcnt lgkmcnt(2)
    v_mfma_f32_32x32x16_bf16 v[0:15], a[200:203], a[136:139], v[0:15]
    buffer_load_dwordx4 v237, s[8:11], s33 offen offset:1024 lds
    v_exp_f32 v67, v67
    v_add_f32 v244, v244, v82
    v_exp_f32 v83, v83
    v_mfma_f32_32x32x16_bf16 v[16:31], a[200:203], a[168:171], v[16:31]
    ds_read_b128 a[216:219], v230 offset:0
    v_add_f32 v243, v243, v67
    v_cvt_pk_bf16_f32 v161, v66, v67
    v_exp_f32 v68, v68
    v_add_f32 v244, v244, v83
    v_mfma_f32_32x32x16_bf16 v[0:15], a[204:207], a[140:143], v[0:15]
    buffer_load_dwordx4 v238, s[8:11], s33 offen offset:2048 lds
    v_cvt_pk_bf16_f32 v165, v82, v83
    v_exp_f32 v84, v84
    v_add_f32 v243, v243, v68
    v_mfma_f32_32x32x16_bf16 v[16:31], a[204:207], a[172:175], v[16:31]
    ds_read_b128 a[220:223], v231 offset:0
    v_exp_f32 v69, v69
    v_add_f32 v244, v244, v84
    s_waitcnt lgkmcnt(2)
    v_mfma_f32_32x32x16_bf16 v[0:15], a[208:211], a[144:147], v[0:15]
    buffer_load_dwordx4 v239, s[8:11], s33 offen offset:3072 lds
    v_exp_f32 v85, v85
    v_add_f32 v243, v243, v69
    v_cvt_pk_bf16_f32 v162, v68, v69
    v_mfma_f32_32x32x16_bf16 v[16:31], a[208:211], a[176:179], v[16:31]
    ds_read_b128 a[192:195], v224 offset:8192
    s_mov_b32 m0, s39
    v_exp_f32 v70, v70
    v_add_f32 v244, v244, v85
    v_cvt_pk_bf16_f32 v166, v84, v85
    v_mfma_f32_32x32x16_bf16 v[0:15], a[212:215], a[148:151], v[0:15]
    buffer_load_dwordx4 v240, s[12:15], s34 offen lds
    v_exp_f32 v86, v86
    v_add_f32 v243, v243, v70
    v_exp_f32 v71, v71
    v_mfma_f32_32x32x16_bf16 v[16:31], a[212:215], a[180:183], v[16:31]
    ds_read_b128 a[196:199], v225 offset:8192
    v_add_f32 v244, v244, v86
    v_exp_f32 v87, v87
    v_add_f32 v243, v243, v71
    s_waitcnt lgkmcnt(2)
    v_mfma_f32_32x32x16_bf16 v[0:15], a[216:219], a[152:155], v[0:15]
    buffer_load_dwordx4 v240, s[12:15], s34 offen offset:1024 lds
    v_cvt_pk_bf16_f32 v163, v70, v71
    v_exp_f32 v72, v72
    v_add_f32 v244, v244, v87
    v_cvt_pk_bf16_f32 v167, v86, v87
    v_mfma_f32_32x32x16_bf16 v[16:31], a[216:219], a[184:187], v[16:31]
    ds_read_b128 a[200:203], v226 offset:8192
    v_exp_f32 v88, v88
    v_add_f32 v243, v243, v72
    v_exp_f32 v73, v73
    v_mfma_f32_32x32x16_bf16 v[0:15], a[220:223], a[156:159], v[0:15]
    buffer_load_dwordx4 v240, s[12:15], s34 offen offset:2048 lds
    v_add_f32 v244, v244, v88
    v_exp_f32 v89, v89
    v_add_f32 v243, v243, v73
    v_cvt_pk_bf16_f32 v168, v72, v73
    v_mfma_f32_32x32x16_bf16 v[16:31], a[220:223], a[188:191], v[16:31]
    ds_read_b128 a[204:207], v227 offset:8192
    v_exp_f32 v74, v74
    v_add_f32 v244, v244, v89
    v_cvt_pk_bf16_f32 v172, v88, v89
    s_waitcnt lgkmcnt(2)
    v_mfma_f32_32x32x16_bf16 v[32:47], a[192:195], a[128:131], v[192:207]
    buffer_load_dwordx4 v240, s[12:15], s34 offen offset:3072 lds
    v_exp_f32 v90, v90
    v_add_f32 v243, v243, v74
    v_exp_f32 v75, v75
    v_mfma_f32_32x32x16_bf16 v[48:63], a[192:195], a[160:163], v[208:223]
    ds_read_b128 a[208:211], v228 offset:8192
    v_add_f32 v244, v244, v90
    v_exp_f32 v91, v91
    v_add_f32 v243, v243, v75
    v_cvt_pk_bf16_f32 v169, v74, v75
    v_mfma_f32_32x32x16_bf16 v[32:47], a[196:199], a[132:135], v[32:47]
    s_add_u32 s33, s33, 16384
    v_exp_f32 v76, v76
    v_add_f32 v244, v244, v91
    v_cvt_pk_bf16_f32 v173, v90, v91
    v_mfma_f32_32x32x16_bf16 v[48:63], a[196:199], a[164:167], v[48:63]
    ds_read_b128 a[212:215], v229 offset:8192
    s_add_u32 s34, s34, 16384
    v_exp_f32 v92, v92
    v_add_f32 v243, v243, v76
    s_waitcnt lgkmcnt(2)
    v_mfma_f32_32x32x16_bf16 v[32:47], a[200:203], a[136:139], v[32:47]
    v_exp_f32 v77, v77
    v_add_f32 v244, v244, v92
    v_exp_f32 v93, v93
    v_add_f32 v243, v243, v77
    v_mfma_f32_32x32x16_bf16 v[48:63], a[200:203], a[168:171], v[48:63]
    ds_read_b128 a[216:219], v230 offset:8192
    ds_read_b64_tr_b16 a[224:225], v232 offset:16384
    v_cvt_pk_bf16_f32 v170, v76, v77
    v_exp_f32 v78, v78
    v_add_f32 v244, v244, v93
    v_mfma_f32_32x32x16_bf16 v[32:47], a[204:207], a[140:143], v[32:47]
    ds_read_b64_tr_b16 a[226:227], v232 offset:18432
    v_cvt_pk_bf16_f32 v174, v92, v93
    v_exp_f32 v94, v94
    v_add_f32 v243, v243, v78
    v_mfma_f32_32x32x16_bf16 v[48:63], a[204:207], a[172:175], v[48:63]
    ds_read_b128 a[220:223], v231 offset:8192
    ds_read_b64_tr_b16 a[228:229], v233 offset:16384
    v_exp_f32 v79, v79
    v_add_f32 v244, v244, v94
    s_waitcnt lgkmcnt(5)
    v_mfma_f32_32x32x16_bf16 v[32:47], a[208:211], a[144:147], v[32:47]
    ds_read_b64_tr_b16 a[230:231], v233 offset:18432
    v_exp_f32 v95, v95
    v_add_f32 v243, v243, v79
    v_cvt_pk_bf16_f32 v171, v78, v79
    v_mfma_f32_32x32x16_bf16 v[48:63], a[208:211], a[176:179], v[48:63]
    ds_read_b64_tr_b16 a[232:233], v234 offset:16384
    v_exp_f32 v96, v96
    v_add_f32 v244, v244, v95
    v_cvt_pk_bf16_f32 v175, v94, v95
    v_mfma_f32_32x32x16_bf16 v[32:47], a[212:215], a[148:151], v[32:47]
    ds_read_b64_tr_b16 a[234:235], v234 offset:18432
    v_exp_f32 v112, v112
    v_add_f32 v243, v243, v96
    v_exp_f32 v97, v97
    v_mfma_f32_32x32x16_bf16 v[48:63], a[212:215], a[180:183], v[48:63]
    ds_read_b64_tr_b16 a[236:237], v235 offset:16384
    v_add_f32 v244, v244, v112
    v_exp_f32 v113, v113
    v_add_f32 v243, v243, v97
    s_waitcnt lgkmcnt(5)
    v_mfma_f32_32x32x16_bf16 v[32:47], a[216:219], a[152:155], v[32:47]
    ds_read_b64_tr_b16 a[238:239], v235 offset:18432
    v_cvt_pk_bf16_f32 v176, v96, v97
    v_exp_f32 v98, v98
    v_add_f32 v244, v244, v113
    v_cvt_pk_bf16_f32 v180, v112, v113
    v_mfma_f32_32x32x16_bf16 v[48:63], a[216:219], a[184:187], v[48:63]
    ds_read_b64_tr_b16 a[240:241], v232 offset:20480
    v_exp_f32 v114, v114
    v_add_f32 v243, v243, v98
    v_exp_f32 v99, v99
    v_mfma_f32_32x32x16_bf16 v[32:47], a[220:223], a[156:159], v[32:47]
    ds_read_b64_tr_b16 a[242:243], v232 offset:22528
    v_add_f32 v244, v244, v114
    v_exp_f32 v115, v115
    v_add_f32 v243, v243, v99
    v_cvt_pk_bf16_f32 v177, v98, v99
    v_mfma_f32_32x32x16_bf16 v[48:63], a[220:223], a[188:191], v[48:63]
    ds_read_b64_tr_b16 a[244:245], v233 offset:20480
    v_exp_f32 v100, v100
    v_add_f32 v244, v244, v115
    v_cvt_pk_bf16_f32 v181, v114, v115
    s_waitcnt lgkmcnt(7)
    v_mfma_f32_32x32x16_bf16 a[0:15], a[224:227], v[128:131], a[0:15]
    ds_read_b64_tr_b16 a[246:247], v233 offset:22528
    v_exp_f32 v116, v116
    v_add_f32 v243, v243, v100
    v_exp_f32 v101, v101
    v_mfma_f32_32x32x16_bf16 a[16:31], a[224:227], v[132:135], a[16:31]
    ds_read_b64_tr_b16 a[248:249], v234 offset:20480
    v_add_f32 v244, v244, v116
    v_exp_f32 v117, v117
    v_add_f32 v243, v243, v101
    v_cvt_pk_bf16_f32 v178, v100, v101
    v_mfma_f32_32x32x16_bf16 a[32:47], a[228:231], v[128:131], a[32:47]
    ds_read_b64_tr_b16 a[250:251], v234 offset:22528
    v_exp_f32 v102, v102
    v_add_f32 v244, v244, v117
    v_cvt_pk_bf16_f32 v182, v116, v117
    v_mfma_f32_32x32x16_bf16 a[48:63], a[228:231], v[132:135], a[48:63]
    ds_read_b64_tr_b16 a[252:253], v235 offset:20480
    v_exp_f32 v118, v118
    v_add_f32 v243, v243, v102
    s_waitcnt lgkmcnt(7)
    v_mfma_f32_32x32x16_bf16 a[64:79], a[232:235], v[128:131], a[64:79]
    ds_read_b64_tr_b16 a[254:255], v235 offset:22528
    v_exp_f32 v103, v103
    v_add_f32 v244, v244, v118
    v_exp_f32 v119, v119
    v_mfma_f32_32x32x16_bf16 a[80:95], a[232:235], v[132:135], a[80:95]
    ds_read_b64_tr_b16 a[224:225], v232 offset:24576
    v_add_f32 v243, v243, v103
    v_cvt_pk_bf16_f32 v179, v102, v103
    v_exp_f32 v104, v104
    v_add_f32 v244, v244, v119
    v_mfma_f32_32x32x16_bf16 a[96:111], a[236:239], v[128:131], a[96:111]
    ds_read_b64_tr_b16 a[226:227], v232 offset:26624
    v_cvt_pk_bf16_f32 v183, v118, v119
    v_exp_f32 v120, v120
    v_add_f32 v243, v243, v104
    v_mfma_f32_32x32x16_bf16 a[112:127], a[236:239], v[132:135], a[112:127]
    ds_read_b64_tr_b16 a[228:229], v233 offset:24576
    v_exp_f32 v105, v105
    v_add_f32 v244, v244, v120
    s_waitcnt lgkmcnt(7)
    v_mfma_f32_32x32x16_bf16 a[0:15], a[240:243], v[136:139], a[0:15]
    ds_read_b64_tr_b16 a[230:231], v233 offset:26624
    v_exp_f32 v121, v121
    v_add_f32 v243, v243, v105
    v_cvt_pk_bf16_f32 v184, v104, v105
    v_mfma_f32_32x32x16_bf16 a[16:31], a[240:243], v[140:143], a[16:31]
    ds_read_b64_tr_b16 a[232:233], v234 offset:24576
    v_exp_f32 v106, v106
    v_add_f32 v244, v244, v121
    v_cvt_pk_bf16_f32 v188, v120, v121
    v_mfma_f32_32x32x16_bf16 a[32:47], a[244:247], v[136:139], a[32:47]
    ds_read_b64_tr_b16 a[234:235], v234 offset:26624
    v_exp_f32 v122, v122
    v_add_f32 v243, v243, v106
    v_exp_f32 v107, v107
    v_mfma_f32_32x32x16_bf16 a[48:63], a[244:247], v[140:143], a[48:63]
    ds_read_b64_tr_b16 a[236:237], v235 offset:24576
    v_add_f32 v244, v244, v122
    v_exp_f32 v123, v123
    v_add_f32 v243, v243, v107
    s_waitcnt lgkmcnt(7)
    v_mfma_f32_32x32x16_bf16 a[64:79], a[248:251], v[136:139], a[64:79]
    ds_read_b64_tr_b16 a[238:239], v235 offset:26624
    v_cvt_pk_bf16_f32 v185, v106, v107
    v_exp_f32 v108, v108
    v_add_f32 v244, v244, v123
    v_cvt_pk_bf16_f32 v189, v122, v123
    v_mfma_f32_32x32x16_bf16 a[80:95], a[248:251], v[140:143], a[80:95]
    ds_read_b64_tr_b16 a[240:241], v232 offset:28672
    v_exp_f32 v124, v124
    v_add_f32 v243, v243, v108
    v_exp_f32 v109, v109
    v_mfma_f32_32x32x16_bf16 a[96:111], a[252:255], v[136:139], a[96:111]
    ds_read_b64_tr_b16 a[242:243], v232 offset:30720
    v_add_f32 v244, v244, v124
    v_exp_f32 v125, v125
    v_add_f32 v243, v243, v109
    v_cvt_pk_bf16_f32 v186, v108, v109
    v_mfma_f32_32x32x16_bf16 a[112:127], a[252:255], v[140:143], a[112:127]
    ds_read_b64_tr_b16 a[244:245], v233 offset:28672
    v_exp_f32 v110, v110
    v_add_f32 v244, v244, v125
    v_cvt_pk_bf16_f32 v190, v124, v125
    s_waitcnt lgkmcnt(7)
    v_mfma_f32_32x32x16_bf16 a[0:15], a[224:227], v[144:147], a[0:15]
    ds_read_b64_tr_b16 a[246:247], v233 offset:30720
    v_exp_f32 v126, v126
    v_add_f32 v243, v243, v110
    v_exp_f32 v111, v111
    v_mfma_f32_32x32x16_bf16 a[16:31], a[224:227], v[148:151], a[16:31]
    ds_read_b64_tr_b16 a[248:249], v234 offset:28672
    v_add_f32 v244, v244, v126
    v_exp_f32 v127, v127
    v_add_f32 v243, v243, v111
    v_cvt_pk_bf16_f32 v187, v110, v111
    v_mfma_f32_32x32x16_bf16 a[32:47], a[228:231], v[144:147], a[32:47]
    ds_read_b64_tr_b16 a[250:251], v234 offset:30720
    v_add_f32 v244, v244, v127
    v_cvt_pk_bf16_f32 v191, v126, v127
    v_max_f32 v246, v243, v244
    v_cmp_lt_f32 vcc, s43, v246
    v_mfma_f32_32x32x16_bf16 a[48:63], a[228:231], v[148:151], a[48:63]
    ds_read_b64_tr_b16 a[252:253], v235 offset:28672
    s_waitcnt lgkmcnt(7)
    v_mfma_f32_32x32x16_bf16 a[64:79], a[232:235], v[144:147], a[64:79]
    ds_read_b64_tr_b16 a[254:255], v235 offset:30720
    v_mfma_f32_32x32x16_bf16 a[80:95], a[232:235], v[148:151], a[80:95]
    v_mfma_f32_32x32x16_bf16 a[96:111], a[236:239], v[144:147], a[96:111]
    v_mfma_f32_32x32x16_bf16 a[112:127], a[236:239], v[148:151], a[112:127]
    s_waitcnt lgkmcnt(4)
    v_mfma_f32_32x32x16_bf16 a[0:15], a[240:243], v[152:155], a[0:15]
    s_waitcnt vmcnt(8) lgkmcnt(0)
    s_barrier
    v_mfma_f32_32x32x16_bf16 a[16:31], a[240:243], v[156:159], a[16:31]
    ds_read_b128 a[192:195], v224 offset:16384
    v_mfma_f32_32x32x16_bf16 a[32:47], a[244:247], v[152:155], a[32:47]
    ds_read_b128 a[196:199], v225 offset:16384
    v_mfma_f32_32x32x16_bf16 a[48:63], a[244:247], v[156:159], a[48:63]
    ds_read_b128 a[200:203], v226 offset:16384
    v_mfma_f32_32x32x16_bf16 a[64:79], a[248:251], v[152:155], a[64:79]
    ds_read_b128 a[204:207], v227 offset:16384
    v_mfma_f32_32x32x16_bf16 a[80:95], a[248:251], v[156:159], a[80:95]
    v_mfma_f32_32x32x16_bf16 a[96:111], a[252:255], v[152:155], a[96:111]
    v_mfma_f32_32x32x16_bf16 a[112:127], a[252:255], v[156:159], a[112:127]
    s_cbranch_vccnz L_rare4
L_ret4:
    v_add_f32 v241, v241, v243
    v_add_f32 v242, v242, v244
    s_add_u32 s35, s35, 16384
    s_waitcnt lgkmcnt(2)
    v_mfma_f32_32x32x16_bf16 v[64:79], a[192:195], a[128:131], v[192:207]
    v_exp_f32 v0, v0
    v_exp_f32 v16, v16
    v_exp_f32 v1, v1
    v_mfma_f32_32x32x16_bf16 v[80:95], a[192:195], a[160:163], v[208:223]
    ds_read_b128 a[208:211], v228 offset:16384
    s_mov_b32 m0, s36
    v_exp_f32 v17, v17
    v_add_f32 v243, v0, v1
    v_cvt_pk_bf16_f32 v128, v0, v1
    v_mfma_f32_32x32x16_bf16 v[64:79], a[196:199], a[132:135], v[64:79]
    buffer_load_dwordx4 v236, s[8:11], s33 offen lds
    v_exp_f32 v2, v2
    v_add_f32 v244, v16, v17
    v_cvt_pk_bf16_f32 v132, v16, v17
    v_mfma_f32_32x32x16_bf16 v[80:95], a[196:199], a[164:167], v[80:95]
    ds_read_b128 a[212:215], v229 offset:16384
    v_exp_f32 v18, v18
    v_add_f32 v243, v243, v2
    s_waitcnt lgkmcnt(2)
    v_mfma_f32_32x32x16_bf16 v[64:79], a[200:203], a[136:139], v[64:79]
    buffer_load_dwordx4 v237, s[8:11], s33 offen offset:1024 lds
    v_exp_f32 v3, v3
    v_add_f32 v244, v244, v18
    v_exp_f32 v19, v19
    v_mfma_f32_32x32x16_bf16 v[80:95], a[200:203], a[168:171], v[80:95]
    ds_read_b128 a[216:219], v230 offset:16384
    v_add_f32 v243, v243, v3
    v_cvt_pk_bf16_f32 v129, v2, v3
    v_exp_f32 v4, v4
    v_add_f32 v244, v244, v19
    v_mfma_f32_32x32x16_bf16 v[64:79], a[204:207], a[140:143], v[64:79]
    buffer_load_dwordx4 v238, s[8:11], s33 offen offset:2048 lds
    v_cvt_pk_bf16_f32 v133, v18, v19
    v_exp_f32 v20, v20
    v_add_f32 v243, v243, v4
    v_mfma_f32_32x32x16_bf16 v[80:95], a[204:207], a[172:175], v[80:95]
    ds_read_b128 a[220:223], v231 offset:16384
    v_exp_f32 v5, v5
    v_add_f32 v244, v244, v20
    s_waitcnt lgkmcnt(2)
    v_mfma_f32_32x32x16_bf16 v[64:79], a[208:211], a[144:147], v[64:79]
    buffer_load_dwordx4 v239, s[8:11], s33 offen offset:3072 lds
    v_exp_f32 v21, v21
    v_add_f32 v243, v243, v5
    v_cvt_pk_bf16_f32 v130, v4, v5
    v_mfma_f32_32x32x16_bf16 v[80:95], a[208:211], a[176:179], v[80:95]
    ds_read_b128 a[192:195], v224 offset:24576
    s_mov_b32 m0, s40
    v_exp_f32 v6, v6
    v_add_f32 v244, v244, v21
    v_cvt_pk_bf16_f32 v134, v20, v21
    v_mfma_f32_32x32x16_bf16 v[64:79], a[212:215], a[148:151], v[64:79]
    buffer_load_dwordx4 v240, s[12:15], s34 offen lds
    v_exp_f32 v22, v22
    v_add_f32 v243, v243, v6
    v_exp_f32 v7, v7
    v_mfma_f32_32x32x16_bf16 v[80:95], a[212:215], a[180:183], v[80:95]
    ds_read_b128 a[196:199], v225 offset:24576
    v_add_f32 v244, v244, v22
    v_exp_f32 v23, v23
    v_add_f32 v243, v243, v7
    s_waitcnt lgkmcnt(2)
    v_mfma_f32_32x32x16_bf16 v[64:79], a[216:219], a[152:155], v[64:79]
    buffer_load_dwordx4 v240, s[12:15], s34 offen offset:1024 lds
    v_cvt_pk_bf16_f32 v131, v6, v7
    v_exp_f32 v8, v8
    v_add_f32 v244, v244, v23
    v_cvt_pk_bf16_f32 v135, v22, v23
    v_mfma_f32_32x32x16_bf16 v[80:95], a[216:219], a[184:187], v[80:95]
    ds_read_b128 a[200:203], v226 offset:24576
    v_exp_f32 v24, v24
    v_add_f32 v243, v243, v8
    v_exp_f32 v9, v9
    v_mfma_f32_32x32x16_bf16 v[64:79], a[220:223], a[156:159], v[64:79]
    buffer_load_dwordx4 v240, s[12:15], s34 offen offset:2048 lds
    v_add_f32 v244, v244, v24
    v_exp_f32 v25, v25
    v_add_f32 v243, v243, v9
    v_cvt_pk_bf16_f32 v136, v8, v9
    v_mfma_f32_32x32x16_bf16 v[80:95], a[220:223], a[188:191], v[80:95]
    ds_read_b128 a[204:207], v227 offset:24576
    v_exp_f32 v10, v10
    v_add_f32 v244, v244, v25
    v_cvt_pk_bf16_f32 v140, v24, v25
    s_waitcnt lgkmcnt(2)
    v_mfma_f32_32x32x16_bf16 v[96:111], a[192:195], a[128:131], v[192:207]
    buffer_load_dwordx4 v240, s[12:15], s34 offen offset:3072 lds
    v_exp_f32 v26, v26
    v_add_f32 v243, v243, v10
    v_exp_f32 v11, v11
    v_mfma_f32_32x32x16_bf16 v[112:127], a[192:195], a[160:163], v[208:223]
    ds_read_b128 a[208:211], v228 offset:24576
    v_add_f32 v244, v244, v26
    v_exp_f32 v27, v27
    v_add_f32 v243, v243, v11
    v_cvt_pk_bf16_f32 v137, v10, v11
    v_mfma_f32_32x32x16_bf16 v[96:111], a[196:199], a[132:135], v[96:111]
    s_add_u32 s33, s33, 16384
    v_exp_f32 v12, v12
    v_add_f32 v244, v244, v27
    v_cvt_pk_bf16_f32 v141, v26, v27
    v_mfma_f32_32x32x16_bf16 v[112:127], a[196:199], a[164:167], v[112:127]
    ds_read_b128 a[212:215], v229 offset:24576
    s_add_u32 s34, s34, 16384
    v_exp_f32 v28, v28
    v_add_f32 v243, v243, v12
    s_waitcnt lgkmcnt(2)
    v_mfma_f32_32x32x16_bf16 v[96:111], a[200:203], a[136:139], v[96:111]
    v_exp_f32 v13, v13
    v_add_f32 v244, v244, v28
    v_exp_f32 v29, v29
    v_add_f32 v243, v243, v13
    v_mfma_f32_32x32x16_bf16 v[112:127], a[200:203], a[168:171], v[112:127]
    ds_read_b128 a[216:219], v230 offset:24576
    ds_read_b64_tr_b16 a[224:225], v232 offset:32768
    v_cvt_pk_bf16_f32 v138, v12, v13
    v_exp_f32 v14, v14
    v_add_f32 v244, v244, v29
    v_mfma_f32_32x32x16_bf16 v[96:111], a[204:207], a[140:143], v[96:111]
    ds_read_b64_tr_b16 a[226:227], v232 offset:34816
    v_cvt_pk_bf16_f32 v142, v28, v29
    v_exp_f32 v30, v30
    v_add_f32 v243, v243, v14
    v_mfma_f32_32x32x16_bf16 v[112:127], a[204:207], a[172:175], v[112:127]
    ds_read_b128 a[220:223], v231 offset:24576
    ds_read_b64_tr_b16 a[228:229], v233 offset:32768
    v_exp_f32 v15, v15
    v_add_f32 v244, v244, v30
    s_waitcnt lgkmcnt(5)
    v_mfma_f32_32x32x16_bf16 v[96:111], a[208:211], a[144:147], v[96:111]
    ds_read_b64_tr_b16 a[230:231], v233 offset:34816
    v_exp_f32 v31, v31
    v_add_f32 v243, v243, v15
    v_cvt_pk_bf16_f32 v139, v14, v15
    v_mfma_f32_32x32x16_bf16 v[112:127], a[208:211], a[176:179], v[112:127]
    ds_read_b64_tr_b16 a[232:233], v234 offset:32768
    v_exp_f32 v32, v32
    v_add_f32 v244, v244, v31
    v_cvt_pk_bf16_f32 v143, v30, v31
    v_mfma_f32_32x32x16_bf16 v[96:111], a[212:215], a[148:151], v[96:111]
    ds_read_b64_tr_b16 a[234:235], v234 offset:34816
    v_exp_f32 v48, v48
    v_add_f32 v243, v243, v32
    v_exp_f32 v33, v33
    v_mfma_f32_32x32x16_bf16 v[112:127], a[212:215], a[180:183], v[112:127]
    ds_read_b64_tr_b16 a[236:237], v235 offset:32768
    v_add_f32 v244, v244, v48
    v_exp_f32 v49, v49
    v_add_f32 v243, v243, v33
    s_waitcnt lgkmcnt(5)
    v_mfma_f32_32x32x16_bf16 v[96:111], a[216:219], a[152:155], v[96:111]
    ds_read_b64_tr_b16 a[238:239], v235 offset:34816
    v_cvt_pk_bf16_f32 v144, v32, v33
    v_exp_f32 v34, v34
    v_add_f32 v244, v244, v49
    v_cvt_pk_bf16_f32 v148, v48, v49
    v_mfma_f32_32x32x16_bf16 v[112:127], a[216:219], a[184:187], v[112:127]
    ds_read_b64_tr_b16 a[240:241], v232 offset:36864
    v_exp_f32 v50, v50
    v_add_f32 v243, v243, v34
    v_exp_f32 v35, v35
    v_mfma_f32_32x32x16_bf16 v[96:111], a[220:223], a[156:159], v[96:111]
    ds_read_b64_tr_b16 a[242:243], v232 offset:38912
    v_add_f32 v244, v244, v50
    v_exp_f32 v51, v51
    v_add_f32 v243, v243, v35
    v_cvt_pk_bf16_f32 v145, v34, v35
    v_mfma_f32_32x32x16_bf16 v[112:127], a[220:223], a[188:191], v[112:127]
    ds_read_b64_tr_b16 a[244:245], v233 offset:36864
    v_exp_f32 v36, v36
    v_add_f32 v244, v244, v51
    v_cvt_pk_bf16_f32 v149, v50, v51
    s_waitcnt lgkmcnt(7)
    v_mfma_f32_32x32x16_bf16 a[0:15], a[224:227], v[160:163], a[0:15]
    ds_read_b64_tr_b16 a[246:247], v233 offset:38912
    v_exp_f32 v52, v52
    v_add_f32 v243, v243, v36
    v_exp_f32 v37, v37
    v_mfma_f32_32x32x16_bf16 a[16:31], a[224:227], v[164:167], a[16:31]
    ds_read_b64_tr_b16 a[248:249], v234 offset:36864
    v_add_f32 v244, v244, v52
    v_exp_f32 v53, v53
    v_add_f32 v243, v243, v37
    v_cvt_pk_bf16_f32 v146, v36, v37
    v_mfma_f32_32x32x16_bf16 a[32:47], a[228:231], v[160:163], a[32:47]
    ds_read_b64_tr_b16 a[250:251], v234 offset:38912
    v_exp_f32 v38, v38
    v_add_f32 v244, v244, v53
    v_cvt_pk_bf16_f32 v150, v52, v53
    v_mfma_f32_32x32x16_bf16 a[48:63], a[228:231], v[164:167], a[48:63]
    ds_read_b64_tr_b16 a[252:253], v235 offset:36864
    v_exp_f32 v54, v54
    v_add_f32 v243, v243, v38
    s_waitcnt lgkmcnt(7)
    v_mfma_f32_32x32x16_bf16 a[64:79], a[232:235], v[160:163], a[64:79]
    ds_read_b64_tr_b16 a[254:255], v235 offset:38912
    v_exp_f32 v39, v39
    v_add_f32 v244, v244, v54
    v_exp_f32 v55, v55
    v_mfma_f32_32x32x16_bf16 a[80:95], a[232:235], v[164:167], a[80:95]
    ds_read_b64_tr_b16 a[224:225], v232 offset:40960
    v_add_f32 v243, v243, v39
    v_cvt_pk_bf16_f32 v147, v38, v39
    v_exp_f32 v40, v40
    v_add_f32 v244, v244, v55
    v_mfma_f32_32x32x16_bf16 a[96:111], a[236:239], v[160:163], a[96:111]
    ds_read_b64_tr_b16 a[226:227], v232 offset:43008
    v_cvt_pk_bf16_f32 v151, v54, v55
    v_exp_f32 v56, v56
    v_add_f32 v243, v243, v40
    v_mfma_f32_32x32x16_bf16 a[112:127], a[236:239], v[164:167], a[112:127]
    ds_read_b64_tr_b16 a[228:229], v233 offset:40960
    v_exp_f32 v41, v41
    v_add_f32 v244, v244, v56
    s_waitcnt lgkmcnt(7)
    v_mfma_f32_32x32x16_bf16 a[0:15], a[240:243], v[168:171], a[0:15]
    ds_read_b64_tr_b16 a[230:231], v233 offset:43008
    v_exp_f32 v57, v57
    v_add_f32 v243, v243, v41
    v_cvt_pk_bf16_f32 v152, v40, v41
    v_mfma_f32_32x32x16_bf16 a[16:31], a[240:243], v[172:175], a[16:31]
    ds_read_b64_tr_b16 a[232:233], v234 offset:40960
    v_exp_f32 v42, v42
    v_add_f32 v244, v244, v57
    v_cvt_pk_bf16_f32 v156, v56, v57
    v_mfma_f32_32x32x16_bf16 a[32:47], a[244:247], v[168:171], a[32:47]
    ds_read_b64_tr_b16 a[234:235], v234 offset:43008
    v_exp_f32 v58, v58
    v_add_f32 v243, v243, v42
    v_exp_f32 v43, v43
    v_mfma_f32_32x32x16_bf16 a[48:63], a[244:247], v[172:175], a[48:63]
    ds_read_b64_tr_b16 a[236:237], v235 offset:40960
    v_add_f32 v244, v244, v58
    v_exp_f32 v59, v59
    v_add_f32 v243, v243, v43
    s_waitcnt lgkmcnt(7)
    v_mfma_f32_32x32x16_bf16 a[64:79], a[248:251], v[168:171], a[64:79]
    ds_read_b64_tr_b16 a[238:239], v235 offset:43008
    v_cvt_pk_bf16_f32 v153, v42, v43
    v_exp_f32 v44, v44
    v_add_f32 v244, v244, v59
    v_cvt_pk_bf16_f32 v157, v58, v59
    v_mfma_f32_32x32x16_bf16 a[80:95], a[248:251], v[172:175], a[80:95]
    ds_read_b64_tr_b16 a[240:241], v232 offset:45056
    v_exp_f32 v60, v60
    v_add_f32 v243, v243, v44
    v_exp_f32 v45, v45
    v_mfma_f32_32x32x16_bf16 a[96:111], a[252:255], v[168:171], a[96:111]
    ds_read_b64_tr_b16 a[242:243], v232 offset:47104
    v_add_f32 v244, v244, v60
    v_exp_f32 v61, v61
    v_add_f32 v243, v243, v45
    v_cvt_pk_bf16_f32 v154, v44, v45
    v_mfma_f32_32x32x16_bf16 a[112:127], a[252:255], v[172:175], a[112:127]
    ds_read_b64_tr_b16 a[244:245], v233 offset:45056
    v_exp_f32 v46, v46
    v_add_f32 v244, v244, v61
    v_cvt_pk_bf16_f32 v158, v60, v61
    s_waitcnt lgkmcnt(7)
    v_mfma_f32_32x32x16_bf16 a[0:15], a[224:227], v[176:179], a[0:15]
    ds_read_b64_tr_b16 a[246:247], v233 offset:47104
    v_exp_f32 v62, v62
    v_add_f32 v243, v243, v46
    v_exp_f32 v47, v47
    v_mfma_f32_32x32x16_bf16 a[16:31], a[224:227], v[180:183], a[16:31]
    ds_read_b64_tr_b16 a[248:249], v234 offset:45056
    v_add_f32 v244, v244, v62
    v_exp_f32 v63, v63
    v_add_f32 v243, v243, v47
    v_cvt_pk_bf16_f32 v155, v46, v47
    v_mfma_f32_32x32x16_bf16 a[32:47], a[228:231], v[176:179], a[32:47]
    ds_read_b64_tr_b16 a[250:251], v234 offset:47104
    v_add_f32 v244, v244, v63
    v_cvt_pk_bf16_f32 v159, v62, v63
    v_max_f32 v246, v243, v244
    v_cmp_lt_f32 vcc, s43, v246
    v_mfma_f32_32x32x16_bf16 a[48:63], a[228:231], v[180:183], a[48:63]
    ds_read_b64_tr_b16 a[252:253], v235 offset:45056
    s_waitcnt lgkmcnt(7)
    v_mfma_f32_32x32x16_bf16 a[64:79], a[232:235], v[176:179], a[64:79]
    ds_read_b64_tr_b16 a[254:255], v235 offset:47104
    v_mfma_f32_32x32x16_bf16 a[80:95], a[232:235], v[180:183], a[80:95]
    v_mfma_f32_32x32x16_bf16 a[96:111], a[236:239], v[176:179], a[96:111]
    v_mfma_f32_32x32x16_bf16 a[112:127], a[236:239], v[180:183], a[112:127]
    s_waitcnt lgkmcnt(4)
    v_mfma_f32_32x32x16_bf16 a[0:15], a[240:243], v[184:187], a[0:15]
    s_waitcnt vmcnt(8) lgkmcnt(0)
    s_barrier
    v_mfma_f32_32x32x16_bf16 a[16:31], a[240:243], v[188:191], a[16:31]
    ds_read_b128 a[192:195], v224 offset:32768
    v_mfma_f32_32x32x16_bf16 a[32:47], a[244:247], v[184:187], a[32:47]
    ds_read_b128 a[196:199], v225 offset:32768
    v_mfma_f32_32x32x16_bf16 a[48:63], a[244:247], v[188:191], a[48:63]
    ds_read_b128 a[200:203], v226 offset:32768
    v_mfma_f32_32x32x16_bf16 a[64:79], a[248:251], v[184:187], a[64:79]
    ds_read_b128 a[204:207], v227 offset:32768
    v_mfma_f32_32x32x16_bf16 a[80:95], a[248:251], v[188:191], a[80:95]
    v_mfma_f32_32x32x16_bf16 a[96:111], a[252:255], v[184:187], a[96:111]
    v_mfma_f32_32x32x16_bf16 a[112:127], a[252:255], v[188:191], a[112:127]
    s_cbranch_vccnz L_rare5
L_ret5:
    v_add_f32 v241, v241, v243
    v_add_f32 v242, v242, v244
    s_add_u32 s35, s35, 16384
    s_add_u32 s42, s42, 1
    s_cmp_lt_u32 s42, 5
    s_cbranch_scc1 L_loop
    ds_read_b64_tr_b16 a[224:225], v232 offset:0
    ds_read_b64_tr_b16 a[226:227], v232 offset:2048
    ds_read_b64_tr_b16 a[228:229], v233 offset:0
    ds_read_b64_tr_b16 a[230:231], v233 offset:2048
    ds_read_b64_tr_b16 a[232:233], v234 offset:0
    ds_read_b64_tr_b16 a[234:235], v234 offset:2048
    ds_read_b64_tr_b16 a[236:237], v235 offset:0
    ds_read_b64_tr_b16 a[238:239], v235 offset:2048
    ds_read_b64_tr_b16 a[240:241], v232 offset:4096
    ds_read_b64_tr_b16 a[242:243], v232 offset:6144
    ds_read_b64_tr_b16 a[244:245], v233 offset:4096
    s_waitcnt lgkmcnt(7)
    v_mfma_f32_32x32x16_bf16 a[0:15], a[224:227], v[128:131], a[0:15]
    ds_read_b64_tr_b16 a[246:247], v233 offset:6144
    v_exp_f32 v64, v64
    v_exp_f32 v80, v80
    v_mfma_f32_32x32x16_bf16 a[16:31], a[224:227], v[132:135], a[16:31]
    ds_read_b64_tr_b16 a[248:249], v234 offset:4096
    v_exp_f32 v65, v65
    v_exp_f32 v81, v81
    v_add_f32 v243, v64, v65
    v_mfma_f32_32x32x16_bf16 a[32:47], a[228:231], v[128:131], a[32:47]
    ds_read_b64_tr_b16 a[250:251], v234 offset:6144
    v_cvt_pk_bf16_f32 v160, v64, v65
    v_exp_f32 v66, v66
    v_add_f32 v244, v80, v81
    v_cvt_pk_bf16_f32 v164, v80, v81
    v_mfma_f32_32x32x16_bf16 a[48:63], a[228:231], v[132:135], a[48:63]
    ds_read_b64_tr_b16 a[252:253], v235 offset:4096
    v_exp_f32 v82, v82
    v_add_f32 v243, v243, v66
    s_waitcnt lgkmcnt(7)
    v_mfma_f32_32x32x16_bf16 a[64:79], a[232:235], v[128:131], a[64:79]
    ds_read_b64_tr_b16 a[254:255], v235 offset:6144
    v_exp_f32 v67, v67
    v_add_f32 v244, v244, v82
    v_exp_f32 v83, v83
    v_mfma_f32_32x32x16_bf16 a[80:95], a[232:235], v[132:135], a[80:95]
    ds_read_b64_tr_b16 a[224:225], v232 offset:8192
    v_add_f32 v243, v243, v67
    v_cvt_pk_bf16_f32 v161, v66, v67
    v_exp_f32 v68, v68
    v_add_f32 v244, v244, v83
    v_mfma_f32_32x32x16_bf16 a[96:111], a[236:239], v[128:131], a[96:111]
    ds_read_b64_tr_b16 a[226:227], v232 offset:10240
    v_cvt_pk_bf16_f32 v165, v82, v83
    v_exp_f32 v84, v84
    v_add_f32 v243, v243, v68
    v_mfma_f32_32x32x16_bf16 a[112:127], a[236:239], v[132:135], a[112:127]
    ds_read_b64_tr_b16 a[228:229], v233 offset:8192
    v_exp_f32 v69, v69
    v_add_f32 v244, v244, v84
    s_waitcnt lgkmcnt(7)
    v_mfma_f32_32x32x16_bf16 a[0:15], a[240:243], v[136:139], a[0:15]
    ds_read_b64_tr_b16 a[230:231], v233 offset:10240
    v_exp_f32 v85, v85
    v_add_f32 v243, v243, v69
    v_cvt_pk_bf16_f32 v162, v68, v69
    v_mfma_f32_32x32x16_bf16 a[16:31], a[240:243], v[140:143], a[16:31]
    ds_read_b64_tr_b16 a[232:233], v234 offset:8192
    v_exp_f32 v70, v70
    v_add_f32 v244, v244, v85
    v_cvt_pk_bf16_f32 v166, v84, v85
    v_mfma_f32_32x32x16_bf16 a[32:47], a[244:247], v[136:139], a[32:47]
    ds_read_b64_tr_b16 a[234:235], v234 offset:10240
    v_exp_f32 v86, v86
    v_add_f32 v243, v243, v70
    v_exp_f32 v71, v71
    v_mfma_f32_32x32x16_bf16 a[48:63], a[244:247], v[140:143], a[48:63]
    ds_read_b64_tr_b16 a[236:237], v235 offset:8192
    v_add_f32 v244, v244, v86
    v_exp_f32 v87, v87
    v_add_f32 v243, v243, v71
    s_waitcnt lgkmcnt(7)
    v_mfma_f32_32x32x16_bf16 a[64:79], a[248:251], v[136:139], a[64:79]
    ds_read_b64_tr_b16 a[238:239], v235 offset:10240
    v_cvt_pk_bf16_f32 v163, v70, v71
    v_exp_f32 v72, v72
    v_add_f32 v244, v244, v87
    v_cvt_pk_bf16_f32 v167, v86, v87
    v_mfma_f32_32x32x16_bf16 a[80:95], a[248:251], v[140:143], a[80:95]
    ds_read_b64_tr_b16 a[240:241], v232 offset:12288
    v_exp_f32 v88, v88
    v_add_f32 v243, v243, v72
    v_exp_f32 v73, v73
    v_mfma_f32_32x32x16_bf16 a[96:111], a[252:255], v[136:139], a[96:111]
    ds_read_b64_tr_b16 a[242:243], v232 offset:14336
    v_add_f32 v244, v244, v88
    v_exp_f32 v89, v89
    v_add_f32 v243, v243, v73
    v_cvt_pk_bf16_f32 v168, v72, v73
    v_mfma_f32_32x32x16_bf16 a[112:127], a[252:255], v[140:143], a[112:127]
    ds_read_b64_tr_b16 a[244:245], v233 offset:12288
    v_exp_f32 v74, v74
    v_add_f32 v244, v244, v89
    v_cvt_pk_bf16_f32 v172, v88, v89
    s_waitcnt lgkmcnt(7)
    v_mfma_f32_32x32x16_bf16 a[0:15], a[224:227], v[144:147], a[0:15]
    ds_read_b64_tr_b16 a[246:247], v233 offset:14336
    v_exp_f32 v90, v90
    v_add_f32 v243, v243, v74
    v_exp_f32 v75, v75
    v_mfma_f32_32x32x16_bf16 a[16:31], a[224:227], v[148:151], a[16:31]
    ds_read_b64_tr_b16 a[248:249], v234 offset:12288
    v_add_f32 v244, v244, v90
    v_exp_f32 v91, v91
    v_add_f32 v243, v243, v75
    v_cvt_pk_bf16_f32 v169, v74, v75
    v_mfma_f32_32x32x16_bf16 a[32:47], a[228:231], v[144:147], a[32:47]
    ds_read_b64_tr_b16 a[250:251], v234 offset:14336
    v_exp_f32 v76, v76
    v_add_f32 v244, v244, v91
    v_cvt_pk_bf16_f32 v173, v90, v91
    v_mfma_f32_32x32x16_bf16 a[48:63], a[228:231], v[148:151], a[48:63]
    ds_read_b64_tr_b16 a[252:253], v235 offset:12288
    v_exp_f32 v92, v92
    v_add_f32 v243, v243, v76
    s_waitcnt lgkmcnt(7)
    v_mfma_f32_32x32x16_bf16 a[64:79], a[232:235], v[144:147], a[64:79]
    ds_read_b64_tr_b16 a[254:255], v235 offset:14336
    v_exp_f32 v77, v77
    v_add_f32 v244, v244, v92
    v_exp_f32 v93, v93
    v_mfma_f32_32x32x16_bf16 a[80:95], a[232:235], v[148:151], a[80:95]
    v_add_f32 v243, v243, v77
    v_cvt_pk_bf16_f32 v170, v76, v77
    v_exp_f32 v78, v78
    v_add_f32 v244, v244, v93
    v_cvt_pk_bf16_f32 v174, v92, v93
    v_mfma_f32_32x32x16_bf16 a[96:111], a[236:239], v[144:147], a[96:111]
    v_exp_f32 v94, v94
    v_add_f32 v243, v243, v78
    v_exp_f32 v79, v79
    v_add_f32 v244, v244, v94
    v_mfma_f32_32x32x16_bf16 a[112:127], a[236:239], v[148:151], a[112:127]
    v_exp_f32 v95, v95
    v_add_f32 v243, v243, v79
    v_cvt_pk_bf16_f32 v171, v78, v79
    s_waitcnt lgkmcnt(4)
    v_mfma_f32_32x32x16_bf16 a[0:15], a[240:243], v[152:155], a[0:15]
    s_waitcnt vmcnt(0) lgkmcnt(0)
    s_barrier
    v_exp_f32 v96, v96
    v_add_f32 v244, v244, v95
    v_cvt_pk_bf16_f32 v175, v94, v95
    v_mfma_f32_32x32x16_bf16 a[16:31], a[240:243], v[156:159], a[16:31]
    v_exp_f32 v112, v112
    v_add_f32 v243, v243, v96
    v_exp_f32 v97, v97
    v_add_f32 v244, v244, v112
    v_mfma_f32_32x32x16_bf16 a[32:47], a[244:247], v[152:155], a[32:47]
    v_exp_f32 v113, v113
    v_add_f32 v243, v243, v97
    v_cvt_pk_bf16_f32 v176, v96, v97
    v_exp_f32 v98, v98
    v_mfma_f32_32x32x16_bf16 a[48:63], a[244:247], v[156:159], a[48:63]
    v_add_f32 v244, v244, v113
    v_cvt_pk_bf16_f32 v180, v112, v113
    v_exp_f32 v114, v114
    v_add_f32 v243, v243, v98
    v_mfma_f32_32x32x16_bf16 a[64:79], a[248:251], v[152:155], a[64:79]
    v_exp_f32 v99, v99
    v_add_f32 v244, v244, v114
    v_exp_f32 v115, v115
    v_add_f32 v243, v243, v99
    v_mfma_f32_32x32x16_bf16 a[80:95], a[248:251], v[156:159], a[80:95]
    v_cvt_pk_bf16_f32 v177, v98, v99
    v_exp_f32 v100, v100
    v_add_f32 v244, v244, v115
    v_cvt_pk_bf16_f32 v181, v114, v115
    v_mfma_f32_32x32x16_bf16 a[96:111], a[252:255], v[152:155], a[96:111]
    v_exp_f32 v116, v116
    v_add_f32 v243, v243, v100
    v_exp_f32 v101, v101
    v_add_f32 v244, v244, v116
    v_mfma_f32_32x32x16_bf16 a[112:127], a[252:255], v[156:159], a[112:127]
    v_exp_f32 v117, v117
    v_add_f32 v243, v243, v101
    v_cvt_pk_bf16_f32 v178, v100, v101
    v_exp_f32 v102, v102
    v_add_f32 v244, v244, v117
    v_cvt_pk_bf16_f32 v182, v116, v117
    v_exp_f32 v118, v118
    v_add_f32 v243, v243, v102
    v_exp_f32 v103, v103
    v_add_f32 v244, v244, v118
    v_exp_f32 v119, v119
    v_add_f32 v243, v243, v103
    v_cvt_pk_bf16_f32 v179, v102, v103
    v_exp_f32 v104, v104
    v_add_f32 v244, v244, v119
    v_cvt_pk_bf16_f32 v183, v118, v119
    v_exp_f32 v120, v120
    v_add_f32 v243, v243, v104
    v_exp_f32 v105, v105
    v_add_f32 v244, v244, v120
    v_exp_f32 v121, v121
    v_add_f32 v243, v243, v105
    v_cvt_pk_bf16_f32 v184, v104, v105
    v_exp_f32 v106, v106
    v_add_f32 v244, v244, v121
    v_cvt_pk_bf16_f32 v188, v120, v121
    v_exp_f32 v122, v122
    v_add_f32 v243, v243, v106
    v_exp_f32 v107, v107
    v_add_f32 v244, v244, v122
    v_exp_f32 v123, v123
    v_add_f32 v243, v243, v107
    v_cvt_pk_bf16_f32 v185, v106, v107
    v_exp_f32 v108, v108
    v_add_f32 v244, v244, v123
    v_cvt_pk_bf16_f32 v189, v122, v123
    v_exp_f32 v124, v124
    v_add_f32 v243, v243, v108
    v_exp_f32 v109, v109
    v_add_f32 v244, v244, v124
    v_exp_f32 v125, v125
    v_add_f32 v243, v243, v109
    v_cvt_pk_bf16_f32 v186, v108, v109
    v_exp_f32 v110, v110
    v_add_f32 v244, v244, v125
    v_cvt_pk_bf16_f32 v190, v124, v125
    v_exp_f32 v126, v126
    v_add_f32 v243, v243, v110
    v_exp_f32 v111, v111
    v_add_f32 v244, v244, v126
    v_exp_f32 v127, v127
    v_add_f32 v243, v243, v111
    v_cvt_pk_bf16_f32 v187, v110, v111
    v_add_f32 v244, v244, v127
    v_cvt_pk_bf16_f32 v191, v126, v127
    v_max_f32 v246, v243, v244
    v_cmp_lt_f32 vcc, s43, v246
    s_cbranch_vccnz L_rareT
L_retT:
    v_add_f32 v241, v241, v243
    v_add_f32 v242, v242, v244
    s_add_u32 s35, s35, 16384
    ds_read_b64_tr_b16 a[224:225], v232 offset:16384
    ds_read_b64_tr_b16 a[226:227], v232 offset:18432
    ds_read_b64_tr_b16 a[228:229], v233 offset:16384
    ds_read_b64_tr_b16 a[230:231], v233 offset:18432
    ds_read_b64_tr_b16 a[232:233], v234 offset:16384
    ds_read_b64_tr_b16 a[234:235], v234 offset:18432
    ds_read_b64_tr_b16 a[236:237], v235 offset:16384
    ds_read_b64_tr_b16 a[238:239], v235 offset:18432
    ds_read_b64_tr_b16 a[240:241], v232 offset:20480
    ds_read_b64_tr_b16 a[242:243], v232 offset:22528
    ds_read_b64_tr_b16 a[244:245], v233 offset:20480
    s_waitcnt lgkmcnt(7)
    v_mfma_f32_32x32x16_bf16 a[0:15], a[224:227], v[160:163], a[0:15]
    ds_read_b64_tr_b16 a[246:247], v233 offset:22528
    v_mfma_f32_32x32x16_bf16 a[16:31], a[224:227], v[164:167], a[16:31]
    ds_read_b64_tr_b16 a[248:249], v234 offset:20480
    v_mfma_f32_32x32x16_bf16 a[32:47], a[228:231], v[160:163], a[32:47]
    ds_read_b64_tr_b16 a[250:251], v234 offset:22528
    v_mfma_f32_32x32x16_bf16 a[48:63], a[228:231], v[164:167], a[48:63]
    ds_read_b64_tr_b16 a[252:253], v235 offset:20480
    s_waitcnt lgkmcnt(7)
    v_mfma_f32_32x32x16_bf16 a[64:79], a[232:235], v[160:163], a[64:79]
    ds_read_b64_tr_b16 a[254:255], v235 offset:22528
    v_mfma_f32_32x32x16_bf16 a[80:95], a[232:235], v[164:167], a[80:95]
    ds_read_b64_tr_b16 a[224:225], v232 offset:24576
    v_mfma_f32_32x32x16_bf16 a[96:111], a[236:239], v[160:163], a[96:111]
    ds_read_b64_tr_b16 a[226:227], v232 offset:26624
    v_mfma_f32_32x32x16_bf16 a[112:127], a[236:239], v[164:167], a[112:127]
    ds_read_b64_tr_b16 a[228:229], v233 offset:24576
    s_waitcnt lgkmcnt(7)
    v_mfma_f32_32x32x16_bf16 a[0:15], a[240:243], v[168:171], a[0:15]
    ds_read_b64_tr_b16 a[230:231], v233 offset:26624
    v_mfma_f32_32x32x16_bf16 a[16:31], a[240:243], v[172:175], a[16:31]
    ds_read_b64_tr_b16 a[232:233], v234 offset:24576
    v_mfma_f32_32x32x16_bf16 a[32:47], a[244:247], v[168:171], a[32:47]
    ds_read_b64_tr_b16 a[234:235], v234 offset:26624
    v_mfma_f32_32x32x16_bf16 a[48:63], a[244:247], v[172:175], a[48:63]
    ds_read_b64_tr_b16 a[236:237], v235 offset:24576
    s_waitcnt lgkmcnt(7)
    v_mfma_f32_32x32x16_bf16 a[64:79], a[248:251], v[168:171], a[64:79]
    ds_read_b64_tr_b16 a[238:239], v235 offset:26624
    v_mfma_f32_32x32x16_bf16 a[80:95], a[248:251], v[172:175], a[80:95]
    ds_read_b64_tr_b16 a[240:241], v232 offset:28672
    v_mfma_f32_32x32x16_bf16 a[96:111], a[252:255], v[168:171], a[96:111]
    ds_read_b64_tr_b16 a[242:243], v232 offset:30720
    v_mfma_f32_32x32x16_bf16 a[112:127], a[252:255], v[172:175], a[112:127]
    ds_read_b64_tr_b16 a[244:245], v233 offset:28672
    s_waitcnt lgkmcnt(7)
    v_mfma_f32_32x32x16_bf16 a[0:15], a[224:227], v[176:179], a[0:15]
    ds_read_b64_tr_b16 a[246:247], v233 offset:30720
    v_mfma_f32_32x32x16_bf16 a[16:31], a[224:227], v[180:183], a[16:31]
    ds_read_b64_tr_b16 a[248:249], v234 offset:28672
    v_mfma_f32_32x32x16_bf16 a[32:47], a[228:231], v[176:179], a[32:47]
    ds_read_b64_tr_b16 a[250:251], v234 offset:30720
    v_mfma_f32_32x32x16_bf16 a[48:63], a[228:231], v[180:183], a[48:63]
    ds_read_b64_tr_b16 a[252:253], v235 offset:28672
    s_waitcnt lgkmcnt(7)
    v_mfma_f32_32x32x16_bf16 a[64:79], a[232:235], v[176:179], a[64:79]
    ds_read_b64_tr_b16 a[254:255], v235 offset:30720
    v_mfma_f32_32x32x16_bf16 a[80:95], a[232:235], v[180:183], a[80:95]
    v_mfma_f32_32x32x16_bf16 a[96:111], a[236:239], v[176:179], a[96:111]
    v_mfma_f32_32x32x16_bf16 a[112:127], a[236:239], v[180:183], a[112:127]
    s_waitcnt lgkmcnt(4)
    v_mfma_f32_32x32x16_bf16 a[0:15], a[240:243], v[184:187], a[0:15]
    v_mfma_f32_32x32x16_bf16 a[16:31], a[240:243], v[188:191], a[16:31]
    v_mfma_f32_32x32x16_bf16 a[32:47], a[244:247], v[184:187], a[32:47]
    v_mfma_f32_32x32x16_bf16 a[48:63], a[244:247], v[188:191], a[48:63]
    s_waitcnt lgkmcnt(0)
    v_mfma_f32_32x32x16_bf16 a[64:79], a[248:251], v[184:187], a[64:79]
    v_mfma_f32_32x32x16_bf16 a[80:95], a[248:251], v[188:191], a[80:95]
    v_mfma_f32_32x32x16_bf16 a[96:111], a[252:255], v[184:187], a[96:111]
    v_mfma_f32_32x32x16_bf16 a[112:127], a[252:255], v[188:191], a[112:127]
    s_nop 15
    s_nop 3
    v_mov_b32 v248, v241
    v_mov_b32 v249, v241
    s_nop 1
    v_permlane32_swap_b32 v248, v249
    s_nop 1
    v_add_f32 v248, v248, v249
    v_rcp_f32 v246, v248
    v_mov_b32 v248, v242
    v_mov_b32 v249, v242
    s_nop 1
    v_permlane32_swap_b32 v248, v249
    s_nop 1
    v_add_f32 v248, v248, v249
    v_rcp_f32 v247, v248
    s_nop 1
    v_accvgpr_read_b32 v0, a0
    v_accvgpr_read_b32 v1, a1
    v_accvgpr_read_b32 v2, a2
    v_accvgpr_read_b32 v3, a3
    v_accvgpr_read_b32 v4, a4
    v_accvgpr_read_b32 v5, a5
    v_accvgpr_read_b32 v6, a6
    v_accvgpr_read_b32 v7, a7
    s_nop 0
    v_mul_f32 v0, v0, v246
    v_mul_f32 v1, v1, v246
    v_mul_f32 v2, v2, v246
    v_mul_f32 v3, v3, v246
    v_mul_f32 v4, v4, v246
    v_mul_f32 v5, v5, v246
    v_mul_f32 v6, v6, v246
    v_mul_f32 v7, v7, v246
    v_cvt_pk_bf16_f32 v8, v0, v1
    v_cvt_pk_bf16_f32 v9, v2, v3
    v_cvt_pk_bf16_f32 v10, v4, v5
    v_cvt_pk_bf16_f32 v11, v6, v7
    s_nop 1
    v_permlane32_swap_b32 v8, v10
    v_permlane32_swap_b32 v9, v11
    s_nop 0
    buffer_store_dwordx4 v[8:11], v245, s[16:19], s31 offen
    v_accvgpr_read_b32 v16, a8
    v_accvgpr_read_b32 v17, a9
    v_accvgpr_read_b32 v18, a10
    v_accvgpr_read_b32 v19, a11
    v_accvgpr_read_b32 v20, a12
    v_accvgpr_read_b32 v21, a13
    v_accvgpr_read_b32 v22, a14
    v_accvgpr_read_b32 v23, a15
    s_nop 0
    v_mul_f32 v16, v16, v246
    v_mul_f32 v17, v17, v246
    v_mul_f32 v18, v18, v246
    v_mul_f32 v19, v19, v246
    v_mul_f32 v20, v20, v246
    v_mul_f32 v21, v21, v246
    v_mul_f32 v22, v22, v246
    v_mul_f32 v23, v23, v246
    v_cvt_pk_bf16_f32 v24, v16, v17
    v_cvt_pk_bf16_f32 v25, v18, v19
    v_cvt_pk_bf16_f32 v26, v20, v21
    v_cvt_pk_bf16_f32 v27, v22, v23
    s_nop 1
    v_permlane32_swap_b32 v24, v26
    v_permlane32_swap_b32 v25, v27
    s_nop 0
    buffer_store_dwordx4 v[24:27], v245, s[16:19], s31 offen offset:32
    v_accvgpr_read_b32 v32, a32
    v_accvgpr_read_b32 v33, a33
    v_accvgpr_read_b32 v34, a34
    v_accvgpr_read_b32 v35, a35
    v_accvgpr_read_b32 v36, a36
    v_accvgpr_read_b32 v37, a37
    v_accvgpr_read_b32 v38, a38
    v_accvgpr_read_b32 v39, a39
    s_nop 0
    v_mul_f32 v32, v32, v246
    v_mul_f32 v33, v33, v246
    v_mul_f32 v34, v34, v246
    v_mul_f32 v35, v35, v246
    v_mul_f32 v36, v36, v246
    v_mul_f32 v37, v37, v246
    v_mul_f32 v38, v38, v246
    v_mul_f32 v39, v39, v246
    v_cvt_pk_bf16_f32 v40, v32, v33
    v_cvt_pk_bf16_f32 v41, v34, v35
    v_cvt_pk_bf16_f32 v42, v36, v37
    v_cvt_pk_bf16_f32 v43, v38, v39
    s_nop 1
    v_permlane32_swap_b32 v40, v42
    v_permlane32_swap_b32 v41, v43
    s_nop 0
    buffer_store_dwordx4 v[40:43], v245, s[16:19], s31 offen offset:64
    v_accvgpr_read_b32 v48, a40
    v_accvgpr_read_b32 v49, a41
    v_accvgpr_read_b32 v50, a42
    v_accvgpr_read_b32 v51, a43
    v_accvgpr_read_b32 v52, a44
    v_accvgpr_read_b32 v53, a45
    v_accvgpr_read_b32 v54, a46
    v_accvgpr_read_b32 v55, a47
    s_nop 0
    v_mul_f32 v48, v48, v246
    v_mul_f32 v49, v49, v246
    v_mul_f32 v50, v50, v246
    v_mul_f32 v51, v51, v246
    v_mul_f32 v52, v52, v246
    v_mul_f32 v53, v53, v246
    v_mul_f32 v54, v54, v246
    v_mul_f32 v55, v55, v246
    v_cvt_pk_bf16_f32 v56, v48, v49
    v_cvt_pk_bf16_f32 v57, v50, v51
    v_cvt_pk_bf16_f32 v58, v52, v53
    v_cvt_pk_bf16_f32 v59, v54, v55
    s_nop 1
    v_permlane32_swap_b32 v56, v58
    v_permlane32_swap_b32 v57, v59
    s_nop 0
    buffer_store_dwordx4 v[56:59], v245, s[16:19], s31 offen offset:96
    v_accvgpr_read_b32 v0, a64
    v_accvgpr_read_b32 v1, a65
    v_accvgpr_read_b32 v2, a66
    v_accvgpr_read_b32 v3, a67
    v_accvgpr_read_b32 v4, a68
    v_accvgpr_read_b32 v5, a69
    v_accvgpr_read_b32 v6, a70
    v_accvgpr_read_b32 v7, a71
    s_nop 0
    v_mul_f32 v0, v0, v246
    v_mul_f32 v1, v1, v246
    v_mul_f32 v2, v2, v246
    v_mul_f32 v3, v3, v246
    v_mul_f32 v4, v4, v246
    v_mul_f32 v5, v5, v246
    v_mul_f32 v6, v6, v246
    v_mul_f32 v7, v7, v246
    v_cvt_pk_bf16_f32 v8, v0, v1
    v_cvt_pk_bf16_f32 v9, v2, v3
    v_cvt_pk_bf16_f32 v10, v4, v5
    v_cvt_pk_bf16_f32 v11, v6, v7
    s_nop 1
    v_permlane32_swap_b32 v8, v10
    v_permlane32_swap_b32 v9, v11
    s_nop 0
    buffer_store_dwordx4 v[8:11], v245, s[16:19], s31 offen offset:128
    v_accvgpr_read_b32 v16, a72
    v_accvgpr_read_b32 v17, a73
    v_accvgpr_read_b32 v18, a74
    v_accvgpr_read_b32 v19, a75
    v_accvgpr_read_b32 v20, a76
    v_accvgpr_read_b32 v21, a77
    v_accvgpr_read_b32 v22, a78
    v_accvgpr_read_b32 v23, a79
    s_nop 0
    v_mul_f32 v16, v16, v246
    v_mul_f32 v17, v17, v246
    v_mul_f32 v18, v18, v246
    v_mul_f32 v19, v19, v246
    v_mul_f32 v20, v20, v246
    v_mul_f32 v21, v21, v246
    v_mul_f32 v22, v22, v246
    v_mul_f32 v23, v23, v246
    v_cvt_pk_bf16_f32 v24, v16, v17
    v_cvt_pk_bf16_f32 v25, v18, v19
    v_cvt_pk_bf16_f32 v26, v20, v21
    v_cvt_pk_bf16_f32 v27, v22, v23
    s_nop 1
    v_permlane32_swap_b32 v24, v26
    v_permlane32_swap_b32 v25, v27
    s_nop 0
    buffer_store_dwordx4 v[24:27], v245, s[16:19], s31 offen offset:160
    v_accvgpr_read_b32 v32, a96
    v_accvgpr_read_b32 v33, a97
    v_accvgpr_read_b32 v34, a98
    v_accvgpr_read_b32 v35, a99
    v_accvgpr_read_b32 v36, a100
    v_accvgpr_read_b32 v37, a101
    v_accvgpr_read_b32 v38, a102
    v_accvgpr_read_b32 v39, a103
    s_nop 0
    v_mul_f32 v32, v32, v246
    v_mul_f32 v33, v33, v246
    v_mul_f32 v34, v34, v246
    v_mul_f32 v35, v35, v246
    v_mul_f32 v36, v36, v246
    v_mul_f32 v37, v37, v246
    v_mul_f32 v38, v38, v246
    v_mul_f32 v39, v39, v246
    v_cvt_pk_bf16_f32 v40, v32, v33
    v_cvt_pk_bf16_f32 v41, v34, v35
    v_cvt_pk_bf16_f32 v42, v36, v37
    v_cvt_pk_bf16_f32 v43, v38, v39
    s_nop 1
    v_permlane32_swap_b32 v40, v42
    v_permlane32_swap_b32 v41, v43
    s_nop 0
    buffer_store_dwordx4 v[40:43], v245, s[16:19], s31 offen offset:192
    v_accvgpr_read_b32 v48, a104
    v_accvgpr_read_b32 v49, a105
    v_accvgpr_read_b32 v50, a106
    v_accvgpr_read_b32 v51, a107
    v_accvgpr_read_b32 v52, a108
    v_accvgpr_read_b32 v53, a109
    v_accvgpr_read_b32 v54, a110
    v_accvgpr_read_b32 v55, a111
    s_nop 0
    v_mul_f32 v48, v48, v246
    v_mul_f32 v49, v49, v246
    v_mul_f32 v50, v50, v246
    v_mul_f32 v51, v51, v246
    v_mul_f32 v52, v52, v246
    v_mul_f32 v53, v53, v246
    v_mul_f32 v54, v54, v246
    v_mul_f32 v55, v55, v246
    v_cvt_pk_bf16_f32 v56, v48, v49
    v_cvt_pk_bf16_f32 v57, v50, v51
    v_cvt_pk_bf16_f32 v58, v52, v53
    v_cvt_pk_bf16_f32 v59, v54, v55
    s_nop 1
    v_permlane32_swap_b32 v56, v58
    v_permlane32_swap_b32 v57, v59
    s_nop 0
    buffer_store_dwordx4 v[56:59], v245, s[16:19], s31 offen offset:224
    v_accvgpr_read_b32 v0, a16
    v_accvgpr_read_b32 v1, a17
    v_accvgpr_read_b32 v2, a18
    v_accvgpr_read_b32 v3, a19
    v_accvgpr_read_b32 v4, a20
    v_accvgpr_read_b32 v5, a21
    v_accvgpr_read_b32 v6, a22
    v_accvgpr_read_b32 v7, a23
    s_nop 0
    v_mul_f32 v0, v0, v247
    v_mul_f32 v1, v1, v247
    v_mul_f32 v2, v2, v247
    v_mul_f32 v3, v3, v247
    v_mul_f32 v4, v4, v247
    v_mul_f32 v5, v5, v247
    v_mul_f32 v6, v6, v247
    v_mul_f32 v7, v7, v247
    v_cvt_pk_bf16_f32 v8, v0, v1
    v_cvt_pk_bf16_f32 v9, v2, v3
    v_cvt_pk_bf16_f32 v10, v4, v5
    v_cvt_pk_bf16_f32 v11, v6, v7
    s_nop 1
    v_permlane32_swap_b32 v8, v10
    v_permlane32_swap_b32 v9, v11
    s_nop 0
    buffer_store_dwordx4 v[8:11], v245, s[16:19], s48 offen
    v_accvgpr_read_b32 v16, a24
    v_accvgpr_read_b32 v17, a25
    v_accvgpr_read_b32 v18, a26
    v_accvgpr_read_b32 v19, a27
    v_accvgpr_read_b32 v20, a28
    v_accvgpr_read_b32 v21, a29
    v_accvgpr_read_b32 v22, a30
    v_accvgpr_read_b32 v23, a31
    s_nop 0
    v_mul_f32 v16, v16, v247
    v_mul_f32 v17, v17, v247
    v_mul_f32 v18, v18, v247
    v_mul_f32 v19, v19, v247
    v_mul_f32 v20, v20, v247
    v_mul_f32 v21, v21, v247
    v_mul_f32 v22, v22, v247
    v_mul_f32 v23, v23, v247
    v_cvt_pk_bf16_f32 v24, v16, v17
    v_cvt_pk_bf16_f32 v25, v18, v19
    v_cvt_pk_bf16_f32 v26, v20, v21
    v_cvt_pk_bf16_f32 v27, v22, v23
    s_nop 1
    v_permlane32_swap_b32 v24, v26
    v_permlane32_swap_b32 v25, v27
    s_nop 0
    buffer_store_dwordx4 v[24:27], v245, s[16:19], s48 offen offset:32
    v_accvgpr_read_b32 v32, a48
    v_accvgpr_read_b32 v33, a49
    v_accvgpr_read_b32 v34, a50
    v_accvgpr_read_b32 v35, a51
    v_accvgpr_read_b32 v36, a52
    v_accvgpr_read_b32 v37, a53
    v_accvgpr_read_b32 v38, a54
    v_accvgpr_read_b32 v39, a55
    s_nop 0
    v_mul_f32 v32, v32, v247
    v_mul_f32 v33, v33, v247
    v_mul_f32 v34, v34, v247
    v_mul_f32 v35, v35, v247
    v_mul_f32 v36, v36, v247
    v_mul_f32 v37, v37, v247
    v_mul_f32 v38, v38, v247
    v_mul_f32 v39, v39, v247
    v_cvt_pk_bf16_f32 v40, v32, v33
    v_cvt_pk_bf16_f32 v41, v34, v35
    v_cvt_pk_bf16_f32 v42, v36, v37
    v_cvt_pk_bf16_f32 v43, v38, v39
    s_nop 1
    v_permlane32_swap_b32 v40, v42
    v_permlane32_swap_b32 v41, v43
    s_nop 0
    buffer_store_dwordx4 v[40:43], v245, s[16:19], s48 offen offset:64
    v_accvgpr_read_b32 v48, a56
    v_accvgpr_read_b32 v49, a57
    v_accvgpr_read_b32 v50, a58
    v_accvgpr_read_b32 v51, a59
    v_accvgpr_read_b32 v52, a60
    v_accvgpr_read_b32 v53, a61
    v_accvgpr_read_b32 v54, a62
    v_accvgpr_read_b32 v55, a63
    s_nop 0
    v_mul_f32 v48, v48, v247
    v_mul_f32 v49, v49, v247
    v_mul_f32 v50, v50, v247
    v_mul_f32 v51, v51, v247
    v_mul_f32 v52, v52, v247
    v_mul_f32 v53, v53, v247
    v_mul_f32 v54, v54, v247
    v_mul_f32 v55, v55, v247
    v_cvt_pk_bf16_f32 v56, v48, v49
    v_cvt_pk_bf16_f32 v57, v50, v51
    v_cvt_pk_bf16_f32 v58, v52, v53
    v_cvt_pk_bf16_f32 v59, v54, v55
    s_nop 1
    v_permlane32_swap_b32 v56, v58
    v_permlane32_swap_b32 v57, v59
    s_nop 0
    buffer_store_dwordx4 v[56:59], v245, s[16:19], s48 offen offset:96
    v_accvgpr_read_b32 v0, a80
    v_accvgpr_read_b32 v1, a81
    v_accvgpr_read_b32 v2, a82
    v_accvgpr_read_b32 v3, a83
    v_accvgpr_read_b32 v4, a84
    v_accvgpr_read_b32 v5, a85
    v_accvgpr_read_b32 v6, a86
    v_accvgpr_read_b32 v7, a87
    s_nop 0
    v_mul_f32 v0, v0, v247
    v_mul_f32 v1, v1, v247
    v_mul_f32 v2, v2, v247
    v_mul_f32 v3, v3, v247
    v_mul_f32 v4, v4, v247
    v_mul_f32 v5, v5, v247
    v_mul_f32 v6, v6, v247
    v_mul_f32 v7, v7, v247
    v_cvt_pk_bf16_f32 v8, v0, v1
    v_cvt_pk_bf16_f32 v9, v2, v3
    v_cvt_pk_bf16_f32 v10, v4, v5
    v_cvt_pk_bf16_f32 v11, v6, v7
    s_nop 1
    v_permlane32_swap_b32 v8, v10
    v_permlane32_swap_b32 v9, v11
    s_nop 0
    buffer_store_dwordx4 v[8:11], v245, s[16:19], s48 offen offset:128
    v_accvgpr_read_b32 v16, a88
    v_accvgpr_read_b32 v17, a89
    v_accvgpr_read_b32 v18, a90
    v_accvgpr_read_b32 v19, a91
    v_accvgpr_read_b32 v20, a92
    v_accvgpr_read_b32 v21, a93
    v_accvgpr_read_b32 v22, a94
    v_accvgpr_read_b32 v23, a95
    s_nop 0
    v_mul_f32 v16, v16, v247
    v_mul_f32 v17, v17, v247
    v_mul_f32 v18, v18, v247
    v_mul_f32 v19, v19, v247
    v_mul_f32 v20, v20, v247
    v_mul_f32 v21, v21, v247
    v_mul_f32 v22, v22, v247
    v_mul_f32 v23, v23, v247
    v_cvt_pk_bf16_f32 v24, v16, v17
    v_cvt_pk_bf16_f32 v25, v18, v19
    v_cvt_pk_bf16_f32 v26, v20, v21
    v_cvt_pk_bf16_f32 v27, v22, v23
    s_nop 1
    v_permlane32_swap_b32 v24, v26
    v_permlane32_swap_b32 v25, v27
    s_nop 0
    buffer_store_dwordx4 v[24:27], v245, s[16:19], s48 offen offset:160
    v_accvgpr_read_b32 v32, a112
    v_accvgpr_read_b32 v33, a113
    v_accvgpr_read_b32 v34, a114
    v_accvgpr_read_b32 v35, a115
    v_accvgpr_read_b32 v36, a116
    v_accvgpr_read_b32 v37, a117
    v_accvgpr_read_b32 v38, a118
    v_accvgpr_read_b32 v39, a119
    s_nop 0
    v_mul_f32 v32, v32, v247
    v_mul_f32 v33, v33, v247
    v_mul_f32 v34, v34, v247
    v_mul_f32 v35, v35, v247
    v_mul_f32 v36, v36, v247
    v_mul_f32 v37, v37, v247
    v_mul_f32 v38, v38, v247
    v_mul_f32 v39, v39, v247
    v_cvt_pk_bf16_f32 v40, v32, v33
    v_cvt_pk_bf16_f32 v41, v34, v35
    v_cvt_pk_bf16_f32 v42, v36, v37
    v_cvt_pk_bf16_f32 v43, v38, v39
    s_nop 1
    v_permlane32_swap_b32 v40, v42
    v_permlane32_swap_b32 v41, v43
    s_nop 0
    buffer_store_dwordx4 v[40:43], v245, s[16:19], s48 offen offset:192
    v_accvgpr_read_b32 v48, a120
    v_accvgpr_read_b32 v49, a121
    v_accvgpr_read_b32 v50, a122
    v_accvgpr_read_b32 v51, a123
    v_accvgpr_read_b32 v52, a124
    v_accvgpr_read_b32 v53, a125
    v_accvgpr_read_b32 v54, a126
    v_accvgpr_read_b32 v55, a127
    s_nop 0
    v_mul_f32 v48, v48, v247
    v_mul_f32 v49, v49, v247
    v_mul_f32 v50, v50, v247
    v_mul_f32 v51, v51, v247
    v_mul_f32 v52, v52, v247
    v_mul_f32 v53, v53, v247
    v_mul_f32 v54, v54, v247
    v_mul_f32 v55, v55, v247
    v_cvt_pk_bf16_f32 v56, v48, v49
    v_cvt_pk_bf16_f32 v57, v50, v51
    v_cvt_pk_bf16_f32 v58, v52, v53
    v_cvt_pk_bf16_f32 v59, v54, v55
    s_nop 1
    v_permlane32_swap_b32 v56, v58
    v_permlane32_swap_b32 v57, v59
    s_nop 0
    buffer_store_dwordx4 v[56:59], v245, s[16:19], s48 offen offset:224
L_end:
    s_endpgm
L_rare0:
    s_nop 15
    s_nop 3
    s_waitcnt vmcnt(0) lgkmcnt(0)
    s_add_u32 s46, s35, 8192
    buffer_load_dwordx4 a[192:195], v245, s[8:11], s35 offen
    buffer_load_dwordx4 a[196:199], v245, s[8:11], s35 offen offset:32
    buffer_load_dwordx4 a[200:203], v245, s[8:11], s35 offen offset:64
    buffer_load_dwordx4 a[204:207], v245, s[8:11], s35 offen offset:96
    buffer_load_dwordx4 a[208:211], v245, s[8:11], s35 offen offset:128
    buffer_load_dwordx4 a[212:215], v245, s[8:11], s35 offen offset:160
    buffer_load_dwordx4 a[216:219], v245, s[8:11], s35 offen offset:192
    buffer_load_dwordx4 a[220:223], v245, s[8:11], s35 offen offset:224
    buffer_load_dwordx4 a[224:227], v245, s[8:11], s46 offen
    buffer_load_dwordx4 a[228:231], v245, s[8:11], s46 offen offset:32
    buffer_load_dwordx4 a[232:235], v245, s[8:11], s46 offen offset:64
    buffer_load_dwordx4 a[236:239], v245, s[8:11], s46 offen offset:96
    buffer_load_dwordx4 a[240:243], v245, s[8:11], s46 offen offset:128
    buffer_load_dwordx4 a[244:247], v245, s[8:11], s46 offen offset:160
    buffer_load_dwordx4 a[248:251], v245, s[8:11], s46 offen offset:192
    buffer_load_dwordx4 a[252:255], v245, s[8:11], s46 offen offset:224
    s_waitcnt vmcnt(0)
    s_nop 1
    v_mfma_f32_32x32x16_bf16 v[64:79], a[192:195], a[128:131], v[192:207]
    v_mfma_f32_32x32x16_bf16 v[80:95], a[192:195], a[160:163], v[208:223]
    v_mfma_f32_32x32x16_bf16 v[64:79], a[196:199], a[132:135], v[64:79]
    v_mfma_f32_32x32x16_bf16 v[80:95], a[196:199], a[164:167], v[80:95]
    v_mfma_f32_32x32x16_bf16 v[64:79], a[200:203], a[136:139], v[64:79]
    v_mfma_f32_32x32x16_bf16 v[80:95], a[200:203], a[168:171], v[80:95]
    v_mfma_f32_32x32x16_bf16 v[64:79], a[204:207], a[140:143], v[64:79]
    v_mfma_f32_32x32x16_bf16 v[80:95], a[204:207], a[172:175], v[80:95]
    v_mfma_f32_32x32x16_bf16 v[64:79], a[208:211], a[144:147], v[64:79]
    v_mfma_f32_32x32x16_bf16 v[80:95], a[208:211], a[176:179], v[80:95]
    v_mfma_f32_32x32x16_bf16 v[64:79], a[212:215], a[148:151], v[64:79]
    v_mfma_f32_32x32x16_bf16 v[80:95], a[212:215], a[180:183], v[80:95]
    v_mfma_f32_32x32x16_bf16 v[64:79], a[216:219], a[152:155], v[64:79]
    v_mfma_f32_32x32x16_bf16 v[80:95], a[216:219], a[184:187], v[80:95]
    v_mfma_f32_32x32x16_bf16 v[64:79], a[220:223], a[156:159], v[64:79]
    v_mfma_f32_32x32x16_bf16 v[80:95], a[220:223], a[188:191], v[80:95]
    v_mfma_f32_32x32x16_bf16 v[96:111], a[224:227], a[128:131], v[192:207]
    v_mfma_f32_32x32x16_bf16 v[112:127], a[224:227], a[160:163], v[208:223]
    v_mfma_f32_32x32x16_bf16 v[96:111], a[228:231], a[132:135], v[96:111]
    v_mfma_f32_32x32x16_bf16 v[112:127], a[228:231], a[164:167], v[112:127]
    v_mfma_f32_32x32x16_bf16 v[96:111], a[232:235], a[136:139], v[96:111]
    v_mfma_f32_32x32x16_bf16 v[112:127], a[232:235], a[168:171], v[112:127]
    v_mfma_f32_32x32x16_bf16 v[96:111], a[236:239], a[140:143], v[96:111]
    v_mfma_f32_32x32x16_bf16 v[112:127], a[236:239], a[172:175], v[112:127]
    v_mfma_f32_32x32x16_bf16 v[96:111], a[240:243], a[144:147], v[96:111]
    v_mfma_f32_32x32x16_bf16 v[112:127], a[240:243], a[176:179], v[112:127]
    v_mfma_f32_32x32x16_bf16 v[96:111], a[244:247], a[148:151], v[96:111]
    v_mfma_f32_32x32x16_bf16 v[112:127], a[244:247], a[180:183], v[112:127]
    v_mfma_f32_32x32x16_bf16 v[96:111], a[248:251], a[152:155], v[96:111]
    v_mfma_f32_32x32x16_bf16 v[112:127], a[248:251], a[184:187], v[112:127]
    v_mfma_f32_32x32x16_bf16 v[96:111], a[252:255], a[156:159], v[96:111]
    v_mfma_f32_32x32x16_bf16 v[112:127], a[252:255], a[188:191], v[112:127]
    s_nop 15
    s_nop 3
    v_max3_f32 v246, v64, v65, v66
    v_max3_f32 v246, v246, v67, v68
    v_max3_f32 v246, v246, v69, v70
    v_max3_f32 v246, v246, v71, v72
    v_max3_f32 v246, v246, v73, v74
    v_max3_f32 v246, v246, v75, v76
    v_max3_f32 v246, v246, v77, v78
    v_max3_f32 v246, v246, v79, v96
    v_max3_f32 v246, v246, v97, v98
    v_max3_f32 v246, v246, v99, v100
    v_max3_f32 v246, v246, v101, v102
    v_max3_f32 v246, v246, v103, v104
    v_max3_f32 v246, v246, v105, v106
    v_max3_f32 v246, v246, v107, v108
    v_max3_f32 v246, v246, v109, v110
    v_max_f32 v246, v246, v111
    v_mov_b32 v248, v246
    v_mov_b32 v249, v246
    s_nop 1
    v_permlane32_swap_b32 v248, v249
    s_nop 1
    v_max_f32 v246, v248, v249
    v_max_f32 v246, 0, v246
    v_max3_f32 v247, v80, v81, v82
    v_max3_f32 v247, v247, v83, v84
    v_max3_f32 v247, v247, v85, v86
    v_max3_f32 v247, v247, v87, v88
    v_max3_f32 v247, v247, v89, v90
    v_max3_f32 v247, v247, v91, v92
    v_max3_f32 v247, v247, v93, v94
    v_max3_f32 v247, v247, v95, v112
    v_max3_f32 v247, v247, v113, v114
    v_max3_f32 v247, v247, v115, v116
    v_max3_f32 v247, v247, v117, v118
    v_max3_f32 v247, v247, v119, v120
    v_max3_f32 v247, v247, v121, v122
    v_max3_f32 v247, v247, v123, v124
    v_max3_f32 v247, v247, v125, v126
    v_max_f32 v247, v247, v127
    v_mov_b32 v248, v247
    v_mov_b32 v249, v247
    s_nop 1
    v_permlane32_swap_b32 v248, v249
    s_nop 1
    v_max_f32 v247, v248, v249
    v_max_f32 v247, 0, v247
    v_exp_f32_e64 v250, -v246
    v_exp_f32_e64 v251, -v247
    s_nop 1
    v_mul_f32 v241, v241, v250
    v_mul_f32 v242, v242, v251
    v_accvgpr_read_b32 v252, a0
    s_nop 0
    v_mul_f32 v252, v252, v250
    s_nop 0
    v_accvgpr_write_b32 a0, v252
    v_accvgpr_read_b32 v253, a1
    s_nop 0
    v_mul_f32 v253, v253, v250
    s_nop 0
    v_accvgpr_write_b32 a1, v253
    v_accvgpr_read_b32 v254, a2
    s_nop 0
    v_mul_f32 v254, v254, v250
    s_nop 0
    v_accvgpr_write_b32 a2, v254
    v_accvgpr_read_b32 v255, a3
    s_nop 0
    v_mul_f32 v255, v255, v250
    s_nop 0
    v_accvgpr_write_b32 a3, v255
    v_accvgpr_read_b32 v252, a4
    s_nop 0
    v_mul_f32 v252, v252, v250
    s_nop 0
    v_accvgpr_write_b32 a4, v252
    v_accvgpr_read_b32 v253, a5
    s_nop 0
    v_mul_f32 v253, v253, v250
    s_nop 0
    v_accvgpr_write_b32 a5, v253
    v_accvgpr_read_b32 v254, a6
    s_nop 0
    v_mul_f32 v254, v254, v250
    s_nop 0
    v_accvgpr_write_b32 a6, v254
    v_accvgpr_read_b32 v255, a7
    s_nop 0
    v_mul_f32 v255, v255, v250
    s_nop 0
    v_accvgpr_write_b32 a7, v255
    v_accvgpr_read_b32 v252, a8
    s_nop 0
    v_mul_f32 v252, v252, v250
    s_nop 0
    v_accvgpr_write_b32 a8, v252
    v_accvgpr_read_b32 v253, a9
    s_nop 0
    v_mul_f32 v253, v253, v250
    s_nop 0
    v_accvgpr_write_b32 a9, v253
    v_accvgpr_read_b32 v254, a10
    s_nop 0
    v_mul_f32 v254, v254, v250
    s_nop 0
    v_accvgpr_write_b32 a10, v254
    v_accvgpr_read_b32 v255, a11
    s_nop 0
    v_mul_f32 v255, v255, v250
    s_nop 0
    v_accvgpr_write_b32 a11, v255
    v_accvgpr_read_b32 v252, a12
    s_nop 0
    v_mul_f32 v252, v252, v250
    s_nop 0
    v_accvgpr_write_b32 a12, v252
    v_accvgpr_read_b32 v253, a13
    s_nop 0
    v_mul_f32 v253, v253, v250
    s_nop 0
    v_accvgpr_write_b32 a13, v253
    v_accvgpr_read_b32 v254, a14
    s_nop 0
    v_mul_f32 v254, v254, v250
    s_nop 0
    v_accvgpr_write_b32 a14, v254
    v_accvgpr_read_b32 v255, a15
    s_nop 0
    v_mul_f32 v255, v255, v250
    s_nop 0
    v_accvgpr_write_b32 a15, v255
    v_accvgpr_read_b32 v252, a16
    s_nop 0
    v_mul_f32 v252, v252, v251
    s_nop 0
    v_accvgpr_write_b32 a16, v252
    v_accvgpr_read_b32 v253, a17
    s_nop 0
    v_mul_f32 v253, v253, v251
    s_nop 0
    v_accvgpr_write_b32 a17, v253
    v_accvgpr_read_b32 v254, a18
    s_nop 0
    v_mul_f32 v254, v254, v251
    s_nop 0
    v_accvgpr_write_b32 a18, v254
    v_accvgpr_read_b32 v255, a19
    s_nop 0
    v_mul_f32 v255, v255, v251
    s_nop 0
    v_accvgpr_write_b32 a19, v255
    v_accvgpr_read_b32 v252, a20
    s_nop 0
    v_mul_f32 v252, v252, v251
    s_nop 0
    v_accvgpr_write_b32 a20, v252
    v_accvgpr_read_b32 v253, a21
    s_nop 0
    v_mul_f32 v253, v253, v251
    s_nop 0
    v_accvgpr_write_b32 a21, v253
    v_accvgpr_read_b32 v254, a22
    s_nop 0
    v_mul_f32 v254, v254, v251
    s_nop 0
    v_accvgpr_write_b32 a22, v254
    v_accvgpr_read_b32 v255, a23
    s_nop 0
    v_mul_f32 v255, v255, v251
    s_nop 0
    v_accvgpr_write_b32 a23, v255
    v_accvgpr_read_b32 v252, a24
    s_nop 0
    v_mul_f32 v252, v252, v251
    s_nop 0
    v_accvgpr_write_b32 a24, v252
    v_accvgpr_read_b32 v253, a25
    s_nop 0
    v_mul_f32 v253, v253, v251
    s_nop 0
    v_accvgpr_write_b32 a25, v253
    v_accvgpr_read_b32 v254, a26
    s_nop 0
    v_mul_f32 v254, v254, v251
    s_nop 0
    v_accvgpr_write_b32 a26, v254
    v_accvgpr_read_b32 v255, a27
    s_nop 0
    v_mul_f32 v255, v255, v251
    s_nop 0
    v_accvgpr_write_b32 a27, v255
    v_accvgpr_read_b32 v252, a28
    s_nop 0
    v_mul_f32 v252, v252, v251
    s_nop 0
    v_accvgpr_write_b32 a28, v252
    v_accvgpr_read_b32 v253, a29
    s_nop 0
    v_mul_f32 v253, v253, v251
    s_nop 0
    v_accvgpr_write_b32 a29, v253
    v_accvgpr_read_b32 v254, a30
    s_nop 0
    v_mul_f32 v254, v254, v251
    s_nop 0
    v_accvgpr_write_b32 a30, v254
    v_accvgpr_read_b32 v255, a31
    s_nop 0
    v_mul_f32 v255, v255, v251
    s_nop 0
    v_accvgpr_write_b32 a31, v255
    v_accvgpr_read_b32 v252, a32
    s_nop 0
    v_mul_f32 v252, v252, v250
    s_nop 0
    v_accvgpr_write_b32 a32, v252
    v_accvgpr_read_b32 v253, a33
    s_nop 0
    v_mul_f32 v253, v253, v250
    s_nop 0
    v_accvgpr_write_b32 a33, v253
    v_accvgpr_read_b32 v254, a34
    s_nop 0
    v_mul_f32 v254, v254, v250
    s_nop 0
    v_accvgpr_write_b32 a34, v254
    v_accvgpr_read_b32 v255, a35
    s_nop 0
    v_mul_f32 v255, v255, v250
    s_nop 0
    v_accvgpr_write_b32 a35, v255
    v_accvgpr_read_b32 v252, a36
    s_nop 0
    v_mul_f32 v252, v252, v250
    s_nop 0
    v_accvgpr_write_b32 a36, v252
    v_accvgpr_read_b32 v253, a37
    s_nop 0
    v_mul_f32 v253, v253, v250
    s_nop 0
    v_accvgpr_write_b32 a37, v253
    v_accvgpr_read_b32 v254, a38
    s_nop 0
    v_mul_f32 v254, v254, v250
    s_nop 0
    v_accvgpr_write_b32 a38, v254
    v_accvgpr_read_b32 v255, a39
    s_nop 0
    v_mul_f32 v255, v255, v250
    s_nop 0
    v_accvgpr_write_b32 a39, v255
    v_accvgpr_read_b32 v252, a40
    s_nop 0
    v_mul_f32 v252, v252, v250
    s_nop 0
    v_accvgpr_write_b32 a40, v252
    v_accvgpr_read_b32 v253, a41
    s_nop 0
    v_mul_f32 v253, v253, v250
    s_nop 0
    v_accvgpr_write_b32 a41, v253
    v_accvgpr_read_b32 v254, a42
    s_nop 0
    v_mul_f32 v254, v254, v250
    s_nop 0
    v_accvgpr_write_b32 a42, v254
    v_accvgpr_read_b32 v255, a43
    s_nop 0
    v_mul_f32 v255, v255, v250
    s_nop 0
    v_accvgpr_write_b32 a43, v255
    v_accvgpr_read_b32 v252, a44
    s_nop 0
    v_mul_f32 v252, v252, v250
    s_nop 0
    v_accvgpr_write_b32 a44, v252
    v_accvgpr_read_b32 v253, a45
    s_nop 0
    v_mul_f32 v253, v253, v250
    s_nop 0
    v_accvgpr_write_b32 a45, v253
    v_accvgpr_read_b32 v254, a46
    s_nop 0
    v_mul_f32 v254, v254, v250
    s_nop 0
    v_accvgpr_write_b32 a46, v254
    v_accvgpr_read_b32 v255, a47
    s_nop 0
    v_mul_f32 v255, v255, v250
    s_nop 0
    v_accvgpr_write_b32 a47, v255
    v_accvgpr_read_b32 v252, a48
    s_nop 0
    v_mul_f32 v252, v252, v251
    s_nop 0
    v_accvgpr_write_b32 a48, v252
    v_accvgpr_read_b32 v253, a49
    s_nop 0
    v_mul_f32 v253, v253, v251
    s_nop 0
    v_accvgpr_write_b32 a49, v253
    v_accvgpr_read_b32 v254, a50
    s_nop 0
    v_mul_f32 v254, v254, v251
    s_nop 0
    v_accvgpr_write_b32 a50, v254
    v_accvgpr_read_b32 v255, a51
    s_nop 0
    v_mul_f32 v255, v255, v251
    s_nop 0
    v_accvgpr_write_b32 a51, v255
    v_accvgpr_read_b32 v252, a52
    s_nop 0
    v_mul_f32 v252, v252, v251
    s_nop 0
    v_accvgpr_write_b32 a52, v252
    v_accvgpr_read_b32 v253, a53
    s_nop 0
    v_mul_f32 v253, v253, v251
    s_nop 0
    v_accvgpr_write_b32 a53, v253
    v_accvgpr_read_b32 v254, a54
    s_nop 0
    v_mul_f32 v254, v254, v251
    s_nop 0
    v_accvgpr_write_b32 a54, v254
    v_accvgpr_read_b32 v255, a55
    s_nop 0
    v_mul_f32 v255, v255, v251
    s_nop 0
    v_accvgpr_write_b32 a55, v255
    v_accvgpr_read_b32 v252, a56
    s_nop 0
    v_mul_f32 v252, v252, v251
    s_nop 0
    v_accvgpr_write_b32 a56, v252
    v_accvgpr_read_b32 v253, a57
    s_nop 0
    v_mul_f32 v253, v253, v251
    s_nop 0
    v_accvgpr_write_b32 a57, v253
    v_accvgpr_read_b32 v254, a58
    s_nop 0
    v_mul_f32 v254, v254, v251
    s_nop 0
    v_accvgpr_write_b32 a58, v254
    v_accvgpr_read_b32 v255, a59
    s_nop 0
    v_mul_f32 v255, v255, v251
    s_nop 0
    v_accvgpr_write_b32 a59, v255
    v_accvgpr_read_b32 v252, a60
    s_nop 0
    v_mul_f32 v252, v252, v251
    s_nop 0
    v_accvgpr_write_b32 a60, v252
    v_accvgpr_read_b32 v253, a61
    s_nop 0
    v_mul_f32 v253, v253, v251
    s_nop 0
    v_accvgpr_write_b32 a61, v253
    v_accvgpr_read_b32 v254, a62
    s_nop 0
    v_mul_f32 v254, v254, v251
    s_nop 0
    v_accvgpr_write_b32 a62, v254
    v_accvgpr_read_b32 v255, a63
    s_nop 0
    v_mul_f32 v255, v255, v251
    s_nop 0
    v_accvgpr_write_b32 a63, v255
    v_accvgpr_read_b32 v252, a64
    s_nop 0
    v_mul_f32 v252, v252, v250
    s_nop 0
    v_accvgpr_write_b32 a64, v252
    v_accvgpr_read_b32 v253, a65
    s_nop 0
    v_mul_f32 v253, v253, v250
    s_nop 0
    v_accvgpr_write_b32 a65, v253
    v_accvgpr_read_b32 v254, a66
    s_nop 0
    v_mul_f32 v254, v254, v250
    s_nop 0
    v_accvgpr_write_b32 a66, v254
    v_accvgpr_read_b32 v255, a67
    s_nop 0
    v_mul_f32 v255, v255, v250
    s_nop 0
    v_accvgpr_write_b32 a67, v255
    v_accvgpr_read_b32 v252, a68
    s_nop 0
    v_mul_f32 v252, v252, v250
    s_nop 0
    v_accvgpr_write_b32 a68, v252
    v_accvgpr_read_b32 v253, a69
    s_nop 0
    v_mul_f32 v253, v253, v250
    s_nop 0
    v_accvgpr_write_b32 a69, v253
    v_accvgpr_read_b32 v254, a70
    s_nop 0
    v_mul_f32 v254, v254, v250
    s_nop 0
    v_accvgpr_write_b32 a70, v254
    v_accvgpr_read_b32 v255, a71
    s_nop 0
    v_mul_f32 v255, v255, v250
    s_nop 0
    v_accvgpr_write_b32 a71, v255
    v_accvgpr_read_b32 v252, a72
    s_nop 0
    v_mul_f32 v252, v252, v250
    s_nop 0
    v_accvgpr_write_b32 a72, v252
    v_accvgpr_read_b32 v253, a73
    s_nop 0
    v_mul_f32 v253, v253, v250
    s_nop 0
    v_accvgpr_write_b32 a73, v253
    v_accvgpr_read_b32 v254, a74
    s_nop 0
    v_mul_f32 v254, v254, v250
    s_nop 0
    v_accvgpr_write_b32 a74, v254
    v_accvgpr_read_b32 v255, a75
    s_nop 0
    v_mul_f32 v255, v255, v250
    s_nop 0
    v_accvgpr_write_b32 a75, v255
    v_accvgpr_read_b32 v252, a76
    s_nop 0
    v_mul_f32 v252, v252, v250
    s_nop 0
    v_accvgpr_write_b32 a76, v252
    v_accvgpr_read_b32 v253, a77
    s_nop 0
    v_mul_f32 v253, v253, v250
    s_nop 0
    v_accvgpr_write_b32 a77, v253
    v_accvgpr_read_b32 v254, a78
    s_nop 0
    v_mul_f32 v254, v254, v250
    s_nop 0
    v_accvgpr_write_b32 a78, v254
    v_accvgpr_read_b32 v255, a79
    s_nop 0
    v_mul_f32 v255, v255, v250
    s_nop 0
    v_accvgpr_write_b32 a79, v255
    v_accvgpr_read_b32 v252, a80
    s_nop 0
    v_mul_f32 v252, v252, v251
    s_nop 0
    v_accvgpr_write_b32 a80, v252
    v_accvgpr_read_b32 v253, a81
    s_nop 0
    v_mul_f32 v253, v253, v251
    s_nop 0
    v_accvgpr_write_b32 a81, v253
    v_accvgpr_read_b32 v254, a82
    s_nop 0
    v_mul_f32 v254, v254, v251
    s_nop 0
    v_accvgpr_write_b32 a82, v254
    v_accvgpr_read_b32 v255, a83
    s_nop 0
    v_mul_f32 v255, v255, v251
    s_nop 0
    v_accvgpr_write_b32 a83, v255
    v_accvgpr_read_b32 v252, a84
    s_nop 0
    v_mul_f32 v252, v252, v251
    s_nop 0
    v_accvgpr_write_b32 a84, v252
    v_accvgpr_read_b32 v253, a85
    s_nop 0
    v_mul_f32 v253, v253, v251
    s_nop 0
    v_accvgpr_write_b32 a85, v253
    v_accvgpr_read_b32 v254, a86
    s_nop 0
    v_mul_f32 v254, v254, v251
    s_nop 0
    v_accvgpr_write_b32 a86, v254
    v_accvgpr_read_b32 v255, a87
    s_nop 0
    v_mul_f32 v255, v255, v251
    s_nop 0
    v_accvgpr_write_b32 a87, v255
    v_accvgpr_read_b32 v252, a88
    s_nop 0
    v_mul_f32 v252, v252, v251
    s_nop 0
    v_accvgpr_write_b32 a88, v252
    v_accvgpr_read_b32 v253, a89
    s_nop 0
    v_mul_f32 v253, v253, v251
    s_nop 0
    v_accvgpr_write_b32 a89, v253
    v_accvgpr_read_b32 v254, a90
    s_nop 0
    v_mul_f32 v254, v254, v251
    s_nop 0
    v_accvgpr_write_b32 a90, v254
    v_accvgpr_read_b32 v255, a91
    s_nop 0
    v_mul_f32 v255, v255, v251
    s_nop 0
    v_accvgpr_write_b32 a91, v255
    v_accvgpr_read_b32 v252, a92
    s_nop 0
    v_mul_f32 v252, v252, v251
    s_nop 0
    v_accvgpr_write_b32 a92, v252
    v_accvgpr_read_b32 v253, a93
    s_nop 0
    v_mul_f32 v253, v253, v251
    s_nop 0
    v_accvgpr_write_b32 a93, v253
    v_accvgpr_read_b32 v254, a94
    s_nop 0
    v_mul_f32 v254, v254, v251
    s_nop 0
    v_accvgpr_write_b32 a94, v254
    v_accvgpr_read_b32 v255, a95
    s_nop 0
    v_mul_f32 v255, v255, v251
    s_nop 0
    v_accvgpr_write_b32 a95, v255
    v_accvgpr_read_b32 v252, a96
    s_nop 0
    v_mul_f32 v252, v252, v250
    s_nop 0
    v_accvgpr_write_b32 a96, v252
    v_accvgpr_read_b32 v253, a97
    s_nop 0
    v_mul_f32 v253, v253, v250
    s_nop 0
    v_accvgpr_write_b32 a97, v253
    v_accvgpr_read_b32 v254, a98
    s_nop 0
    v_mul_f32 v254, v254, v250
    s_nop 0
    v_accvgpr_write_b32 a98, v254
    v_accvgpr_read_b32 v255, a99
    s_nop 0
    v_mul_f32 v255, v255, v250
    s_nop 0
    v_accvgpr_write_b32 a99, v255
    v_accvgpr_read_b32 v252, a100
    s_nop 0
    v_mul_f32 v252, v252, v250
    s_nop 0
    v_accvgpr_write_b32 a100, v252
    v_accvgpr_read_b32 v253, a101
    s_nop 0
    v_mul_f32 v253, v253, v250
    s_nop 0
    v_accvgpr_write_b32 a101, v253
    v_accvgpr_read_b32 v254, a102
    s_nop 0
    v_mul_f32 v254, v254, v250
    s_nop 0
    v_accvgpr_write_b32 a102, v254
    v_accvgpr_read_b32 v255, a103
    s_nop 0
    v_mul_f32 v255, v255, v250
    s_nop 0
    v_accvgpr_write_b32 a103, v255
    v_accvgpr_read_b32 v252, a104
    s_nop 0
    v_mul_f32 v252, v252, v250
    s_nop 0
    v_accvgpr_write_b32 a104, v252
    v_accvgpr_read_b32 v253, a105
    s_nop 0
    v_mul_f32 v253, v253, v250
    s_nop 0
    v_accvgpr_write_b32 a105, v253
    v_accvgpr_read_b32 v254, a106
    s_nop 0
    v_mul_f32 v254, v254, v250
    s_nop 0
    v_accvgpr_write_b32 a106, v254
    v_accvgpr_read_b32 v255, a107
    s_nop 0
    v_mul_f32 v255, v255, v250
    s_nop 0
    v_accvgpr_write_b32 a107, v255
    v_accvgpr_read_b32 v252, a108
    s_nop 0
    v_mul_f32 v252, v252, v250
    s_nop 0
    v_accvgpr_write_b32 a108, v252
    v_accvgpr_read_b32 v253, a109
    s_nop 0
    v_mul_f32 v253, v253, v250
    s_nop 0
    v_accvgpr_write_b32 a109, v253
    v_accvgpr_read_b32 v254, a110
    s_nop 0
    v_mul_f32 v254, v254, v250
    s_nop 0
    v_accvgpr_write_b32 a110, v254
    v_accvgpr_read_b32 v255, a111
    s_nop 0
    v_mul_f32 v255, v255, v250
    s_nop 0
    v_accvgpr_write_b32 a111, v255
    v_accvgpr_read_b32 v252, a112
    s_nop 0
    v_mul_f32 v252, v252, v251
    s_nop 0
    v_accvgpr_write_b32 a112, v252
    v_accvgpr_read_b32 v253, a113
    s_nop 0
    v_mul_f32 v253, v253, v251
    s_nop 0
    v_accvgpr_write_b32 a113, v253
    v_accvgpr_read_b32 v254, a114
    s_nop 0
    v_mul_f32 v254, v254, v251
    s_nop 0
    v_accvgpr_write_b32 a114, v254
    v_accvgpr_read_b32 v255, a115
    s_nop 0
    v_mul_f32 v255, v255, v251
    s_nop 0
    v_accvgpr_write_b32 a115, v255
    v_accvgpr_read_b32 v252, a116
    s_nop 0
    v_mul_f32 v252, v252, v251
    s_nop 0
    v_accvgpr_write_b32 a116, v252
    v_accvgpr_read_b32 v253, a117
    s_nop 0
    v_mul_f32 v253, v253, v251
    s_nop 0
    v_accvgpr_write_b32 a117, v253
    v_accvgpr_read_b32 v254, a118
    s_nop 0
    v_mul_f32 v254, v254, v251
    s_nop 0
    v_accvgpr_write_b32 a118, v254
    v_accvgpr_read_b32 v255, a119
    s_nop 0
    v_mul_f32 v255, v255, v251
    s_nop 0
    v_accvgpr_write_b32 a119, v255
    v_accvgpr_read_b32 v252, a120
    s_nop 0
    v_mul_f32 v252, v252, v251
    s_nop 0
    v_accvgpr_write_b32 a120, v252
    v_accvgpr_read_b32 v253, a121
    s_nop 0
    v_mul_f32 v253, v253, v251
    s_nop 0
    v_accvgpr_write_b32 a121, v253
    v_accvgpr_read_b32 v254, a122
    s_nop 0
    v_mul_f32 v254, v254, v251
    s_nop 0
    v_accvgpr_write_b32 a122, v254
    v_accvgpr_read_b32 v255, a123
    s_nop 0
    v_mul_f32 v255, v255, v251
    s_nop 0
    v_accvgpr_write_b32 a123, v255
    v_accvgpr_read_b32 v252, a124
    s_nop 0
    v_mul_f32 v252, v252, v251
    s_nop 0
    v_accvgpr_write_b32 a124, v252
    v_accvgpr_read_b32 v253, a125
    s_nop 0
    v_mul_f32 v253, v253, v251
    s_nop 0
    v_accvgpr_write_b32 a125, v253
    v_accvgpr_read_b32 v254, a126
    s_nop 0
    v_mul_f32 v254, v254, v251
    s_nop 0
    v_accvgpr_write_b32 a126, v254
    v_accvgpr_read_b32 v255, a127
    s_nop 0
    v_mul_f32 v255, v255, v251
    s_nop 0
    v_accvgpr_write_b32 a127, v255
    v_sub_f32 v192, v192, v246
    v_sub_f32 v193, v193, v246
    v_sub_f32 v194, v194, v246
    v_sub_f32 v195, v195, v246
    v_sub_f32 v196, v196, v246
    v_sub_f32 v197, v197, v246
    v_sub_f32 v198, v198, v246
    v_sub_f32 v199, v199, v246
    v_sub_f32 v200, v200, v246
    v_sub_f32 v201, v201, v246
    v_sub_f32 v202, v202, v246
    v_sub_f32 v203, v203, v246
    v_sub_f32 v204, v204, v246
    v_sub_f32 v205, v205, v246
    v_sub_f32 v206, v206, v246
    v_sub_f32 v207, v207, v246
    v_sub_f32 v208, v208, v247
    v_sub_f32 v209, v209, v247
    v_sub_f32 v210, v210, v247
    v_sub_f32 v211, v211, v247
    v_sub_f32 v212, v212, v247
    v_sub_f32 v213, v213, v247
    v_sub_f32 v214, v214, v247
    v_sub_f32 v215, v215, v247
    v_sub_f32 v216, v216, v247
    v_sub_f32 v217, v217, v247
    v_sub_f32 v218, v218, v247
    v_sub_f32 v219, v219, v247
    v_sub_f32 v220, v220, v247
    v_sub_f32 v221, v221, v247
    v_sub_f32 v222, v222, v247
    v_sub_f32 v223, v223, v247
    v_sub_f32 v64, v64, v246
    v_sub_f32 v65, v65, v246
    v_sub_f32 v66, v66, v246
    v_sub_f32 v67, v67, v246
    v_sub_f32 v68, v68, v246
    v_sub_f32 v69, v69, v246
    v_sub_f32 v70, v70, v246
    v_sub_f32 v71, v71, v246
    v_sub_f32 v72, v72, v246
    v_sub_f32 v73, v73, v246
    v_sub_f32 v74, v74, v246
    v_sub_f32 v75, v75, v246
    v_sub_f32 v76, v76, v246
    v_sub_f32 v77, v77, v246
    v_sub_f32 v78, v78, v246
    v_sub_f32 v79, v79, v246
    v_sub_f32 v80, v80, v247
    v_sub_f32 v81, v81, v247
    v_sub_f32 v82, v82, v247
    v_sub_f32 v83, v83, v247
    v_sub_f32 v84, v84, v247
    v_sub_f32 v85, v85, v247
    v_sub_f32 v86, v86, v247
    v_sub_f32 v87, v87, v247
    v_sub_f32 v88, v88, v247
    v_sub_f32 v89, v89, v247
    v_sub_f32 v90, v90, v247
    v_sub_f32 v91, v91, v247
    v_sub_f32 v92, v92, v247
    v_sub_f32 v93, v93, v247
    v_sub_f32 v94, v94, v247
    v_sub_f32 v95, v95, v247
    v_sub_f32 v96, v96, v246
    v_sub_f32 v97, v97, v246
    v_sub_f32 v98, v98, v246
    v_sub_f32 v99, v99, v246
    v_sub_f32 v100, v100, v246
    v_sub_f32 v101, v101, v246
    v_sub_f32 v102, v102, v246
    v_sub_f32 v103, v103, v246
    v_sub_f32 v104, v104, v246
    v_sub_f32 v105, v105, v246
    v_sub_f32 v106, v106, v246
    v_sub_f32 v107, v107, v246
    v_sub_f32 v108, v108, v246
    v_sub_f32 v109, v109, v246
    v_sub_f32 v110, v110, v246
    v_sub_f32 v111, v111, v246
    v_sub_f32 v112, v112, v247
    v_sub_f32 v113, v113, v247
    v_sub_f32 v114, v114, v247
    v_sub_f32 v115, v115, v247
    v_sub_f32 v116, v116, v247
    v_sub_f32 v117, v117, v247
    v_sub_f32 v118, v118, v247
    v_sub_f32 v119, v119, v247
    v_sub_f32 v120, v120, v247
    v_sub_f32 v121, v121, v247
    v_sub_f32 v122, v122, v247
    v_sub_f32 v123, v123, v247
    v_sub_f32 v124, v124, v247
    v_sub_f32 v125, v125, v247
    v_sub_f32 v126, v126, v247
    v_sub_f32 v127, v127, v247
    v_exp_f32 v64, v64
    v_exp_f32 v65, v65
    v_exp_f32 v66, v66
    v_exp_f32 v67, v67
    v_exp_f32 v68, v68
    v_exp_f32 v69, v69
    v_exp_f32 v70, v70
    v_exp_f32 v71, v71
    v_exp_f32 v72, v72
    v_exp_f32 v73, v73
    v_exp_f32 v74, v74
    v_exp_f32 v75, v75
    v_exp_f32 v76, v76
    v_exp_f32 v77, v77
    v_exp_f32 v78, v78
    v_exp_f32 v79, v79
    v_exp_f32 v80, v80
    v_exp_f32 v81, v81
    v_exp_f32 v82, v82
    v_exp_f32 v83, v83
    v_exp_f32 v84, v84
    v_exp_f32 v85, v85
    v_exp_f32 v86, v86
    v_exp_f32 v87, v87
    v_exp_f32 v88, v88
    v_exp_f32 v89, v89
    v_exp_f32 v90, v90
    v_exp_f32 v91, v91
    v_exp_f32 v92, v92
    v_exp_f32 v93, v93
    v_exp_f32 v94, v94
    v_exp_f32 v95, v95
    v_exp_f32 v96, v96
    v_exp_f32 v97, v97
    v_exp_f32 v98, v98
    v_exp_f32 v99, v99
    v_exp_f32 v100, v100
    v_exp_f32 v101, v101
    v_exp_f32 v102, v102
    v_exp_f32 v103, v103
    v_exp_f32 v104, v104
    v_exp_f32 v105, v105
    v_exp_f32 v106, v106
    v_exp_f32 v107, v107
    v_exp_f32 v108, v108
    v_exp_f32 v109, v109
    v_exp_f32 v110, v110
    v_exp_f32 v111, v111
    v_exp_f32 v112, v112
    v_exp_f32 v113, v113
    v_exp_f32 v114, v114
    v_exp_f32 v115, v115
    v_exp_f32 v116, v116
    v_exp_f32 v117, v117
    v_exp_f32 v118, v118
    v_exp_f32 v119, v119
    v_exp_f32 v120, v120
    v_exp_f32 v121, v121
    v_exp_f32 v122, v122
    v_exp_f32 v123, v123
    v_exp_f32 v124, v124
    v_exp_f32 v125, v125
    v_exp_f32 v126, v126
    v_exp_f32 v127, v127
    s_nop 0
    v_add_f32 v243, v64, v65
    v_add_f32 v243, v243, v66
    v_add_f32 v243, v243, v67
    v_add_f32 v243, v243, v68
    v_add_f32 v243, v243, v69
    v_add_f32 v243, v243, v70
    v_add_f32 v243, v243, v71
    v_add_f32 v243, v243, v72
    v_add_f32 v243, v243, v73
    v_add_f32 v243, v243, v74
    v_add_f32 v243, v243, v75
    v_add_f32 v243, v243, v76
    v_add_f32 v243, v243, v77
    v_add_f32 v243, v243, v78
    v_add_f32 v243, v243, v79
    v_add_f32 v243, v243, v96
    v_add_f32 v243, v243, v97
    v_add_f32 v243, v243, v98
    v_add_f32 v243, v243, v99
    v_add_f32 v243, v243, v100
    v_add_f32 v243, v243, v101
    v_add_f32 v243, v243, v102
    v_add_f32 v243, v243, v103
    v_add_f32 v243, v243, v104
    v_add_f32 v243, v243, v105
    v_add_f32 v243, v243, v106
    v_add_f32 v243, v243, v107
    v_add_f32 v243, v243, v108
    v_add_f32 v243, v243, v109
    v_add_f32 v243, v243, v110
    v_add_f32 v243, v243, v111
    v_add_f32 v244, v80, v81
    v_add_f32 v244, v244, v82
    v_add_f32 v244, v244, v83
    v_add_f32 v244, v244, v84
    v_add_f32 v244, v244, v85
    v_add_f32 v244, v244, v86
    v_add_f32 v244, v244, v87
    v_add_f32 v244, v244, v88
    v_add_f32 v244, v244, v89
    v_add_f32 v244, v244, v90
    v_add_f32 v244, v244, v91
    v_add_f32 v244, v244, v92
    v_add_f32 v244, v244, v93
    v_add_f32 v244, v244, v94
    v_add_f32 v244, v244, v95
    v_add_f32 v244, v244, v112
    v_add_f32 v244, v244, v113
    v_add_f32 v244, v244, v114
    v_add_f32 v244, v244, v115
    v_add_f32 v244, v244, v116
    v_add_f32 v244, v244, v117
    v_add_f32 v244, v244, v118
    v_add_f32 v244, v244, v119
    v_add_f32 v244, v244, v120
    v_add_f32 v244, v244, v121
    v_add_f32 v244, v244, v122
    v_add_f32 v244, v244, v123
    v_add_f32 v244, v244, v124
    v_add_f32 v244, v244, v125
    v_add_f32 v244, v244, v126
    v_add_f32 v244, v244, v127
    v_cvt_pk_bf16_f32 v160, v64, v65
    v_cvt_pk_bf16_f32 v161, v66, v67
    v_cvt_pk_bf16_f32 v162, v68, v69
    v_cvt_pk_bf16_f32 v163, v70, v71
    v_cvt_pk_bf16_f32 v168, v72, v73
    v_cvt_pk_bf16_f32 v169, v74, v75
    v_cvt_pk_bf16_f32 v170, v76, v77
    v_cvt_pk_bf16_f32 v171, v78, v79
    v_cvt_pk_bf16_f32 v164, v80, v81
    v_cvt_pk_bf16_f32 v165, v82, v83
    v_cvt_pk_bf16_f32 v166, v84, v85
    v_cvt_pk_bf16_f32 v167, v86, v87
    v_cvt_pk_bf16_f32 v172, v88, v89
    v_cvt_pk_bf16_f32 v173, v90, v91
    v_cvt_pk_bf16_f32 v174, v92, v93
    v_cvt_pk_bf16_f32 v175, v94, v95
    v_cvt_pk_bf16_f32 v176, v96, v97
    v_cvt_pk_bf16_f32 v177, v98, v99
    v_cvt_pk_bf16_f32 v178, v100, v101
    v_cvt_pk_bf16_f32 v179, v102, v103
    v_cvt_pk_bf16_f32 v184, v104, v105
    v_cvt_pk_bf16_f32 v185, v106, v107
    v_cvt_pk_bf16_f32 v186, v108, v109
    v_cvt_pk_bf16_f32 v187, v110, v111
    v_cvt_pk_bf16_f32 v180, v112, v113
    v_cvt_pk_bf16_f32 v181, v114, v115
    v_cvt_pk_bf16_f32 v182, v116, v117
    v_cvt_pk_bf16_f32 v183, v118, v119
    v_cvt_pk_bf16_f32 v188, v120, v121
    v_cvt_pk_bf16_f32 v189, v122, v123
    v_cvt_pk_bf16_f32 v190, v124, v125
    v_cvt_pk_bf16_f32 v191, v126, v127
    v_sub_f32 v0, v0, v246
    v_sub_f32 v1, v1, v246
    v_sub_f32 v2, v2, v246
    v_sub_f32 v3, v3, v246
    v_sub_f32 v4, v4, v246
    v_sub_f32 v5, v5, v246
    v_sub_f32 v6, v6, v246
    v_sub_f32 v7, v7, v246
    v_sub_f32 v8, v8, v246
    v_sub_f32 v9, v9, v246
    v_sub_f32 v10, v10, v246
    v_sub_f32 v11, v11, v246
    v_sub_f32 v12, v12, v246
    v_sub_f32 v13, v13, v246
    v_sub_f32 v14, v14, v246
    v_sub_f32 v15, v15, v246
    v_sub_f32 v16, v16, v247
    v_sub_f32 v17, v17, v247
    v_sub_f32 v18, v18, v247
    v_sub_f32 v19, v19, v247
    v_sub_f32 v20, v20, v247
    v_sub_f32 v21, v21, v247
    v_sub_f32 v22, v22, v247
    v_sub_f32 v23, v23, v247
    v_sub_f32 v24, v24, v247
    v_sub_f32 v25, v25, v247
    v_sub_f32 v26, v26, v247
    v_sub_f32 v27, v27, v247
    v_sub_f32 v28, v28, v247
    v_sub_f32 v29, v29, v247
    v_sub_f32 v30, v30, v247
    v_sub_f32 v31, v31, v247
    v_sub_f32 v32, v32, v246
    v_sub_f32 v33, v33, v246
    v_sub_f32 v34, v34, v246
    v_sub_f32 v35, v35, v246
    v_sub_f32 v36, v36, v246
    v_sub_f32 v37, v37, v246
    v_sub_f32 v38, v38, v246
    v_sub_f32 v39, v39, v246
    v_sub_f32 v40, v40, v246
    v_sub_f32 v41, v41, v246
    v_sub_f32 v42, v42, v246
    v_sub_f32 v43, v43, v246
    v_sub_f32 v44, v44, v246
    v_sub_f32 v45, v45, v246
    v_sub_f32 v46, v46, v246
    v_sub_f32 v47, v47, v246
    v_sub_f32 v48, v48, v247
    v_sub_f32 v49, v49, v247
    v_sub_f32 v50, v50, v247
    v_sub_f32 v51, v51, v247
    v_sub_f32 v52, v52, v247
    v_sub_f32 v53, v53, v247
    v_sub_f32 v54, v54, v247
    v_sub_f32 v55, v55, v247
    v_sub_f32 v56, v56, v247
    v_sub_f32 v57, v57, v247
    v_sub_f32 v58, v58, v247
    v_sub_f32 v59, v59, v247
    v_sub_f32 v60, v60, v247
    v_sub_f32 v61, v61, v247
    v_sub_f32 v62, v62, v247
    v_sub_f32 v63, v63, v247
    s_nop 7
    ds_read_b128 a[192:195], v224 offset:0
    ds_read_b128 a[196:199], v225 offset:0
    ds_read_b128 a[200:203], v226 offset:0
    ds_read_b128 a[204:207], v227 offset:0
    s_branch L_ret0
L_rare1:
    s_nop 15
    s_nop 3
    s_waitcnt vmcnt(0) lgkmcnt(0)
    s_add_u32 s46, s35, 8192
    buffer_load_dwordx4 a[192:195], v245, s[8:11], s35 offen
    buffer_load_dwordx4 a[196:199], v245, s[8:11], s35 offen offset:32
    buffer_load_dwordx4 a[200:203], v245, s[8:11], s35 offen offset:64
    buffer_load_dwordx4 a[204:207], v245, s[8:11], s35 offen offset:96
    buffer_load_dwordx4 a[208:211], v245, s[8:11], s35 offen offset:128
    buffer_load_dwordx4 a[212:215], v245, s[8:11], s35 offen offset:160
    buffer_load_dwordx4 a[216:219], v245, s[8:11], s35 offen offset:192
    buffer_load_dwordx4 a[220:223], v245, s[8:11], s35 offen offset:224
    buffer_load_dwordx4 a[224:227], v245, s[8:11], s46 offen
    buffer_load_dwordx4 a[228:231], v245, s[8:11], s46 offen offset:32
    buffer_load_dwordx4 a[232:235], v245, s[8:11], s46 offen offset:64
    buffer_load_dwordx4 a[236:239], v245, s[8:11], s46 offen offset:96
    buffer_load_dwordx4 a[240:243], v245, s[8:11], s46 offen offset:128
    buffer_load_dwordx4 a[244:247], v245, s[8:11], s46 offen offset:160
    buffer_load_dwordx4 a[248:251], v245, s[8:11], s46 offen offset:192
    buffer_load_dwordx4 a[252:255], v245, s[8:11], s46 offen offset:224
    s_waitcnt vmcnt(0)
    s_nop 1
    v_mfma_f32_32x32x16_bf16 v[0:15], a[192:195], a[128:131], v[192:207]
    v_mfma_f32_32x32x16_bf16 v[16:31], a[192:195], a[160:163], v[208:223]
    v_mfma_f32_32x32x16_bf16 v[0:15], a[196:199], a[132:135], v[0:15]
    v_mfma_f32_32x32x16_bf16 v[16:31], a[196:199], a[164:167], v[16:31]
    v_mfma_f32_32x32x16_bf16 v[0:15], a[200:203], a[136:139], v[0:15]
    v_mfma_f32_32x32x16_bf16 v[16:31], a[200:203], a[168:171], v[16:31]
    v_mfma_f32_32x32x16_bf16 v[0:15], a[204:207], a[140:143], v[0:15]
    v_mfma_f32_32x32x16_bf16 v[16:31], a[204:207], a[172:175], v[16:31]
    v_mfma_f32_32x32x16_bf16 v[0:15], a[208:211], a[144:147], v[0:15]
    v_mfma_f32_32x32x16_bf16 v[16:31], a[208:211], a[176:179], v[16:31]
    v_mfma_f32_32x32x16_bf16 v[0:15], a[212:215], a[148:151], v[0:15]
    v_mfma_f32_32x32x16_bf16 v[16:31], a[212:215], a[180:183], v[16:31]
    v_mfma_f32_32x32x16_bf16 v[0:15], a[216:219], a[152:155], v[0:15]
    v_mfma_f32_32x32x16_bf16 v[16:31], a[216:219], a[184:187], v[16:31]
    v_mfma_f32_32x32x16_bf16 v[0:15], a[220:223], a[156:159], v[0:15]
    v_mfma_f32_32x32x16_bf16 v[16:31], a[220:223], a[188:191], v[16:31]
    v_mfma_f32_32x32x16_bf16 v[32:47], a[224:227], a[128:131], v[192:207]
    v_mfma_f32_32x32x16_bf16 v[48:63], a[224:227], a[160:163], v[208:223]
    v_mfma_f32_32x32x16_bf16 v[32:47], a[228:231], a[132:135], v[32:47]
    v_mfma_f32_32x32x16_bf16 v[48:63], a[228:231], a[164:167], v[48:63]
    v_mfma_f32_32x32x16_bf16 v[32:47], a[232:235], a[136:139], v[32:47]
    v_mfma_f32_32x32x16_bf16 v[48:63], a[232:235], a[168:171], v[48:63]
    v_mfma_f32_32x32x16_bf16 v[32:47], a[236:239], a[140:143], v[32:47]
    v_mfma_f32_32x32x16_bf16 v[48:63], a[236:239], a[172:175], v[48:63]
    v_mfma_f32_32x32x16_bf16 v[32:47], a[240:243], a[144:147], v[32:47]
    v_mfma_f32_32x32x16_bf16 v[48:63], a[240:243], a[176:179], v[48:63]
    v_mfma_f32_32x32x16_bf16 v[32:47], a[244:247], a[148:151], v[32:47]
    v_mfma_f32_32x32x16_bf16 v[48:63], a[244:247], a[180:183], v[48:63]
    v_mfma_f32_32x32x16_bf16 v[32:47], a[248:251], a[152:155], v[32:47]
    v_mfma_f32_32x32x16_bf16 v[48:63], a[248:251], a[184:187], v[48:63]
    v_mfma_f32_32x32x16_bf16 v[32:47], a[252:255], a[156:159], v[32:47]
    v_mfma_f32_32x32x16_bf16 v[48:63], a[252:255], a[188:191], v[48:63]
    s_nop 15
    s_nop 3
    v_max3_f32 v246, v0, v1, v2
    v_max3_f32 v246, v246, v3, v4
    v_max3_f32 v246, v246, v5, v6
    v_max3_f32 v246, v246, v7, v8
    v_max3_f32 v246, v246, v9, v10
    v_max3_f32 v246, v246, v11, v12
    v_max3_f32 v246, v246, v13, v14
    v_max3_f32 v246, v246, v15, v32
    v_max3_f32 v246, v246, v33, v34
    v_max3_f32 v246, v246, v35, v36
    v_max3_f32 v246, v246, v37, v38
    v_max3_f32 v246, v246, v39, v40
    v_max3_f32 v246, v246, v41, v42
    v_max3_f32 v246, v246, v43, v44
    v_max3_f32 v246, v246, v45, v46
    v_max_f32 v246, v246, v47
    v_mov_b32 v248, v246
    v_mov_b32 v249, v246
    s_nop 1
    v_permlane32_swap_b32 v248, v249
    s_nop 1
    v_max_f32 v246, v248, v249
    v_max_f32 v246, 0, v246
    v_max3_f32 v247, v16, v17, v18
    v_max3_f32 v247, v247, v19, v20
    v_max3_f32 v247, v247, v21, v22
    v_max3_f32 v247, v247, v23, v24
    v_max3_f32 v247, v247, v25, v26
    v_max3_f32 v247, v247, v27, v28
    v_max3_f32 v247, v247, v29, v30
    v_max3_f32 v247, v247, v31, v48
    v_max3_f32 v247, v247, v49, v50
    v_max3_f32 v247, v247, v51, v52
    v_max3_f32 v247, v247, v53, v54
    v_max3_f32 v247, v247, v55, v56
    v_max3_f32 v247, v247, v57, v58
    v_max3_f32 v247, v247, v59, v60
    v_max3_f32 v247, v247, v61, v62
    v_max_f32 v247, v247, v63
    v_mov_b32 v248, v247
    v_mov_b32 v249, v247
    s_nop 1
    v_permlane32_swap_b32 v248, v249
    s_nop 1
    v_max_f32 v247, v248, v249
    v_max_f32 v247, 0, v247
    v_exp_f32_e64 v250, -v246
    v_exp_f32_e64 v251, -v247
    s_nop 1
    v_mul_f32 v241, v241, v250
    v_mul_f32 v242, v242, v251
    v_accvgpr_read_b32 v252, a0
    s_nop 0
    v_mul_f32 v252, v252, v250
    s_nop 0
    v_accvgpr_write_b32 a0, v252
    v_accvgpr_read_b32 v253, a1
    s_nop 0
    v_mul_f32 v253, v253, v250
    s_nop 0
    v_accvgpr_write_b32 a1, v253
    v_accvgpr_read_b32 v254, a2
    s_nop 0
    v_mul_f32 v254, v254, v250
    s_nop 0
    v_accvgpr_write_b32 a2, v254
    v_accvgpr_read_b32 v255, a3
    s_nop 0
    v_mul_f32 v255, v255, v250
    s_nop 0
    v_accvgpr_write_b32 a3, v255
    v_accvgpr_read_b32 v252, a4
    s_nop 0
    v_mul_f32 v252, v252, v250
    s_nop 0
    v_accvgpr_write_b32 a4, v252
    v_accvgpr_read_b32 v253, a5
    s_nop 0
    v_mul_f32 v253, v253, v250
    s_nop 0
    v_accvgpr_write_b32 a5, v253
    v_accvgpr_read_b32 v254, a6
    s_nop 0
    v_mul_f32 v254, v254, v250
    s_nop 0
    v_accvgpr_write_b32 a6, v254
    v_accvgpr_read_b32 v255, a7
    s_nop 0
    v_mul_f32 v255, v255, v250
    s_nop 0
    v_accvgpr_write_b32 a7, v255
    v_accvgpr_read_b32 v252, a8
    s_nop 0
    v_mul_f32 v252, v252, v250
    s_nop 0
    v_accvgpr_write_b32 a8, v252
    v_accvgpr_read_b32 v253, a9
    s_nop 0
    v_mul_f32 v253, v253, v250
    s_nop 0
    v_accvgpr_write_b32 a9, v253
    v_accvgpr_read_b32 v254, a10
    s_nop 0
    v_mul_f32 v254, v254, v250
    s_nop 0
    v_accvgpr_write_b32 a10, v254
    v_accvgpr_read_b32 v255, a11
    s_nop 0
    v_mul_f32 v255, v255, v250
    s_nop 0
    v_accvgpr_write_b32 a11, v255
    v_accvgpr_read_b32 v252, a12
    s_nop 0
    v_mul_f32 v252, v252, v250
    s_nop 0
    v_accvgpr_write_b32 a12, v252
    v_accvgpr_read_b32 v253, a13
    s_nop 0
    v_mul_f32 v253, v253, v250
    s_nop 0
    v_accvgpr_write_b32 a13, v253
    v_accvgpr_read_b32 v254, a14
    s_nop 0
    v_mul_f32 v254, v254, v250
    s_nop 0
    v_accvgpr_write_b32 a14, v254
    v_accvgpr_read_b32 v255, a15
    s_nop 0
    v_mul_f32 v255, v255, v250
    s_nop 0
    v_accvgpr_write_b32 a15, v255
    v_accvgpr_read_b32 v252, a16
    s_nop 0
    v_mul_f32 v252, v252, v251
    s_nop 0
    v_accvgpr_write_b32 a16, v252
    v_accvgpr_read_b32 v253, a17
    s_nop 0
    v_mul_f32 v253, v253, v251
    s_nop 0
    v_accvgpr_write_b32 a17, v253
    v_accvgpr_read_b32 v254, a18
    s_nop 0
    v_mul_f32 v254, v254, v251
    s_nop 0
    v_accvgpr_write_b32 a18, v254
    v_accvgpr_read_b32 v255, a19
    s_nop 0
    v_mul_f32 v255, v255, v251
    s_nop 0
    v_accvgpr_write_b32 a19, v255
    v_accvgpr_read_b32 v252, a20
    s_nop 0
    v_mul_f32 v252, v252, v251
    s_nop 0
    v_accvgpr_write_b32 a20, v252
    v_accvgpr_read_b32 v253, a21
    s_nop 0
    v_mul_f32 v253, v253, v251
    s_nop 0
    v_accvgpr_write_b32 a21, v253
    v_accvgpr_read_b32 v254, a22
    s_nop 0
    v_mul_f32 v254, v254, v251
    s_nop 0
    v_accvgpr_write_b32 a22, v254
    v_accvgpr_read_b32 v255, a23
    s_nop 0
    v_mul_f32 v255, v255, v251
    s_nop 0
    v_accvgpr_write_b32 a23, v255
    v_accvgpr_read_b32 v252, a24
    s_nop 0
    v_mul_f32 v252, v252, v251
    s_nop 0
    v_accvgpr_write_b32 a24, v252
    v_accvgpr_read_b32 v253, a25
    s_nop 0
    v_mul_f32 v253, v253, v251
    s_nop 0
    v_accvgpr_write_b32 a25, v253
    v_accvgpr_read_b32 v254, a26
    s_nop 0
    v_mul_f32 v254, v254, v251
    s_nop 0
    v_accvgpr_write_b32 a26, v254
    v_accvgpr_read_b32 v255, a27
    s_nop 0
    v_mul_f32 v255, v255, v251
    s_nop 0
    v_accvgpr_write_b32 a27, v255
    v_accvgpr_read_b32 v252, a28
    s_nop 0
    v_mul_f32 v252, v252, v251
    s_nop 0
    v_accvgpr_write_b32 a28, v252
    v_accvgpr_read_b32 v253, a29
    s_nop 0
    v_mul_f32 v253, v253, v251
    s_nop 0
    v_accvgpr_write_b32 a29, v253
    v_accvgpr_read_b32 v254, a30
    s_nop 0
    v_mul_f32 v254, v254, v251
    s_nop 0
    v_accvgpr_write_b32 a30, v254
    v_accvgpr_read_b32 v255, a31
    s_nop 0
    v_mul_f32 v255, v255, v251
    s_nop 0
    v_accvgpr_write_b32 a31, v255
    v_accvgpr_read_b32 v252, a32
    s_nop 0
    v_mul_f32 v252, v252, v250
    s_nop 0
    v_accvgpr_write_b32 a32, v252
    v_accvgpr_read_b32 v253, a33
    s_nop 0
    v_mul_f32 v253, v253, v250
    s_nop 0
    v_accvgpr_write_b32 a33, v253
    v_accvgpr_read_b32 v254, a34
    s_nop 0
    v_mul_f32 v254, v254, v250
    s_nop 0
    v_accvgpr_write_b32 a34, v254
    v_accvgpr_read_b32 v255, a35
    s_nop 0
    v_mul_f32 v255, v255, v250
    s_nop 0
    v_accvgpr_write_b32 a35, v255
    v_accvgpr_read_b32 v252, a36
    s_nop 0
    v_mul_f32 v252, v252, v250
    s_nop 0
    v_accvgpr_write_b32 a36, v252
    v_accvgpr_read_b32 v253, a37
    s_nop 0
    v_mul_f32 v253, v253, v250
    s_nop 0
    v_accvgpr_write_b32 a37, v253
    v_accvgpr_read_b32 v254, a38
    s_nop 0
    v_mul_f32 v254, v254, v250
    s_nop 0
    v_accvgpr_write_b32 a38, v254
    v_accvgpr_read_b32 v255, a39
    s_nop 0
    v_mul_f32 v255, v255, v250
    s_nop 0
    v_accvgpr_write_b32 a39, v255
    v_accvgpr_read_b32 v252, a40
    s_nop 0
    v_mul_f32 v252, v252, v250
    s_nop 0
    v_accvgpr_write_b32 a40, v252
    v_accvgpr_read_b32 v253, a41
    s_nop 0
    v_mul_f32 v253, v253, v250
    s_nop 0
    v_accvgpr_write_b32 a41, v253
    v_accvgpr_read_b32 v254, a42
    s_nop 0
    v_mul_f32 v254, v254, v250
    s_nop 0
    v_accvgpr_write_b32 a42, v254
    v_accvgpr_read_b32 v255, a43
    s_nop 0
    v_mul_f32 v255, v255, v250
    s_nop 0
    v_accvgpr_write_b32 a43, v255
    v_accvgpr_read_b32 v252, a44
    s_nop 0
    v_mul_f32 v252, v252, v250
    s_nop 0
    v_accvgpr_write_b32 a44, v252
    v_accvgpr_read_b32 v253, a45
    s_nop 0
    v_mul_f32 v253, v253, v250
    s_nop 0
    v_accvgpr_write_b32 a45, v253
    v_accvgpr_read_b32 v254, a46
    s_nop 0
    v_mul_f32 v254, v254, v250
    s_nop 0
    v_accvgpr_write_b32 a46, v254
    v_accvgpr_read_b32 v255, a47
    s_nop 0
    v_mul_f32 v255, v255, v250
    s_nop 0
    v_accvgpr_write_b32 a47, v255
    v_accvgpr_read_b32 v252, a48
    s_nop 0
    v_mul_f32 v252, v252, v251
    s_nop 0
    v_accvgpr_write_b32 a48, v252
    v_accvgpr_read_b32 v253, a49
    s_nop 0
    v_mul_f32 v253, v253, v251
    s_nop 0
    v_accvgpr_write_b32 a49, v253
    v_accvgpr_read_b32 v254, a50
    s_nop 0
    v_mul_f32 v254, v254, v251
    s_nop 0
    v_accvgpr_write_b32 a50, v254
    v_accvgpr_read_b32 v255, a51
    s_nop 0
    v_mul_f32 v255, v255, v251
    s_nop 0
    v_accvgpr_write_b32 a51, v255
    v_accvgpr_read_b32 v252, a52
    s_nop 0
    v_mul_f32 v252, v252, v251
    s_nop 0
    v_accvgpr_write_b32 a52, v252
    v_accvgpr_read_b32 v253, a53
    s_nop 0
    v_mul_f32 v253, v253, v251
    s_nop 0
    v_accvgpr_write_b32 a53, v253
    v_accvgpr_read_b32 v254, a54
    s_nop 0
    v_mul_f32 v254, v254, v251
    s_nop 0
    v_accvgpr_write_b32 a54, v254
    v_accvgpr_read_b32 v255, a55
    s_nop 0
    v_mul_f32 v255, v255, v251
    s_nop 0
    v_accvgpr_write_b32 a55, v255
    v_accvgpr_read_b32 v252, a56
    s_nop 0
    v_mul_f32 v252, v252, v251
    s_nop 0
    v_accvgpr_write_b32 a56, v252
    v_accvgpr_read_b32 v253, a57
    s_nop 0
    v_mul_f32 v253, v253, v251
    s_nop 0
    v_accvgpr_write_b32 a57, v253
    v_accvgpr_read_b32 v254, a58
    s_nop 0
    v_mul_f32 v254, v254, v251
    s_nop 0
    v_accvgpr_write_b32 a58, v254
    v_accvgpr_read_b32 v255, a59
    s_nop 0
    v_mul_f32 v255, v255, v251
    s_nop 0
    v_accvgpr_write_b32 a59, v255
    v_accvgpr_read_b32 v252, a60
    s_nop 0
    v_mul_f32 v252, v252, v251
    s_nop 0
    v_accvgpr_write_b32 a60, v252
    v_accvgpr_read_b32 v253, a61
    s_nop 0
    v_mul_f32 v253, v253, v251
    s_nop 0
    v_accvgpr_write_b32 a61, v253
    v_accvgpr_read_b32 v254, a62
    s_nop 0
    v_mul_f32 v254, v254, v251
    s_nop 0
    v_accvgpr_write_b32 a62, v254
    v_accvgpr_read_b32 v255, a63
    s_nop 0
    v_mul_f32 v255, v255, v251
    s_nop 0
    v_accvgpr_write_b32 a63, v255
    v_accvgpr_read_b32 v252, a64
    s_nop 0
    v_mul_f32 v252, v252, v250
    s_nop 0
    v_accvgpr_write_b32 a64, v252
    v_accvgpr_read_b32 v253, a65
    s_nop 0
    v_mul_f32 v253, v253, v250
    s_nop 0
    v_accvgpr_write_b32 a65, v253
    v_accvgpr_read_b32 v254, a66
    s_nop 0
    v_mul_f32 v254, v254, v250
    s_nop 0
    v_accvgpr_write_b32 a66, v254
    v_accvgpr_read_b32 v255, a67
    s_nop 0
    v_mul_f32 v255, v255, v250
    s_nop 0
    v_accvgpr_write_b32 a67, v255
    v_accvgpr_read_b32 v252, a68
    s_nop 0
    v_mul_f32 v252, v252, v250
    s_nop 0
    v_accvgpr_write_b32 a68, v252
    v_accvgpr_read_b32 v253, a69
    s_nop 0
    v_mul_f32 v253, v253, v250
    s_nop 0
    v_accvgpr_write_b32 a69, v253
    v_accvgpr_read_b32 v254, a70
    s_nop 0
    v_mul_f32 v254, v254, v250
    s_nop 0
    v_accvgpr_write_b32 a70, v254
    v_accvgpr_read_b32 v255, a71
    s_nop 0
    v_mul_f32 v255, v255, v250
    s_nop 0
    v_accvgpr_write_b32 a71, v255
    v_accvgpr_read_b32 v252, a72
    s_nop 0
    v_mul_f32 v252, v252, v250
    s_nop 0
    v_accvgpr_write_b32 a72, v252
    v_accvgpr_read_b32 v253, a73
    s_nop 0
    v_mul_f32 v253, v253, v250
    s_nop 0
    v_accvgpr_write_b32 a73, v253
    v_accvgpr_read_b32 v254, a74
    s_nop 0
    v_mul_f32 v254, v254, v250
    s_nop 0
    v_accvgpr_write_b32 a74, v254
    v_accvgpr_read_b32 v255, a75
    s_nop 0
    v_mul_f32 v255, v255, v250
    s_nop 0
    v_accvgpr_write_b32 a75, v255
    v_accvgpr_read_b32 v252, a76
    s_nop 0
    v_mul_f32 v252, v252, v250
    s_nop 0
    v_accvgpr_write_b32 a76, v252
    v_accvgpr_read_b32 v253, a77
    s_nop 0
    v_mul_f32 v253, v253, v250
    s_nop 0
    v_accvgpr_write_b32 a77, v253
    v_accvgpr_read_b32 v254, a78
    s_nop 0
    v_mul_f32 v254, v254, v250
    s_nop 0
    v_accvgpr_write_b32 a78, v254
    v_accvgpr_read_b32 v255, a79
    s_nop 0
    v_mul_f32 v255, v255, v250
    s_nop 0
    v_accvgpr_write_b32 a79, v255
    v_accvgpr_read_b32 v252, a80
    s_nop 0
    v_mul_f32 v252, v252, v251
    s_nop 0
    v_accvgpr_write_b32 a80, v252
    v_accvgpr_read_b32 v253, a81
    s_nop 0
    v_mul_f32 v253, v253, v251
    s_nop 0
    v_accvgpr_write_b32 a81, v253
    v_accvgpr_read_b32 v254, a82
    s_nop 0
    v_mul_f32 v254, v254, v251
    s_nop 0
    v_accvgpr_write_b32 a82, v254
    v_accvgpr_read_b32 v255, a83
    s_nop 0
    v_mul_f32 v255, v255, v251
    s_nop 0
    v_accvgpr_write_b32 a83, v255
    v_accvgpr_read_b32 v252, a84
    s_nop 0
    v_mul_f32 v252, v252, v251
    s_nop 0
    v_accvgpr_write_b32 a84, v252
    v_accvgpr_read_b32 v253, a85
    s_nop 0
    v_mul_f32 v253, v253, v251
    s_nop 0
    v_accvgpr_write_b32 a85, v253
    v_accvgpr_read_b32 v254, a86
    s_nop 0
    v_mul_f32 v254, v254, v251
    s_nop 0
    v_accvgpr_write_b32 a86, v254
    v_accvgpr_read_b32 v255, a87
    s_nop 0
    v_mul_f32 v255, v255, v251
    s_nop 0
    v_accvgpr_write_b32 a87, v255
    v_accvgpr_read_b32 v252, a88
    s_nop 0
    v_mul_f32 v252, v252, v251
    s_nop 0
    v_accvgpr_write_b32 a88, v252
    v_accvgpr_read_b32 v253, a89
    s_nop 0
    v_mul_f32 v253, v253, v251
    s_nop 0
    v_accvgpr_write_b32 a89, v253
    v_accvgpr_read_b32 v254, a90
    s_nop 0
    v_mul_f32 v254, v254, v251
    s_nop 0
    v_accvgpr_write_b32 a90, v254
    v_accvgpr_read_b32 v255, a91
    s_nop 0
    v_mul_f32 v255, v255, v251
    s_nop 0
    v_accvgpr_write_b32 a91, v255
    v_accvgpr_read_b32 v252, a92
    s_nop 0
    v_mul_f32 v252, v252, v251
    s_nop 0
    v_accvgpr_write_b32 a92, v252
    v_accvgpr_read_b32 v253, a93
    s_nop 0
    v_mul_f32 v253, v253, v251
    s_nop 0
    v_accvgpr_write_b32 a93, v253
    v_accvgpr_read_b32 v254, a94
    s_nop 0
    v_mul_f32 v254, v254, v251
    s_nop 0
    v_accvgpr_write_b32 a94, v254
    v_accvgpr_read_b32 v255, a95
    s_nop 0
    v_mul_f32 v255, v255, v251
    s_nop 0
    v_accvgpr_write_b32 a95, v255
    v_accvgpr_read_b32 v252, a96
    s_nop 0
    v_mul_f32 v252, v252, v250
    s_nop 0
    v_accvgpr_write_b32 a96, v252
    v_accvgpr_read_b32 v253, a97
    s_nop 0
    v_mul_f32 v253, v253, v250
    s_nop 0
    v_accvgpr_write_b32 a97, v253
    v_accvgpr_read_b32 v254, a98
    s_nop 0
    v_mul_f32 v254, v254, v250
    s_nop 0
    v_accvgpr_write_b32 a98, v254
    v_accvgpr_read_b32 v255, a99
    s_nop 0
    v_mul_f32 v255, v255, v250
    s_nop 0
    v_accvgpr_write_b32 a99, v255
    v_accvgpr_read_b32 v252, a100
    s_nop 0
    v_mul_f32 v252, v252, v250
    s_nop 0
    v_accvgpr_write_b32 a100, v252
    v_accvgpr_read_b32 v253, a101
    s_nop 0
    v_mul_f32 v253, v253, v250
    s_nop 0
    v_accvgpr_write_b32 a101, v253
    v_accvgpr_read_b32 v254, a102
    s_nop 0
    v_mul_f32 v254, v254, v250
    s_nop 0
    v_accvgpr_write_b32 a102, v254
    v_accvgpr_read_b32 v255, a103
    s_nop 0
    v_mul_f32 v255, v255, v250
    s_nop 0
    v_accvgpr_write_b32 a103, v255
    v_accvgpr_read_b32 v252, a104
    s_nop 0
    v_mul_f32 v252, v252, v250
    s_nop 0
    v_accvgpr_write_b32 a104, v252
    v_accvgpr_read_b32 v253, a105
    s_nop 0
    v_mul_f32 v253, v253, v250
    s_nop 0
    v_accvgpr_write_b32 a105, v253
    v_accvgpr_read_b32 v254, a106
    s_nop 0
    v_mul_f32 v254, v254, v250
    s_nop 0
    v_accvgpr_write_b32 a106, v254
    v_accvgpr_read_b32 v255, a107
    s_nop 0
    v_mul_f32 v255, v255, v250
    s_nop 0
    v_accvgpr_write_b32 a107, v255
    v_accvgpr_read_b32 v252, a108
    s_nop 0
    v_mul_f32 v252, v252, v250
    s_nop 0
    v_accvgpr_write_b32 a108, v252
    v_accvgpr_read_b32 v253, a109
    s_nop 0
    v_mul_f32 v253, v253, v250
    s_nop 0
    v_accvgpr_write_b32 a109, v253
    v_accvgpr_read_b32 v254, a110
    s_nop 0
    v_mul_f32 v254, v254, v250
    s_nop 0
    v_accvgpr_write_b32 a110, v254
    v_accvgpr_read_b32 v255, a111
    s_nop 0
    v_mul_f32 v255, v255, v250
    s_nop 0
    v_accvgpr_write_b32 a111, v255
    v_accvgpr_read_b32 v252, a112
    s_nop 0
    v_mul_f32 v252, v252, v251
    s_nop 0
    v_accvgpr_write_b32 a112, v252
    v_accvgpr_read_b32 v253, a113
    s_nop 0
    v_mul_f32 v253, v253, v251
    s_nop 0
    v_accvgpr_write_b32 a113, v253
    v_accvgpr_read_b32 v254, a114
    s_nop 0
    v_mul_f32 v254, v254, v251
    s_nop 0
    v_accvgpr_write_b32 a114, v254
    v_accvgpr_read_b32 v255, a115
    s_nop 0
    v_mul_f32 v255, v255, v251
    s_nop 0
    v_accvgpr_write_b32 a115, v255
    v_accvgpr_read_b32 v252, a116
    s_nop 0
    v_mul_f32 v252, v252, v251
    s_nop 0
    v_accvgpr_write_b32 a116, v252
    v_accvgpr_read_b32 v253, a117
    s_nop 0
    v_mul_f32 v253, v253, v251
    s_nop 0
    v_accvgpr_write_b32 a117, v253
    v_accvgpr_read_b32 v254, a118
    s_nop 0
    v_mul_f32 v254, v254, v251
    s_nop 0
    v_accvgpr_write_b32 a118, v254
    v_accvgpr_read_b32 v255, a119
    s_nop 0
    v_mul_f32 v255, v255, v251
    s_nop 0
    v_accvgpr_write_b32 a119, v255
    v_accvgpr_read_b32 v252, a120
    s_nop 0
    v_mul_f32 v252, v252, v251
    s_nop 0
    v_accvgpr_write_b32 a120, v252
    v_accvgpr_read_b32 v253, a121
    s_nop 0
    v_mul_f32 v253, v253, v251
    s_nop 0
    v_accvgpr_write_b32 a121, v253
    v_accvgpr_read_b32 v254, a122
    s_nop 0
    v_mul_f32 v254, v254, v251
    s_nop 0
    v_accvgpr_write_b32 a122, v254
    v_accvgpr_read_b32 v255, a123
    s_nop 0
    v_mul_f32 v255, v255, v251
    s_nop 0
    v_accvgpr_write_b32 a123, v255
    v_accvgpr_read_b32 v252, a124
    s_nop 0
    v_mul_f32 v252, v252, v251
    s_nop 0
    v_accvgpr_write_b32 a124, v252
    v_accvgpr_read_b32 v253, a125
    s_nop 0
    v_mul_f32 v253, v253, v251
    s_nop 0
    v_accvgpr_write_b32 a125, v253
    v_accvgpr_read_b32 v254, a126
    s_nop 0
    v_mul_f32 v254, v254, v251
    s_nop 0
    v_accvgpr_write_b32 a126, v254
    v_accvgpr_read_b32 v255, a127
    s_nop 0
    v_mul_f32 v255, v255, v251
    s_nop 0
    v_accvgpr_write_b32 a127, v255
    v_sub_f32 v192, v192, v246
    v_sub_f32 v193, v193, v246
    v_sub_f32 v194, v194, v246
    v_sub_f32 v195, v195, v246
    v_sub_f32 v196, v196, v246
    v_sub_f32 v197, v197, v246
    v_sub_f32 v198, v198, v246
    v_sub_f32 v199, v199, v246
    v_sub_f32 v200, v200, v246
    v_sub_f32 v201, v201, v246
    v_sub_f32 v202, v202, v246
    v_sub_f32 v203, v203, v246
    v_sub_f32 v204, v204, v246
    v_sub_f32 v205, v205, v246
    v_sub_f32 v206, v206, v246
    v_sub_f32 v207, v207, v246
    v_sub_f32 v208, v208, v247
    v_sub_f32 v209, v209, v247
    v_sub_f32 v210, v210, v247
    v_sub_f32 v211, v211, v247
    v_sub_f32 v212, v212, v247
    v_sub_f32 v213, v213, v247
    v_sub_f32 v214, v214, v247
    v_sub_f32 v215, v215, v247
    v_sub_f32 v216, v216, v247
    v_sub_f32 v217, v217, v247
    v_sub_f32 v218, v218, v247
    v_sub_f32 v219, v219, v247
    v_sub_f32 v220, v220, v247
    v_sub_f32 v221, v221, v247
    v_sub_f32 v222, v222, v247
    v_sub_f32 v223, v223, v247
    v_sub_f32 v0, v0, v246
    v_sub_f32 v1, v1, v246
    v_sub_f32 v2, v2, v246
    v_sub_f32 v3, v3, v246
    v_sub_f32 v4, v4, v246
    v_sub_f32 v5, v5, v246
    v_sub_f32 v6, v6, v246
    v_sub_f32 v7, v7, v246
    v_sub_f32 v8, v8, v246
    v_sub_f32 v9, v9, v246
    v_sub_f32 v10, v10, v246
    v_sub_f32 v11, v11, v246
    v_sub_f32 v12, v12, v246
    v_sub_f32 v13, v13, v246
    v_sub_f32 v14, v14, v246
    v_sub_f32 v15, v15, v246
    v_sub_f32 v16, v16, v247
    v_sub_f32 v17, v17, v247
    v_sub_f32 v18, v18, v247
    v_sub_f32 v19, v19, v247
    v_sub_f32 v20, v20, v247
    v_sub_f32 v21, v21, v247
    v_sub_f32 v22, v22, v247
    v_sub_f32 v23, v23, v247
    v_sub_f32 v24, v24, v247
    v_sub_f32 v25, v25, v247
    v_sub_f32 v26, v26, v247
    v_sub_f32 v27, v27, v247
    v_sub_f32 v28, v28, v247
    v_sub_f32 v29, v29, v247
    v_sub_f32 v30, v30, v247
    v_sub_f32 v31, v31, v247
    v_sub_f32 v32, v32, v246
    v_sub_f32 v33, v33, v246
    v_sub_f32 v34, v34, v246
    v_sub_f32 v35, v35, v246
    v_sub_f32 v36, v36, v246
    v_sub_f32 v37, v37, v246
    v_sub_f32 v38, v38, v246
    v_sub_f32 v39, v39, v246
    v_sub_f32 v40, v40, v246
    v_sub_f32 v41, v41, v246
    v_sub_f32 v42, v42, v246
    v_sub_f32 v43, v43, v246
    v_sub_f32 v44, v44, v246
    v_sub_f32 v45, v45, v246
    v_sub_f32 v46, v46, v246
    v_sub_f32 v47, v47, v246
    v_sub_f32 v48, v48, v247
    v_sub_f32 v49, v49, v247
    v_sub_f32 v50, v50, v247
    v_sub_f32 v51, v51, v247
    v_sub_f32 v52, v52, v247
    v_sub_f32 v53, v53, v247
    v_sub_f32 v54, v54, v247
    v_sub_f32 v55, v55, v247
    v_sub_f32 v56, v56, v247
    v_sub_f32 v57, v57, v247
    v_sub_f32 v58, v58, v247
    v_sub_f32 v59, v59, v247
    v_sub_f32 v60, v60, v247
    v_sub_f32 v61, v61, v247
    v_sub_f32 v62, v62, v247
    v_sub_f32 v63, v63, v247
    v_exp_f32 v0, v0
    v_exp_f32 v1, v1
    v_exp_f32 v2, v2
    v_exp_f32 v3, v3
    v_exp_f32 v4, v4
    v_exp_f32 v5, v5
    v_exp_f32 v6, v6
    v_exp_f32 v7, v7
    v_exp_f32 v8, v8
    v_exp_f32 v9, v9
    v_exp_f32 v10, v10
    v_exp_f32 v11, v11
    v_exp_f32 v12, v12
    v_exp_f32 v13, v13
    v_exp_f32 v14, v14
    v_exp_f32 v15, v15
    v_exp_f32 v16, v16
    v_exp_f32 v17, v17
    v_exp_f32 v18, v18
    v_exp_f32 v19, v19
    v_exp_f32 v20, v20
    v_exp_f32 v21, v21
    v_exp_f32 v22, v22
    v_exp_f32 v23, v23
    v_exp_f32 v24, v24
    v_exp_f32 v25, v25
    v_exp_f32 v26, v26
    v_exp_f32 v27, v27
    v_exp_f32 v28, v28
    v_exp_f32 v29, v29
    v_exp_f32 v30, v30
    v_exp_f32 v31, v31
    v_exp_f32 v32, v32
    v_exp_f32 v33, v33
    v_exp_f32 v34, v34
    v_exp_f32 v35, v35
    v_exp_f32 v36, v36
    v_exp_f32 v37, v37
    v_exp_f32 v38, v38
    v_exp_f32 v39, v39
    v_exp_f32 v40, v40
    v_exp_f32 v41, v41
    v_exp_f32 v42, v42
    v_exp_f32 v43, v43
    v_exp_f32 v44, v44
    v_exp_f32 v45, v45
    v_exp_f32 v46, v46
    v_exp_f32 v47, v47
    v_exp_f32 v48, v48
    v_exp_f32 v49, v49
    v_exp_f32 v50, v50
    v_exp_f32 v51, v51
    v_exp_f32 v52, v52
    v_exp_f32 v53, v53
    v_exp_f32 v54, v54
    v_exp_f32 v55, v55
    v_exp_f32 v56, v56
    v_exp_f32 v57, v57
    v_exp_f32 v58, v58
    v_exp_f32 v59, v59
    v_exp_f32 v60, v60
    v_exp_f32 v61, v61
    v_exp_f32 v62, v62
    v_exp_f32 v63, v63
    s_nop 0
    v_add_f32 v243, v0, v1
    v_add_f32 v243, v243, v2
    v_add_f32 v243, v243, v3
    v_add_f32 v243, v243, v4
    v_add_f32 v243, v243, v5
    v_add_f32 v243, v243, v6
    v_add_f32 v243, v243, v7
    v_add_f32 v243, v243, v8
    v_add_f32 v243, v243, v9
    v_add_f32 v243, v243, v10
    v_add_f32 v243, v243, v11
    v_add_f32 v243, v243, v12
    v_add_f32 v243, v243, v13
    v_add_f32 v243, v243, v14
    v_add_f32 v243, v243, v15
    v_add_f32 v243, v243, v32
    v_add_f32 v243, v243, v33
    v_add_f32 v243, v243, v34
    v_add_f32 v243, v243, v35
    v_add_f32 v243, v243, v36
    v_add_f32 v243, v243, v37
    v_add_f32 v243, v243, v38
    v_add_f32 v243, v243, v39
    v_add_f32 v243, v243, v40
    v_add_f32 v243, v243, v41
    v_add_f32 v243, v243, v42
    v_add_f32 v243, v243, v43
    v_add_f32 v243, v243, v44
    v_add_f32 v243, v243, v45
    v_add_f32 v243, v243, v46
    v_add_f32 v243, v243, v47
    v_add_f32 v244, v16, v17
    v_add_f32 v244, v244, v18
    v_add_f32 v244, v244, v19
    v_add_f32 v244, v244, v20
    v_add_f32 v244, v244, v21
    v_add_f32 v244, v244, v22
    v_add_f32 v244, v244, v23
    v_add_f32 v244, v244, v24
    v_add_f32 v244, v244, v25
    v_add_f32 v244, v244, v26
    v_add_f32 v244, v244, v27
    v_add_f32 v244, v244, v28
    v_add_f32 v244, v244, v29
    v_add_f32 v244, v244, v30
    v_add_f32 v244, v244, v31
    v_add_f32 v244, v244, v48
    v_add_f32 v244, v244, v49
    v_add_f32 v244, v244, v50
    v_add_f32 v244, v244, v51
    v_add_f32 v244, v244, v52
    v_add_f32 v244, v244, v53
    v_add_f32 v244, v244, v54
    v_add_f32 v244, v244, v55
    v_add_f32 v244, v244, v56
    v_add_f32 v244, v244, v57
    v_add_f32 v244, v244, v58
    v_add_f32 v244, v244, v59
    v_add_f32 v244, v244, v60
    v_add_f32 v244, v244, v61
    v_add_f32 v244, v244, v62
    v_add_f32 v244, v244, v63
    v_cvt_pk_bf16_f32 v128, v0, v1
    v_cvt_pk_bf16_f32 v129, v2, v3
    v_cvt_pk_bf16_f32 v130, v4, v5
    v_cvt_pk_bf16_f32 v131, v6, v7
    v_cvt_pk_bf16_f32 v136, v8, v9
    v_cvt_pk_bf16_f32 v137, v10, v11
    v_cvt_pk_bf16_f32 v138, v12, v13
    v_cvt_pk_bf16_f32 v139, v14, v15
    v_cvt_pk_bf16_f32 v132, v16, v17
    v_cvt_pk_bf16_f32 v133, v18, v19
    v_cvt_pk_bf16_f32 v134, v20, v21
    v_cvt_pk_bf16_f32 v135, v22, v23
    v_cvt_pk_bf16_f32 v140, v24, v25
    v_cvt_pk_bf16_f32 v141, v26, v27
    v_cvt_pk_bf16_f32 v142, v28, v29
    v_cvt_pk_bf16_f32 v143, v30, v31
    v_cvt_pk_bf16_f32 v144, v32, v33
    v_cvt_pk_bf16_f32 v145, v34, v35
    v_cvt_pk_bf16_f32 v146, v36, v37
    v_cvt_pk_bf16_f32 v147, v38, v39
    v_cvt_pk_bf16_f32 v152, v40, v41
    v_cvt_pk_bf16_f32 v153, v42, v43
    v_cvt_pk_bf16_f32 v154, v44, v45
    v_cvt_pk_bf16_f32 v155, v46, v47
    v_cvt_pk_bf16_f32 v148, v48, v49
    v_cvt_pk_bf16_f32 v149, v50, v51
    v_cvt_pk_bf16_f32 v150, v52, v53
    v_cvt_pk_bf16_f32 v151, v54, v55
    v_cvt_pk_bf16_f32 v156, v56, v57
    v_cvt_pk_bf16_f32 v157, v58, v59
    v_cvt_pk_bf16_f32 v158, v60, v61
    v_cvt_pk_bf16_f32 v159, v62, v63
    v_sub_f32 v64, v64, v246
    v_sub_f32 v65, v65, v246
    v_sub_f32 v66, v66, v246
    v_sub_f32 v67, v67, v246
    v_sub_f32 v68, v68, v246
    v_sub_f32 v69, v69, v246
    v_sub_f32 v70, v70, v246
    v_sub_f32 v71, v71, v246
    v_sub_f32 v72, v72, v246
    v_sub_f32 v73, v73, v246
    v_sub_f32 v74, v74, v246
    v_sub_f32 v75, v75, v246
    v_sub_f32 v76, v76, v246
    v_sub_f32 v77, v77, v246
    v_sub_f32 v78, v78, v246
    v_sub_f32 v79, v79, v246
    v_sub_f32 v80, v80, v247
    v_sub_f32 v81, v81, v247
    v_sub_f32 v82, v82, v247
    v_sub_f32 v83, v83, v247
    v_sub_f32 v84, v84, v247
    v_sub_f32 v85, v85, v247
    v_sub_f32 v86, v86, v247
    v_sub_f32 v87, v87, v247
    v_sub_f32 v88, v88, v247
    v_sub_f32 v89, v89, v247
    v_sub_f32 v90, v90, v247
    v_sub_f32 v91, v91, v247
    v_sub_f32 v92, v92, v247
    v_sub_f32 v93, v93, v247
    v_sub_f32 v94, v94, v247
    v_sub_f32 v95, v95, v247
    v_sub_f32 v96, v96, v246
    v_sub_f32 v97, v97, v246
    v_sub_f32 v98, v98, v246
    v_sub_f32 v99, v99, v246
    v_sub_f32 v100, v100, v246
    v_sub_f32 v101, v101, v246
    v_sub_f32 v102, v102, v246
    v_sub_f32 v103, v103, v246
    v_sub_f32 v104, v104, v246
    v_sub_f32 v105, v105, v246
    v_sub_f32 v106, v106, v246
    v_sub_f32 v107, v107, v246
    v_sub_f32 v108, v108, v246
    v_sub_f32 v109, v109, v246
    v_sub_f32 v110, v110, v246
    v_sub_f32 v111, v111, v246
    v_sub_f32 v112, v112, v247
    v_sub_f32 v113, v113, v247
    v_sub_f32 v114, v114, v247
    v_sub_f32 v115, v115, v247
    v_sub_f32 v116, v116, v247
    v_sub_f32 v117, v117, v247
    v_sub_f32 v118, v118, v247
    v_sub_f32 v119, v119, v247
    v_sub_f32 v120, v120, v247
    v_sub_f32 v121, v121, v247
    v_sub_f32 v122, v122, v247
    v_sub_f32 v123, v123, v247
    v_sub_f32 v124, v124, v247
    v_sub_f32 v125, v125, v247
    v_sub_f32 v126, v126, v247
    v_sub_f32 v127, v127, v247
    s_nop 7
    ds_read_b128 a[192:195], v224 offset:16384
    ds_read_b128 a[196:199], v225 offset:16384
    ds_read_b128 a[200:203], v226 offset:16384
    ds_read_b128 a[204:207], v227 offset:16384
    s_branch L_ret1
L_rare2:
    s_nop 15
    s_nop 3
    s_waitcnt vmcnt(0) lgkmcnt(0)
    s_add_u32 s46, s35, 8192
    buffer_load_dwordx4 a[192:195], v245, s[8:11], s35 offen
    buffer_load_dwordx4 a[196:199], v245, s[8:11], s35 offen offset:32
    buffer_load_dwordx4 a[200:203], v245, s[8:11], s35 offen offset:64
    buffer_load_dwordx4 a[204:207], v245, s[8:11], s35 offen offset:96
    buffer_load_dwordx4 a[208:211], v245, s[8:11], s35 offen offset:128
    buffer_load_dwordx4 a[212:215], v245, s[8:11], s35 offen offset:160
    buffer_load_dwordx4 a[216:219], v245, s[8:11], s35 offen offset:192
    buffer_load_dwordx4 a[220:223], v245, s[8:11], s35 offen offset:224
    buffer_load_dwordx4 a[224:227], v245, s[8:11], s46 offen
    buffer_load_dwordx4 a[228:231], v245, s[8:11], s46 offen offset:32
    buffer_load_dwordx4 a[232:235], v245, s[8:11], s46 offen offset:64
    buffer_load_dwordx4 a[236:239], v245, s[8:11], s46 offen offset:96
    buffer_load_dwordx4 a[240:243], v245, s[8:11], s46 offen offset:128
    buffer_load_dwordx4 a[244:247], v245, s[8:11], s46 offen offset:160
    buffer_load_dwordx4 a[248:251], v245, s[8:11], s46 offen offset:192
    buffer_load_dwordx4 a[252:255], v245, s[8:11], s46 offen offset:224
    s_waitcnt vmcnt(0)
    s_nop 1
    v_mfma_f32_32x32x16_bf16 v[64:79], a[192:195], a[128:131], v[192:207]
    v_mfma_f32_32x32x16_bf16 v[80:95], a[192:195], a[160:163], v[208:223]
    v_mfma_f32_32x32x16_bf16 v[64:79], a[196:199], a[132:135], v[64:79]
    v_mfma_f32_32x32x16_bf16 v[80:95], a[196:199], a[164:167], v[80:95]
    v_mfma_f32_32x32x16_bf16 v[64:79], a[200:203], a[136:139], v[64:79]
    v_mfma_f32_32x32x16_bf16 v[80:95], a[200:203], a[168:171], v[80:95]
    v_mfma_f32_32x32x16_bf16 v[64:79], a[204:207], a[140:143], v[64:79]
    v_mfma_f32_32x32x16_bf16 v[80:95], a[204:207], a[172:175], v[80:95]
    v_mfma_f32_32x32x16_bf16 v[64:79], a[208:211], a[144:147], v[64:79]
    v_mfma_f32_32x32x16_bf16 v[80:95], a[208:211], a[176:179], v[80:95]
    v_mfma_f32_32x32x16_bf16 v[64:79], a[212:215], a[148:151], v[64:79]
    v_mfma_f32_32x32x16_bf16 v[80:95], a[212:215], a[180:183], v[80:95]
    v_mfma_f32_32x32x16_bf16 v[64:79], a[216:219], a[152:155], v[64:79]
    v_mfma_f32_32x32x16_bf16 v[80:95], a[216:219], a[184:187], v[80:95]
    v_mfma_f32_32x32x16_bf16 v[64:79], a[220:223], a[156:159], v[64:79]
    v_mfma_f32_32x32x16_bf16 v[80:95], a[220:223], a[188:191], v[80:95]
    v_mfma_f32_32x32x16_bf16 v[96:111], a[224:227], a[128:131], v[192:207]
    v_mfma_f32_32x32x16_bf16 v[112:127], a[224:227], a[160:163], v[208:223]
    v_mfma_f32_32x32x16_bf16 v[96:111], a[228:231], a[132:135], v[96:111]
    v_mfma_f32_32x32x16_bf16 v[112:127], a[228:231], a[164:167], v[112:127]
    v_mfma_f32_32x32x16_bf16 v[96:111], a[232:235], a[136:139], v[96:111]
    v_mfma_f32_32x32x16_bf16 v[112:127], a[232:235], a[168:171], v[112:127]
    v_mfma_f32_32x32x16_bf16 v[96:111], a[236:239], a[140:143], v[96:111]
    v_mfma_f32_32x32x16_bf16 v[112:127], a[236:239], a[172:175], v[112:127]
    v_mfma_f32_32x32x16_bf16 v[96:111], a[240:243], a[144:147], v[96:111]
    v_mfma_f32_32x32x16_bf16 v[112:127], a[240:243], a[176:179], v[112:127]
    v_mfma_f32_32x32x16_bf16 v[96:111], a[244:247], a[148:151], v[96:111]
    v_mfma_f32_32x32x16_bf16 v[112:127], a[244:247], a[180:183], v[112:127]
    v_mfma_f32_32x32x16_bf16 v[96:111], a[248:251], a[152:155], v[96:111]
    v_mfma_f32_32x32x16_bf16 v[112:127], a[248:251], a[184:187], v[112:127]
    v_mfma_f32_32x32x16_bf16 v[96:111], a[252:255], a[156:159], v[96:111]
    v_mfma_f32_32x32x16_bf16 v[112:127], a[252:255], a[188:191], v[112:127]
    s_nop 15
    s_nop 3
    v_max3_f32 v246, v64, v65, v66
    v_max3_f32 v246, v246, v67, v68
    v_max3_f32 v246, v246, v69, v70
    v_max3_f32 v246, v246, v71, v72
    v_max3_f32 v246, v246, v73, v74
    v_max3_f32 v246, v246, v75, v76
    v_max3_f32 v246, v246, v77, v78
    v_max3_f32 v246, v246, v79, v96
    v_max3_f32 v246, v246, v97, v98
    v_max3_f32 v246, v246, v99, v100
    v_max3_f32 v246, v246, v101, v102
    v_max3_f32 v246, v246, v103, v104
    v_max3_f32 v246, v246, v105, v106
    v_max3_f32 v246, v246, v107, v108
    v_max3_f32 v246, v246, v109, v110
    v_max_f32 v246, v246, v111
    v_mov_b32 v248, v246
    v_mov_b32 v249, v246
    s_nop 1
    v_permlane32_swap_b32 v248, v249
    s_nop 1
    v_max_f32 v246, v248, v249
    v_max_f32 v246, 0, v246
    v_max3_f32 v247, v80, v81, v82
    v_max3_f32 v247, v247, v83, v84
    v_max3_f32 v247, v247, v85, v86
    v_max3_f32 v247, v247, v87, v88
    v_max3_f32 v247, v247, v89, v90
    v_max3_f32 v247, v247, v91, v92
    v_max3_f32 v247, v247, v93, v94
    v_max3_f32 v247, v247, v95, v112
    v_max3_f32 v247, v247, v113, v114
    v_max3_f32 v247, v247, v115, v116
    v_max3_f32 v247, v247, v117, v118
    v_max3_f32 v247, v247, v119, v120
    v_max3_f32 v247, v247, v121, v122
    v_max3_f32 v247, v247, v123, v124
    v_max3_f32 v247, v247, v125, v126
    v_max_f32 v247, v247, v127
    v_mov_b32 v248, v247
    v_mov_b32 v249, v247
    s_nop 1
    v_permlane32_swap_b32 v248, v249
    s_nop 1
    v_max_f32 v247, v248, v249
    v_max_f32 v247, 0, v247
    v_exp_f32_e64 v250, -v246
    v_exp_f32_e64 v251, -v247
    s_nop 1
    v_mul_f32 v241, v241, v250
    v_mul_f32 v242, v242, v251
    v_accvgpr_read_b32 v252, a0
    s_nop 0
    v_mul_f32 v252, v252, v250
    s_nop 0
    v_accvgpr_write_b32 a0, v252
    v_accvgpr_read_b32 v253, a1
    s_nop 0
    v_mul_f32 v253, v253, v250
    s_nop 0
    v_accvgpr_write_b32 a1, v253
    v_accvgpr_read_b32 v254, a2
    s_nop 0
    v_mul_f32 v254, v254, v250
    s_nop 0
    v_accvgpr_write_b32 a2, v254
    v_accvgpr_read_b32 v255, a3
    s_nop 0
    v_mul_f32 v255, v255, v250
    s_nop 0
    v_accvgpr_write_b32 a3, v255
    v_accvgpr_read_b32 v252, a4
    s_nop 0
    v_mul_f32 v252, v252, v250
    s_nop 0
    v_accvgpr_write_b32 a4, v252
    v_accvgpr_read_b32 v253, a5
    s_nop 0
    v_mul_f32 v253, v253, v250
    s_nop 0
    v_accvgpr_write_b32 a5, v253
    v_accvgpr_read_b32 v254, a6
    s_nop 0
    v_mul_f32 v254, v254, v250
    s_nop 0
    v_accvgpr_write_b32 a6, v254
    v_accvgpr_read_b32 v255, a7
    s_nop 0
    v_mul_f32 v255, v255, v250
    s_nop 0
    v_accvgpr_write_b32 a7, v255
    v_accvgpr_read_b32 v252, a8
    s_nop 0
    v_mul_f32 v252, v252, v250
    s_nop 0
    v_accvgpr_write_b32 a8, v252
    v_accvgpr_read_b32 v253, a9
    s_nop 0
    v_mul_f32 v253, v253, v250
    s_nop 0
    v_accvgpr_write_b32 a9, v253
    v_accvgpr_read_b32 v254, a10
    s_nop 0
    v_mul_f32 v254, v254, v250
    s_nop 0
    v_accvgpr_write_b32 a10, v254
    v_accvgpr_read_b32 v255, a11
    s_nop 0
    v_mul_f32 v255, v255, v250
    s_nop 0
    v_accvgpr_write_b32 a11, v255
    v_accvgpr_read_b32 v252, a12
    s_nop 0
    v_mul_f32 v252, v252, v250
    s_nop 0
    v_accvgpr_write_b32 a12, v252
    v_accvgpr_read_b32 v253, a13
    s_nop 0
    v_mul_f32 v253, v253, v250
    s_nop 0
    v_accvgpr_write_b32 a13, v253
    v_accvgpr_read_b32 v254, a14
    s_nop 0
    v_mul_f32 v254, v254, v250
    s_nop 0
    v_accvgpr_write_b32 a14, v254
    v_accvgpr_read_b32 v255, a15
    s_nop 0
    v_mul_f32 v255, v255, v250
    s_nop 0
    v_accvgpr_write_b32 a15, v255
    v_accvgpr_read_b32 v252, a16
    s_nop 0
    v_mul_f32 v252, v252, v251
    s_nop 0
    v_accvgpr_write_b32 a16, v252
    v_accvgpr_read_b32 v253, a17
    s_nop 0
    v_mul_f32 v253, v253, v251
    s_nop 0
    v_accvgpr_write_b32 a17, v253
    v_accvgpr_read_b32 v254, a18
    s_nop 0
    v_mul_f32 v254, v254, v251
    s_nop 0
    v_accvgpr_write_b32 a18, v254
    v_accvgpr_read_b32 v255, a19
    s_nop 0
    v_mul_f32 v255, v255, v251
    s_nop 0
    v_accvgpr_write_b32 a19, v255
    v_accvgpr_read_b32 v252, a20
    s_nop 0
    v_mul_f32 v252, v252, v251
    s_nop 0
    v_accvgpr_write_b32 a20, v252
    v_accvgpr_read_b32 v253, a21
    s_nop 0
    v_mul_f32 v253, v253, v251
    s_nop 0
    v_accvgpr_write_b32 a21, v253
    v_accvgpr_read_b32 v254, a22
    s_nop 0
    v_mul_f32 v254, v254, v251
    s_nop 0
    v_accvgpr_write_b32 a22, v254
    v_accvgpr_read_b32 v255, a23
    s_nop 0
    v_mul_f32 v255, v255, v251
    s_nop 0
    v_accvgpr_write_b32 a23, v255
    v_accvgpr_read_b32 v252, a24
    s_nop 0
    v_mul_f32 v252, v252, v251
    s_nop 0
    v_accvgpr_write_b32 a24, v252
    v_accvgpr_read_b32 v253, a25
    s_nop 0
    v_mul_f32 v253, v253, v251
    s_nop 0
    v_accvgpr_write_b32 a25, v253
    v_accvgpr_read_b32 v254, a26
    s_nop 0
    v_mul_f32 v254, v254, v251
    s_nop 0
    v_accvgpr_write_b32 a26, v254
    v_accvgpr_read_b32 v255, a27
    s_nop 0
    v_mul_f32 v255, v255, v251
    s_nop 0
    v_accvgpr_write_b32 a27, v255
    v_accvgpr_read_b32 v252, a28
    s_nop 0
    v_mul_f32 v252, v252, v251
    s_nop 0
    v_accvgpr_write_b32 a28, v252
    v_accvgpr_read_b32 v253, a29
    s_nop 0
    v_mul_f32 v253, v253, v251
    s_nop 0
    v_accvgpr_write_b32 a29, v253
    v_accvgpr_read_b32 v254, a30
    s_nop 0
    v_mul_f32 v254, v254, v251
    s_nop 0
    v_accvgpr_write_b32 a30, v254
    v_accvgpr_read_b32 v255, a31
    s_nop 0
    v_mul_f32 v255, v255, v251
    s_nop 0
    v_accvgpr_write_b32 a31, v255
    v_accvgpr_read_b32 v252, a32
    s_nop 0
    v_mul_f32 v252, v252, v250
    s_nop 0
    v_accvgpr_write_b32 a32, v252
    v_accvgpr_read_b32 v253, a33
    s_nop 0
    v_mul_f32 v253, v253, v250
    s_nop 0
    v_accvgpr_write_b32 a33, v253
    v_accvgpr_read_b32 v254, a34
    s_nop 0
    v_mul_f32 v254, v254, v250
    s_nop 0
    v_accvgpr_write_b32 a34, v254
    v_accvgpr_read_b32 v255, a35
    s_nop 0
    v_mul_f32 v255, v255, v250
    s_nop 0
    v_accvgpr_write_b32 a35, v255
    v_accvgpr_read_b32 v252, a36
    s_nop 0
    v_mul_f32 v252, v252, v250
    s_nop 0
    v_accvgpr_write_b32 a36, v252
    v_accvgpr_read_b32 v253, a37
    s_nop 0
    v_mul_f32 v253, v253, v250
    s_nop 0
    v_accvgpr_write_b32 a37, v253
    v_accvgpr_read_b32 v254, a38
    s_nop 0
    v_mul_f32 v254, v254, v250
    s_nop 0
    v_accvgpr_write_b32 a38, v254
    v_accvgpr_read_b32 v255, a39
    s_nop 0
    v_mul_f32 v255, v255, v250
    s_nop 0
    v_accvgpr_write_b32 a39, v255
    v_accvgpr_read_b32 v252, a40
    s_nop 0
    v_mul_f32 v252, v252, v250
    s_nop 0
    v_accvgpr_write_b32 a40, v252
    v_accvgpr_read_b32 v253, a41
    s_nop 0
    v_mul_f32 v253, v253, v250
    s_nop 0
    v_accvgpr_write_b32 a41, v253
    v_accvgpr_read_b32 v254, a42
    s_nop 0
    v_mul_f32 v254, v254, v250
    s_nop 0
    v_accvgpr_write_b32 a42, v254
    v_accvgpr_read_b32 v255, a43
    s_nop 0
    v_mul_f32 v255, v255, v250
    s_nop 0
    v_accvgpr_write_b32 a43, v255
    v_accvgpr_read_b32 v252, a44
    s_nop 0
    v_mul_f32 v252, v252, v250
    s_nop 0
    v_accvgpr_write_b32 a44, v252
    v_accvgpr_read_b32 v253, a45
    s_nop 0
    v_mul_f32 v253, v253, v250
    s_nop 0
    v_accvgpr_write_b32 a45, v253
    v_accvgpr_read_b32 v254, a46
    s_nop 0
    v_mul_f32 v254, v254, v250
    s_nop 0
    v_accvgpr_write_b32 a46, v254
    v_accvgpr_read_b32 v255, a47
    s_nop 0
    v_mul_f32 v255, v255, v250
    s_nop 0
    v_accvgpr_write_b32 a47, v255
    v_accvgpr_read_b32 v252, a48
    s_nop 0
    v_mul_f32 v252, v252, v251
    s_nop 0
    v_accvgpr_write_b32 a48, v252
    v_accvgpr_read_b32 v253, a49
    s_nop 0
    v_mul_f32 v253, v253, v251
    s_nop 0
    v_accvgpr_write_b32 a49, v253
    v_accvgpr_read_b32 v254, a50
    s_nop 0
    v_mul_f32 v254, v254, v251
    s_nop 0
    v_accvgpr_write_b32 a50, v254
    v_accvgpr_read_b32 v255, a51
    s_nop 0
    v_mul_f32 v255, v255, v251
    s_nop 0
    v_accvgpr_write_b32 a51, v255
    v_accvgpr_read_b32 v252, a52
    s_nop 0
    v_mul_f32 v252, v252, v251
    s_nop 0
    v_accvgpr_write_b32 a52, v252
    v_accvgpr_read_b32 v253, a53
    s_nop 0
    v_mul_f32 v253, v253, v251
    s_nop 0
    v_accvgpr_write_b32 a53, v253
    v_accvgpr_read_b32 v254, a54
    s_nop 0
    v_mul_f32 v254, v254, v251
    s_nop 0
    v_accvgpr_write_b32 a54, v254
    v_accvgpr_read_b32 v255, a55
    s_nop 0
    v_mul_f32 v255, v255, v251
    s_nop 0
    v_accvgpr_write_b32 a55, v255
    v_accvgpr_read_b32 v252, a56
    s_nop 0
    v_mul_f32 v252, v252, v251
    s_nop 0
    v_accvgpr_write_b32 a56, v252
    v_accvgpr_read_b32 v253, a57
    s_nop 0
    v_mul_f32 v253, v253, v251
    s_nop 0
    v_accvgpr_write_b32 a57, v253
    v_accvgpr_read_b32 v254, a58
    s_nop 0
    v_mul_f32 v254, v254, v251
    s_nop 0
    v_accvgpr_write_b32 a58, v254
    v_accvgpr_read_b32 v255, a59
    s_nop 0
    v_mul_f32 v255, v255, v251
    s_nop 0
    v_accvgpr_write_b32 a59, v255
    v_accvgpr_read_b32 v252, a60
    s_nop 0
    v_mul_f32 v252, v252, v251
    s_nop 0
    v_accvgpr_write_b32 a60, v252
    v_accvgpr_read_b32 v253, a61
    s_nop 0
    v_mul_f32 v253, v253, v251
    s_nop 0
    v_accvgpr_write_b32 a61, v253
    v_accvgpr_read_b32 v254, a62
    s_nop 0
    v_mul_f32 v254, v254, v251
    s_nop 0
    v_accvgpr_write_b32 a62, v254
    v_accvgpr_read_b32 v255, a63
    s_nop 0
    v_mul_f32 v255, v255, v251
    s_nop 0
    v_accvgpr_write_b32 a63, v255
    v_accvgpr_read_b32 v252, a64
    s_nop 0
    v_mul_f32 v252, v252, v250
    s_nop 0
    v_accvgpr_write_b32 a64, v252
    v_accvgpr_read_b32 v253, a65
    s_nop 0
    v_mul_f32 v253, v253, v250
    s_nop 0
    v_accvgpr_write_b32 a65, v253
    v_accvgpr_read_b32 v254, a66
    s_nop 0
    v_mul_f32 v254, v254, v250
    s_nop 0
    v_accvgpr_write_b32 a66, v254
    v_accvgpr_read_b32 v255, a67
    s_nop 0
    v_mul_f32 v255, v255, v250
    s_nop 0
    v_accvgpr_write_b32 a67, v255
    v_accvgpr_read_b32 v252, a68
    s_nop 0
    v_mul_f32 v252, v252, v250
    s_nop 0
    v_accvgpr_write_b32 a68, v252
    v_accvgpr_read_b32 v253, a69
    s_nop 0
    v_mul_f32 v253, v253, v250
    s_nop 0
    v_accvgpr_write_b32 a69, v253
    v_accvgpr_read_b32 v254, a70
    s_nop 0
    v_mul_f32 v254, v254, v250
    s_nop 0
    v_accvgpr_write_b32 a70, v254
    v_accvgpr_read_b32 v255, a71
    s_nop 0
    v_mul_f32 v255, v255, v250
    s_nop 0
    v_accvgpr_write_b32 a71, v255
    v_accvgpr_read_b32 v252, a72
    s_nop 0
    v_mul_f32 v252, v252, v250
    s_nop 0
    v_accvgpr_write_b32 a72, v252
    v_accvgpr_read_b32 v253, a73
    s_nop 0
    v_mul_f32 v253, v253, v250
    s_nop 0
    v_accvgpr_write_b32 a73, v253
    v_accvgpr_read_b32 v254, a74
    s_nop 0
    v_mul_f32 v254, v254, v250
    s_nop 0
    v_accvgpr_write_b32 a74, v254
    v_accvgpr_read_b32 v255, a75
    s_nop 0
    v_mul_f32 v255, v255, v250
    s_nop 0
    v_accvgpr_write_b32 a75, v255
    v_accvgpr_read_b32 v252, a76
    s_nop 0
    v_mul_f32 v252, v252, v250
    s_nop 0
    v_accvgpr_write_b32 a76, v252
    v_accvgpr_read_b32 v253, a77
    s_nop 0
    v_mul_f32 v253, v253, v250
    s_nop 0
    v_accvgpr_write_b32 a77, v253
    v_accvgpr_read_b32 v254, a78
    s_nop 0
    v_mul_f32 v254, v254, v250
    s_nop 0
    v_accvgpr_write_b32 a78, v254
    v_accvgpr_read_b32 v255, a79
    s_nop 0
    v_mul_f32 v255, v255, v250
    s_nop 0
    v_accvgpr_write_b32 a79, v255
    v_accvgpr_read_b32 v252, a80
    s_nop 0
    v_mul_f32 v252, v252, v251
    s_nop 0
    v_accvgpr_write_b32 a80, v252
    v_accvgpr_read_b32 v253, a81
    s_nop 0
    v_mul_f32 v253, v253, v251
    s_nop 0
    v_accvgpr_write_b32 a81, v253
    v_accvgpr_read_b32 v254, a82
    s_nop 0
    v_mul_f32 v254, v254, v251
    s_nop 0
    v_accvgpr_write_b32 a82, v254
    v_accvgpr_read_b32 v255, a83
    s_nop 0
    v_mul_f32 v255, v255, v251
    s_nop 0
    v_accvgpr_write_b32 a83, v255
    v_accvgpr_read_b32 v252, a84
    s_nop 0
    v_mul_f32 v252, v252, v251
    s_nop 0
    v_accvgpr_write_b32 a84, v252
    v_accvgpr_read_b32 v253, a85
    s_nop 0
    v_mul_f32 v253, v253, v251
    s_nop 0
    v_accvgpr_write_b32 a85, v253
    v_accvgpr_read_b32 v254, a86
    s_nop 0
    v_mul_f32 v254, v254, v251
    s_nop 0
    v_accvgpr_write_b32 a86, v254
    v_accvgpr_read_b32 v255, a87
    s_nop 0
    v_mul_f32 v255, v255, v251
    s_nop 0
    v_accvgpr_write_b32 a87, v255
    v_accvgpr_read_b32 v252, a88
    s_nop 0
    v_mul_f32 v252, v252, v251
    s_nop 0
    v_accvgpr_write_b32 a88, v252
    v_accvgpr_read_b32 v253, a89
    s_nop 0
    v_mul_f32 v253, v253, v251
    s_nop 0
    v_accvgpr_write_b32 a89, v253
    v_accvgpr_read_b32 v254, a90
    s_nop 0
    v_mul_f32 v254, v254, v251
    s_nop 0
    v_accvgpr_write_b32 a90, v254
    v_accvgpr_read_b32 v255, a91
    s_nop 0
    v_mul_f32 v255, v255, v251
    s_nop 0
    v_accvgpr_write_b32 a91, v255
    v_accvgpr_read_b32 v252, a92
    s_nop 0
    v_mul_f32 v252, v252, v251
    s_nop 0
    v_accvgpr_write_b32 a92, v252
    v_accvgpr_read_b32 v253, a93
    s_nop 0
    v_mul_f32 v253, v253, v251
    s_nop 0
    v_accvgpr_write_b32 a93, v253
    v_accvgpr_read_b32 v254, a94
    s_nop 0
    v_mul_f32 v254, v254, v251
    s_nop 0
    v_accvgpr_write_b32 a94, v254
    v_accvgpr_read_b32 v255, a95
    s_nop 0
    v_mul_f32 v255, v255, v251
    s_nop 0
    v_accvgpr_write_b32 a95, v255
    v_accvgpr_read_b32 v252, a96
    s_nop 0
    v_mul_f32 v252, v252, v250
    s_nop 0
    v_accvgpr_write_b32 a96, v252
    v_accvgpr_read_b32 v253, a97
    s_nop 0
    v_mul_f32 v253, v253, v250
    s_nop 0
    v_accvgpr_write_b32 a97, v253
    v_accvgpr_read_b32 v254, a98
    s_nop 0
    v_mul_f32 v254, v254, v250
    s_nop 0
    v_accvgpr_write_b32 a98, v254
    v_accvgpr_read_b32 v255, a99
    s_nop 0
    v_mul_f32 v255, v255, v250
    s_nop 0
    v_accvgpr_write_b32 a99, v255
    v_accvgpr_read_b32 v252, a100
    s_nop 0
    v_mul_f32 v252, v252, v250
    s_nop 0
    v_accvgpr_write_b32 a100, v252
    v_accvgpr_read_b32 v253, a101
    s_nop 0
    v_mul_f32 v253, v253, v250
    s_nop 0
    v_accvgpr_write_b32 a101, v253
    v_accvgpr_read_b32 v254, a102
    s_nop 0
    v_mul_f32 v254, v254, v250
    s_nop 0
    v_accvgpr_write_b32 a102, v254
    v_accvgpr_read_b32 v255, a103
    s_nop 0
    v_mul_f32 v255, v255, v250
    s_nop 0
    v_accvgpr_write_b32 a103, v255
    v_accvgpr_read_b32 v252, a104
    s_nop 0
    v_mul_f32 v252, v252, v250
    s_nop 0
    v_accvgpr_write_b32 a104, v252
    v_accvgpr_read_b32 v253, a105
    s_nop 0
    v_mul_f32 v253, v253, v250
    s_nop 0
    v_accvgpr_write_b32 a105, v253
    v_accvgpr_read_b32 v254, a106
    s_nop 0
    v_mul_f32 v254, v254, v250
    s_nop 0
    v_accvgpr_write_b32 a106, v254
    v_accvgpr_read_b32 v255, a107
    s_nop 0
    v_mul_f32 v255, v255, v250
    s_nop 0
    v_accvgpr_write_b32 a107, v255
    v_accvgpr_read_b32 v252, a108
    s_nop 0
    v_mul_f32 v252, v252, v250
    s_nop 0
    v_accvgpr_write_b32 a108, v252
    v_accvgpr_read_b32 v253, a109
    s_nop 0
    v_mul_f32 v253, v253, v250
    s_nop 0
    v_accvgpr_write_b32 a109, v253
    v_accvgpr_read_b32 v254, a110
    s_nop 0
    v_mul_f32 v254, v254, v250
    s_nop 0
    v_accvgpr_write_b32 a110, v254
    v_accvgpr_read_b32 v255, a111
    s_nop 0
    v_mul_f32 v255, v255, v250
    s_nop 0
    v_accvgpr_write_b32 a111, v255
    v_accvgpr_read_b32 v252, a112
    s_nop 0
    v_mul_f32 v252, v252, v251
    s_nop 0
    v_accvgpr_write_b32 a112, v252
    v_accvgpr_read_b32 v253, a113
    s_nop 0
    v_mul_f32 v253, v253, v251
    s_nop 0
    v_accvgpr_write_b32 a113, v253
    v_accvgpr_read_b32 v254, a114
    s_nop 0
    v_mul_f32 v254, v254, v251
    s_nop 0
    v_accvgpr_write_b32 a114, v254
    v_accvgpr_read_b32 v255, a115
    s_nop 0
    v_mul_f32 v255, v255, v251
    s_nop 0
    v_accvgpr_write_b32 a115, v255
    v_accvgpr_read_b32 v252, a116
    s_nop 0
    v_mul_f32 v252, v252, v251
    s_nop 0
    v_accvgpr_write_b32 a116, v252
    v_accvgpr_read_b32 v253, a117
    s_nop 0
    v_mul_f32 v253, v253, v251
    s_nop 0
    v_accvgpr_write_b32 a117, v253
    v_accvgpr_read_b32 v254, a118
    s_nop 0
    v_mul_f32 v254, v254, v251
    s_nop 0
    v_accvgpr_write_b32 a118, v254
    v_accvgpr_read_b32 v255, a119
    s_nop 0
    v_mul_f32 v255, v255, v251
    s_nop 0
    v_accvgpr_write_b32 a119, v255
    v_accvgpr_read_b32 v252, a120
    s_nop 0
    v_mul_f32 v252, v252, v251
    s_nop 0
    v_accvgpr_write_b32 a120, v252
    v_accvgpr_read_b32 v253, a121
    s_nop 0
    v_mul_f32 v253, v253, v251
    s_nop 0
    v_accvgpr_write_b32 a121, v253
    v_accvgpr_read_b32 v254, a122
    s_nop 0
    v_mul_f32 v254, v254, v251
    s_nop 0
    v_accvgpr_write_b32 a122, v254
    v_accvgpr_read_b32 v255, a123
    s_nop 0
    v_mul_f32 v255, v255, v251
    s_nop 0
    v_accvgpr_write_b32 a123, v255
    v_accvgpr_read_b32 v252, a124
    s_nop 0
    v_mul_f32 v252, v252, v251
    s_nop 0
    v_accvgpr_write_b32 a124, v252
    v_accvgpr_read_b32 v253, a125
    s_nop 0
    v_mul_f32 v253, v253, v251
    s_nop 0
    v_accvgpr_write_b32 a125, v253
    v_accvgpr_read_b32 v254, a126
    s_nop 0
    v_mul_f32 v254, v254, v251
    s_nop 0
    v_accvgpr_write_b32 a126, v254
    v_accvgpr_read_b32 v255, a127
    s_nop 0
    v_mul_f32 v255, v255, v251
    s_nop 0
    v_accvgpr_write_b32 a127, v255
    v_sub_f32 v192, v192, v246
    v_sub_f32 v193, v193, v246
    v_sub_f32 v194, v194, v246
    v_sub_f32 v195, v195, v246
    v_sub_f32 v196, v196, v246
    v_sub_f32 v197, v197, v246
    v_sub_f32 v198, v198, v246
    v_sub_f32 v199, v199, v246
    v_sub_f32 v200, v200, v246
    v_sub_f32 v201, v201, v246
    v_sub_f32 v202, v202, v246
    v_sub_f32 v203, v203, v246
    v_sub_f32 v204, v204, v246
    v_sub_f32 v205, v205, v246
    v_sub_f32 v206, v206, v246
    v_sub_f32 v207, v207, v246
    v_sub_f32 v208, v208, v247
    v_sub_f32 v209, v209, v247
    v_sub_f32 v210, v210, v247
    v_sub_f32 v211, v211, v247
    v_sub_f32 v212, v212, v247
    v_sub_f32 v213, v213, v247
    v_sub_f32 v214, v214, v247
    v_sub_f32 v215, v215, v247
    v_sub_f32 v216, v216, v247
    v_sub_f32 v217, v217, v247
    v_sub_f32 v218, v218, v247
    v_sub_f32 v219, v219, v247
    v_sub_f32 v220, v220, v247
    v_sub_f32 v221, v221, v247
    v_sub_f32 v222, v222, v247
    v_sub_f32 v223, v223, v247
    v_sub_f32 v64, v64, v246
    v_sub_f32 v65, v65, v246
    v_sub_f32 v66, v66, v246
    v_sub_f32 v67, v67, v246
    v_sub_f32 v68, v68, v246
    v_sub_f32 v69, v69, v246
    v_sub_f32 v70, v70, v246
    v_sub_f32 v71, v71, v246
    v_sub_f32 v72, v72, v246
    v_sub_f32 v73, v73, v246
    v_sub_f32 v74, v74, v246
    v_sub_f32 v75, v75, v246
    v_sub_f32 v76, v76, v246
    v_sub_f32 v77, v77, v246
    v_sub_f32 v78, v78, v246
    v_sub_f32 v79, v79, v246
    v_sub_f32 v80, v80, v247
    v_sub_f32 v81, v81, v247
    v_sub_f32 v82, v82, v247
    v_sub_f32 v83, v83, v247
    v_sub_f32 v84, v84, v247
    v_sub_f32 v85, v85, v247
    v_sub_f32 v86, v86, v247
    v_sub_f32 v87, v87, v247
    v_sub_f32 v88, v88, v247
    v_sub_f32 v89, v89, v247
    v_sub_f32 v90, v90, v247
    v_sub_f32 v91, v91, v247
    v_sub_f32 v92, v92, v247
    v_sub_f32 v93, v93, v247
    v_sub_f32 v94, v94, v247
    v_sub_f32 v95, v95, v247
    v_sub_f32 v96, v96, v246
    v_sub_f32 v97, v97, v246
    v_sub_f32 v98, v98, v246
    v_sub_f32 v99, v99, v246
    v_sub_f32 v100, v100, v246
    v_sub_f32 v101, v101, v246
    v_sub_f32 v102, v102, v246
    v_sub_f32 v103, v103, v246
    v_sub_f32 v104, v104, v246
    v_sub_f32 v105, v105, v246
    v_sub_f32 v106, v106, v246
    v_sub_f32 v107, v107, v246
    v_sub_f32 v108, v108, v246
    v_sub_f32 v109, v109, v246
    v_sub_f32 v110, v110, v246
    v_sub_f32 v111, v111, v246
    v_sub_f32 v112, v112, v247
    v_sub_f32 v113, v113, v247
    v_sub_f32 v114, v114, v247
    v_sub_f32 v115, v115, v247
    v_sub_f32 v116, v116, v247
    v_sub_f32 v117, v117, v247
    v_sub_f32 v118, v118, v247
    v_sub_f32 v119, v119, v247
    v_sub_f32 v120, v120, v247
    v_sub_f32 v121, v121, v247
    v_sub_f32 v122, v122, v247
    v_sub_f32 v123, v123, v247
    v_sub_f32 v124, v124, v247
    v_sub_f32 v125, v125, v247
    v_sub_f32 v126, v126, v247
    v_sub_f32 v127, v127, v247
    v_exp_f32 v64, v64
    v_exp_f32 v65, v65
    v_exp_f32 v66, v66
    v_exp_f32 v67, v67
    v_exp_f32 v68, v68
    v_exp_f32 v69, v69
    v_exp_f32 v70, v70
    v_exp_f32 v71, v71
    v_exp_f32 v72, v72
    v_exp_f32 v73, v73
    v_exp_f32 v74, v74
    v_exp_f32 v75, v75
    v_exp_f32 v76, v76
    v_exp_f32 v77, v77
    v_exp_f32 v78, v78
    v_exp_f32 v79, v79
    v_exp_f32 v80, v80
    v_exp_f32 v81, v81
    v_exp_f32 v82, v82
    v_exp_f32 v83, v83
    v_exp_f32 v84, v84
    v_exp_f32 v85, v85
    v_exp_f32 v86, v86
    v_exp_f32 v87, v87
    v_exp_f32 v88, v88
    v_exp_f32 v89, v89
    v_exp_f32 v90, v90
    v_exp_f32 v91, v91
    v_exp_f32 v92, v92
    v_exp_f32 v93, v93
    v_exp_f32 v94, v94
    v_exp_f32 v95, v95
    v_exp_f32 v96, v96
    v_exp_f32 v97, v97
    v_exp_f32 v98, v98
    v_exp_f32 v99, v99
    v_exp_f32 v100, v100
    v_exp_f32 v101, v101
    v_exp_f32 v102, v102
    v_exp_f32 v103, v103
    v_exp_f32 v104, v104
    v_exp_f32 v105, v105
    v_exp_f32 v106, v106
    v_exp_f32 v107, v107
    v_exp_f32 v108, v108
    v_exp_f32 v109, v109
    v_exp_f32 v110, v110
    v_exp_f32 v111, v111
    v_exp_f32 v112, v112
    v_exp_f32 v113, v113
    v_exp_f32 v114, v114
    v_exp_f32 v115, v115
    v_exp_f32 v116, v116
    v_exp_f32 v117, v117
    v_exp_f32 v118, v118
    v_exp_f32 v119, v119
    v_exp_f32 v120, v120
    v_exp_f32 v121, v121
    v_exp_f32 v122, v122
    v_exp_f32 v123, v123
    v_exp_f32 v124, v124
    v_exp_f32 v125, v125
    v_exp_f32 v126, v126
    v_exp_f32 v127, v127
    s_nop 0
    v_add_f32 v243, v64, v65
    v_add_f32 v243, v243, v66
    v_add_f32 v243, v243, v67
    v_add_f32 v243, v243, v68
    v_add_f32 v243, v243, v69
    v_add_f32 v243, v243, v70
    v_add_f32 v243, v243, v71
    v_add_f32 v243, v243, v72
    v_add_f32 v243, v243, v73
    v_add_f32 v243, v243, v74
    v_add_f32 v243, v243, v75
    v_add_f32 v243, v243, v76
    v_add_f32 v243, v243, v77
    v_add_f32 v243, v243, v78
    v_add_f32 v243, v243, v79
    v_add_f32 v243, v243, v96
    v_add_f32 v243, v243, v97
    v_add_f32 v243, v243, v98
    v_add_f32 v243, v243, v99
    v_add_f32 v243, v243, v100
    v_add_f32 v243, v243, v101
    v_add_f32 v243, v243, v102
    v_add_f32 v243, v243, v103
    v_add_f32 v243, v243, v104
    v_add_f32 v243, v243, v105
    v_add_f32 v243, v243, v106
    v_add_f32 v243, v243, v107
    v_add_f32 v243, v243, v108
    v_add_f32 v243, v243, v109
    v_add_f32 v243, v243, v110
    v_add_f32 v243, v243, v111
    v_add_f32 v244, v80, v81
    v_add_f32 v244, v244, v82
    v_add_f32 v244, v244, v83
    v_add_f32 v244, v244, v84
    v_add_f32 v244, v244, v85
    v_add_f32 v244, v244, v86
    v_add_f32 v244, v244, v87
    v_add_f32 v244, v244, v88
    v_add_f32 v244, v244, v89
    v_add_f32 v244, v244, v90
    v_add_f32 v244, v244, v91
    v_add_f32 v244, v244, v92
    v_add_f32 v244, v244, v93
    v_add_f32 v244, v244, v94
    v_add_f32 v244, v244, v95
    v_add_f32 v244, v244, v112
    v_add_f32 v244, v244, v113
    v_add_f32 v244, v244, v114
    v_add_f32 v244, v244, v115
    v_add_f32 v244, v244, v116
    v_add_f32 v244, v244, v117
    v_add_f32 v244, v244, v118
    v_add_f32 v244, v244, v119
    v_add_f32 v244, v244, v120
    v_add_f32 v244, v244, v121
    v_add_f32 v244, v244, v122
    v_add_f32 v244, v244, v123
    v_add_f32 v244, v244, v124
    v_add_f32 v244, v244, v125
    v_add_f32 v244, v244, v126
    v_add_f32 v244, v244, v127
    v_cvt_pk_bf16_f32 v160, v64, v65
    v_cvt_pk_bf16_f32 v161, v66, v67
    v_cvt_pk_bf16_f32 v162, v68, v69
    v_cvt_pk_bf16_f32 v163, v70, v71
    v_cvt_pk_bf16_f32 v168, v72, v73
    v_cvt_pk_bf16_f32 v169, v74, v75
    v_cvt_pk_bf16_f32 v170, v76, v77
    v_cvt_pk_bf16_f32 v171, v78, v79
    v_cvt_pk_bf16_f32 v164, v80, v81
    v_cvt_pk_bf16_f32 v165, v82, v83
    v_cvt_pk_bf16_f32 v166, v84, v85
    v_cvt_pk_bf16_f32 v167, v86, v87
    v_cvt_pk_bf16_f32 v172, v88, v89
    v_cvt_pk_bf16_f32 v173, v90, v91
    v_cvt_pk_bf16_f32 v174, v92, v93
    v_cvt_pk_bf16_f32 v175, v94, v95
    v_cvt_pk_bf16_f32 v176, v96, v97
    v_cvt_pk_bf16_f32 v177, v98, v99
    v_cvt_pk_bf16_f32 v178, v100, v101
    v_cvt_pk_bf16_f32 v179, v102, v103
    v_cvt_pk_bf16_f32 v184, v104, v105
    v_cvt_pk_bf16_f32 v185, v106, v107
    v_cvt_pk_bf16_f32 v186, v108, v109
    v_cvt_pk_bf16_f32 v187, v110, v111
    v_cvt_pk_bf16_f32 v180, v112, v113
    v_cvt_pk_bf16_f32 v181, v114, v115
    v_cvt_pk_bf16_f32 v182, v116, v117
    v_cvt_pk_bf16_f32 v183, v118, v119
    v_cvt_pk_bf16_f32 v188, v120, v121
    v_cvt_pk_bf16_f32 v189, v122, v123
    v_cvt_pk_bf16_f32 v190, v124, v125
    v_cvt_pk_bf16_f32 v191, v126, v127
    v_sub_f32 v0, v0, v246
    v_sub_f32 v1, v1, v246
    v_sub_f32 v2, v2, v246
    v_sub_f32 v3, v3, v246
    v_sub_f32 v4, v4, v246
    v_sub_f32 v5, v5, v246
    v_sub_f32 v6, v6, v246
    v_sub_f32 v7, v7, v246
    v_sub_f32 v8, v8, v246
    v_sub_f32 v9, v9, v246
    v_sub_f32 v10, v10, v246
    v_sub_f32 v11, v11, v246
    v_sub_f32 v12, v12, v246
    v_sub_f32 v13, v13, v246
    v_sub_f32 v14, v14, v246
    v_sub_f32 v15, v15, v246
    v_sub_f32 v16, v16, v247
    v_sub_f32 v17, v17, v247
    v_sub_f32 v18, v18, v247
    v_sub_f32 v19, v19, v247
    v_sub_f32 v20, v20, v247
    v_sub_f32 v21, v21, v247
    v_sub_f32 v22, v22, v247
    v_sub_f32 v23, v23, v247
    v_sub_f32 v24, v24, v247
    v_sub_f32 v25, v25, v247
    v_sub_f32 v26, v26, v247
    v_sub_f32 v27, v27, v247
    v_sub_f32 v28, v28, v247
    v_sub_f32 v29, v29, v247
    v_sub_f32 v30, v30, v247
    v_sub_f32 v31, v31, v247
    v_sub_f32 v32, v32, v246
    v_sub_f32 v33, v33, v246
    v_sub_f32 v34, v34, v246
    v_sub_f32 v35, v35, v246
    v_sub_f32 v36, v36, v246
    v_sub_f32 v37, v37, v246
    v_sub_f32 v38, v38, v246
    v_sub_f32 v39, v39, v246
    v_sub_f32 v40, v40, v246
    v_sub_f32 v41, v41, v246
    v_sub_f32 v42, v42, v246
    v_sub_f32 v43, v43, v246
    v_sub_f32 v44, v44, v246
    v_sub_f32 v45, v45, v246
    v_sub_f32 v46, v46, v246
    v_sub_f32 v47, v47, v246
    v_sub_f32 v48, v48, v247
    v_sub_f32 v49, v49, v247
    v_sub_f32 v50, v50, v247
    v_sub_f32 v51, v51, v247
    v_sub_f32 v52, v52, v247
    v_sub_f32 v53, v53, v247
    v_sub_f32 v54, v54, v247
    v_sub_f32 v55, v55, v247
    v_sub_f32 v56, v56, v247
    v_sub_f32 v57, v57, v247
    v_sub_f32 v58, v58, v247
    v_sub_f32 v59, v59, v247
    v_sub_f32 v60, v60, v247
    v_sub_f32 v61, v61, v247
    v_sub_f32 v62, v62, v247
    v_sub_f32 v63, v63, v247
    s_nop 7
    ds_read_b128 a[192:195], v224 offset:32768
    ds_read_b128 a[196:199], v225 offset:32768
    ds_read_b128 a[200:203], v226 offset:32768
    ds_read_b128 a[204:207], v227 offset:32768
    s_branch L_ret2
L_rare3:
    s_nop 15
    s_nop 3
    s_waitcnt vmcnt(0) lgkmcnt(0)
    s_add_u32 s46, s35, 8192
    buffer_load_dwordx4 a[192:195], v245, s[8:11], s35 offen
    buffer_load_dwordx4 a[196:199], v245, s[8:11], s35 offen offset:32
    buffer_load_dwordx4 a[200:203], v245, s[8:11], s35 offen offset:64
    buffer_load_dwordx4 a[204:207], v245, s[8:11], s35 offen offset:96
    buffer_load_dwordx4 a[208:211], v245, s[8:11], s35 offen offset:128
    buffer_load_dwordx4 a[212:215], v245, s[8:11], s35 offen offset:160
    buffer_load_dwordx4 a[216:219], v245, s[8:11], s35 offen offset:192
    buffer_load_dwordx4 a[220:223], v245, s[8:11], s35 offen offset:224
    buffer_load_dwordx4 a[224:227], v245, s[8:11], s46 offen
    buffer_load_dwordx4 a[228:231], v245, s[8:11], s46 offen offset:32
    buffer_load_dwordx4 a[232:235], v245, s[8:11], s46 offen offset:64
    buffer_load_dwordx4 a[236:239], v245, s[8:11], s46 offen offset:96
    buffer_load_dwordx4 a[240:243], v245, s[8:11], s46 offen offset:128
    buffer_load_dwordx4 a[244:247], v245, s[8:11], s46 offen offset:160
    buffer_load_dwordx4 a[248:251], v245, s[8:11], s46 offen offset:192
    buffer_load_dwordx4 a[252:255], v245, s[8:11], s46 offen offset:224
    s_waitcnt vmcnt(0)
    s_nop 1
    v_mfma_f32_32x32x16_bf16 v[0:15], a[192:195], a[128:131], v[192:207]
    v_mfma_f32_32x32x16_bf16 v[16:31], a[192:195], a[160:163], v[208:223]
    v_mfma_f32_32x32x16_bf16 v[0:15], a[196:199], a[132:135], v[0:15]
    v_mfma_f32_32x32x16_bf16 v[16:31], a[196:199], a[164:167], v[16:31]
    v_mfma_f32_32x32x16_bf16 v[0:15], a[200:203], a[136:139], v[0:15]
    v_mfma_f32_32x32x16_bf16 v[16:31], a[200:203], a[168:171], v[16:31]
    v_mfma_f32_32x32x16_bf16 v[0:15], a[204:207], a[140:143], v[0:15]
    v_mfma_f32_32x32x16_bf16 v[16:31], a[204:207], a[172:175], v[16:31]
    v_mfma_f32_32x32x16_bf16 v[0:15], a[208:211], a[144:147], v[0:15]
    v_mfma_f32_32x32x16_bf16 v[16:31], a[208:211], a[176:179], v[16:31]
    v_mfma_f32_32x32x16_bf16 v[0:15], a[212:215], a[148:151], v[0:15]
    v_mfma_f32_32x32x16_bf16 v[16:31], a[212:215], a[180:183], v[16:31]
    v_mfma_f32_32x32x16_bf16 v[0:15], a[216:219], a[152:155], v[0:15]
    v_mfma_f32_32x32x16_bf16 v[16:31], a[216:219], a[184:187], v[16:31]
    v_mfma_f32_32x32x16_bf16 v[0:15], a[220:223], a[156:159], v[0:15]
    v_mfma_f32_32x32x16_bf16 v[16:31], a[220:223], a[188:191], v[16:31]
    v_mfma_f32_32x32x16_bf16 v[32:47], a[224:227], a[128:131], v[192:207]
    v_mfma_f32_32x32x16_bf16 v[48:63], a[224:227], a[160:163], v[208:223]
    v_mfma_f32_32x32x16_bf16 v[32:47], a[228:231], a[132:135], v[32:47]
    v_mfma_f32_32x32x16_bf16 v[48:63], a[228:231], a[164:167], v[48:63]
    v_mfma_f32_32x32x16_bf16 v[32:47], a[232:235], a[136:139], v[32:47]
    v_mfma_f32_32x32x16_bf16 v[48:63], a[232:235], a[168:171], v[48:63]
    v_mfma_f32_32x32x16_bf16 v[32:47], a[236:239], a[140:143], v[32:47]
    v_mfma_f32_32x32x16_bf16 v[48:63], a[236:239], a[172:175], v[48:63]
    v_mfma_f32_32x32x16_bf16 v[32:47], a[240:243], a[144:147], v[32:47]
    v_mfma_f32_32x32x16_bf16 v[48:63], a[240:243], a[176:179], v[48:63]
    v_mfma_f32_32x32x16_bf16 v[32:47], a[244:247], a[148:151], v[32:47]
    v_mfma_f32_32x32x16_bf16 v[48:63], a[244:247], a[180:183], v[48:63]
    v_mfma_f32_32x32x16_bf16 v[32:47], a[248:251], a[152:155], v[32:47]
    v_mfma_f32_32x32x16_bf16 v[48:63], a[248:251], a[184:187], v[48:63]
    v_mfma_f32_32x32x16_bf16 v[32:47], a[252:255], a[156:159], v[32:47]
    v_mfma_f32_32x32x16_bf16 v[48:63], a[252:255], a[188:191], v[48:63]
    s_nop 15
    s_nop 3
    v_max3_f32 v246, v0, v1, v2
    v_max3_f32 v246, v246, v3, v4
    v_max3_f32 v246, v246, v5, v6
    v_max3_f32 v246, v246, v7, v8
    v_max3_f32 v246, v246, v9, v10
    v_max3_f32 v246, v246, v11, v12
    v_max3_f32 v246, v246, v13, v14
    v_max3_f32 v246, v246, v15, v32
    v_max3_f32 v246, v246, v33, v34
    v_max3_f32 v246, v246, v35, v36
    v_max3_f32 v246, v246, v37, v38
    v_max3_f32 v246, v246, v39, v40
    v_max3_f32 v246, v246, v41, v42
    v_max3_f32 v246, v246, v43, v44
    v_max3_f32 v246, v246, v45, v46
    v_max_f32 v246, v246, v47
    v_mov_b32 v248, v246
    v_mov_b32 v249, v246
    s_nop 1
    v_permlane32_swap_b32 v248, v249
    s_nop 1
    v_max_f32 v246, v248, v249
    v_max_f32 v246, 0, v246
    v_max3_f32 v247, v16, v17, v18
    v_max3_f32 v247, v247, v19, v20
    v_max3_f32 v247, v247, v21, v22
    v_max3_f32 v247, v247, v23, v24
    v_max3_f32 v247, v247, v25, v26
    v_max3_f32 v247, v247, v27, v28
    v_max3_f32 v247, v247, v29, v30
    v_max3_f32 v247, v247, v31, v48
    v_max3_f32 v247, v247, v49, v50
    v_max3_f32 v247, v247, v51, v52
    v_max3_f32 v247, v247, v53, v54
    v_max3_f32 v247, v247, v55, v56
    v_max3_f32 v247, v247, v57, v58
    v_max3_f32 v247, v247, v59, v60
    v_max3_f32 v247, v247, v61, v62
    v_max_f32 v247, v247, v63
    v_mov_b32 v248, v247
    v_mov_b32 v249, v247
    s_nop 1
    v_permlane32_swap_b32 v248, v249
    s_nop 1
    v_max_f32 v247, v248, v249
    v_max_f32 v247, 0, v247
    v_exp_f32_e64 v250, -v246
    v_exp_f32_e64 v251, -v247
    s_nop 1
    v_mul_f32 v241, v241, v250
    v_mul_f32 v242, v242, v251
    v_accvgpr_read_b32 v252, a0
    s_nop 0
    v_mul_f32 v252, v252, v250
    s_nop 0
    v_accvgpr_write_b32 a0, v252
    v_accvgpr_read_b32 v253, a1
    s_nop 0
    v_mul_f32 v253, v253, v250
    s_nop 0
    v_accvgpr_write_b32 a1, v253
    v_accvgpr_read_b32 v254, a2
    s_nop 0
    v_mul_f32 v254, v254, v250
    s_nop 0
    v_accvgpr_write_b32 a2, v254
    v_accvgpr_read_b32 v255, a3
    s_nop 0
    v_mul_f32 v255, v255, v250
    s_nop 0
    v_accvgpr_write_b32 a3, v255
    v_accvgpr_read_b32 v252, a4
    s_nop 0
    v_mul_f32 v252, v252, v250
    s_nop 0
    v_accvgpr_write_b32 a4, v252
    v_accvgpr_read_b32 v253, a5
    s_nop 0
    v_mul_f32 v253, v253, v250
    s_nop 0
    v_accvgpr_write_b32 a5, v253
    v_accvgpr_read_b32 v254, a6
    s_nop 0
    v_mul_f32 v254, v254, v250
    s_nop 0
    v_accvgpr_write_b32 a6, v254
    v_accvgpr_read_b32 v255, a7
    s_nop 0
    v_mul_f32 v255, v255, v250
    s_nop 0
    v_accvgpr_write_b32 a7, v255
    v_accvgpr_read_b32 v252, a8
    s_nop 0
    v_mul_f32 v252, v252, v250
    s_nop 0
    v_accvgpr_write_b32 a8, v252
    v_accvgpr_read_b32 v253, a9
    s_nop 0
    v_mul_f32 v253, v253, v250
    s_nop 0
    v_accvgpr_write_b32 a9, v253
    v_accvgpr_read_b32 v254, a10
    s_nop 0
    v_mul_f32 v254, v254, v250
    s_nop 0
    v_accvgpr_write_b32 a10, v254
    v_accvgpr_read_b32 v255, a11
    s_nop 0
    v_mul_f32 v255, v255, v250
    s_nop 0
    v_accvgpr_write_b32 a11, v255
    v_accvgpr_read_b32 v252, a12
    s_nop 0
    v_mul_f32 v252, v252, v250
    s_nop 0
    v_accvgpr_write_b32 a12, v252
    v_accvgpr_read_b32 v253, a13
    s_nop 0
    v_mul_f32 v253, v253, v250
    s_nop 0
    v_accvgpr_write_b32 a13, v253
    v_accvgpr_read_b32 v254, a14
    s_nop 0
    v_mul_f32 v254, v254, v250
    s_nop 0
    v_accvgpr_write_b32 a14, v254
    v_accvgpr_read_b32 v255, a15
    s_nop 0
    v_mul_f32 v255, v255, v250
    s_nop 0
    v_accvgpr_write_b32 a15, v255
    v_accvgpr_read_b32 v252, a16
    s_nop 0
    v_mul_f32 v252, v252, v251
    s_nop 0
    v_accvgpr_write_b32 a16, v252
    v_accvgpr_read_b32 v253, a17
    s_nop 0
    v_mul_f32 v253, v253, v251
    s_nop 0
    v_accvgpr_write_b32 a17, v253
    v_accvgpr_read_b32 v254, a18
    s_nop 0
    v_mul_f32 v254, v254, v251
    s_nop 0
    v_accvgpr_write_b32 a18, v254
    v_accvgpr_read_b32 v255, a19
    s_nop 0
    v_mul_f32 v255, v255, v251
    s_nop 0
    v_accvgpr_write_b32 a19, v255
    v_accvgpr_read_b32 v252, a20
    s_nop 0
    v_mul_f32 v252, v252, v251
    s_nop 0
    v_accvgpr_write_b32 a20, v252
    v_accvgpr_read_b32 v253, a21
    s_nop 0
    v_mul_f32 v253, v253, v251
    s_nop 0
    v_accvgpr_write_b32 a21, v253
    v_accvgpr_read_b32 v254, a22
    s_nop 0
    v_mul_f32 v254, v254, v251
    s_nop 0
    v_accvgpr_write_b32 a22, v254
    v_accvgpr_read_b32 v255, a23
    s_nop 0
    v_mul_f32 v255, v255, v251
    s_nop 0
    v_accvgpr_write_b32 a23, v255
    v_accvgpr_read_b32 v252, a24
    s_nop 0
    v_mul_f32 v252, v252, v251
    s_nop 0
    v_accvgpr_write_b32 a24, v252
    v_accvgpr_read_b32 v253, a25
    s_nop 0
    v_mul_f32 v253, v253, v251
    s_nop 0
    v_accvgpr_write_b32 a25, v253
    v_accvgpr_read_b32 v254, a26
    s_nop 0
    v_mul_f32 v254, v254, v251
    s_nop 0
    v_accvgpr_write_b32 a26, v254
    v_accvgpr_read_b32 v255, a27
    s_nop 0
    v_mul_f32 v255, v255, v251
    s_nop 0
    v_accvgpr_write_b32 a27, v255
    v_accvgpr_read_b32 v252, a28
    s_nop 0
    v_mul_f32 v252, v252, v251
    s_nop 0
    v_accvgpr_write_b32 a28, v252
    v_accvgpr_read_b32 v253, a29
    s_nop 0
    v_mul_f32 v253, v253, v251
    s_nop 0
    v_accvgpr_write_b32 a29, v253
    v_accvgpr_read_b32 v254, a30
    s_nop 0
    v_mul_f32 v254, v254, v251
    s_nop 0
    v_accvgpr_write_b32 a30, v254
    v_accvgpr_read_b32 v255, a31
    s_nop 0
    v_mul_f32 v255, v255, v251
    s_nop 0
    v_accvgpr_write_b32 a31, v255
    v_accvgpr_read_b32 v252, a32
    s_nop 0
    v_mul_f32 v252, v252, v250
    s_nop 0
    v_accvgpr_write_b32 a32, v252
    v_accvgpr_read_b32 v253, a33
    s_nop 0
    v_mul_f32 v253, v253, v250
    s_nop 0
    v_accvgpr_write_b32 a33, v253
    v_accvgpr_read_b32 v254, a34
    s_nop 0
    v_mul_f32 v254, v254, v250
    s_nop 0
    v_accvgpr_write_b32 a34, v254
    v_accvgpr_read_b32 v255, a35
    s_nop 0
    v_mul_f32 v255, v255, v250
    s_nop 0
    v_accvgpr_write_b32 a35, v255
    v_accvgpr_read_b32 v252, a36
    s_nop 0
    v_mul_f32 v252, v252, v250
    s_nop 0
    v_accvgpr_write_b32 a36, v252
    v_accvgpr_read_b32 v253, a37
    s_nop 0
    v_mul_f32 v253, v253, v250
    s_nop 0
    v_accvgpr_write_b32 a37, v253
    v_accvgpr_read_b32 v254, a38
    s_nop 0
    v_mul_f32 v254, v254, v250
    s_nop 0
    v_accvgpr_write_b32 a38, v254
    v_accvgpr_read_b32 v255, a39
    s_nop 0
    v_mul_f32 v255, v255, v250
    s_nop 0
    v_accvgpr_write_b32 a39, v255
    v_accvgpr_read_b32 v252, a40
    s_nop 0
    v_mul_f32 v252, v252, v250
    s_nop 0
    v_accvgpr_write_b32 a40, v252
    v_accvgpr_read_b32 v253, a41
    s_nop 0
    v_mul_f32 v253, v253, v250
    s_nop 0
    v_accvgpr_write_b32 a41, v253
    v_accvgpr_read_b32 v254, a42
    s_nop 0
    v_mul_f32 v254, v254, v250
    s_nop 0
    v_accvgpr_write_b32 a42, v254
    v_accvgpr_read_b32 v255, a43
    s_nop 0
    v_mul_f32 v255, v255, v250
    s_nop 0
    v_accvgpr_write_b32 a43, v255
    v_accvgpr_read_b32 v252, a44
    s_nop 0
    v_mul_f32 v252, v252, v250
    s_nop 0
    v_accvgpr_write_b32 a44, v252
    v_accvgpr_read_b32 v253, a45
    s_nop 0
    v_mul_f32 v253, v253, v250
    s_nop 0
    v_accvgpr_write_b32 a45, v253
    v_accvgpr_read_b32 v254, a46
    s_nop 0
    v_mul_f32 v254, v254, v250
    s_nop 0
    v_accvgpr_write_b32 a46, v254
    v_accvgpr_read_b32 v255, a47
    s_nop 0
    v_mul_f32 v255, v255, v250
    s_nop 0
    v_accvgpr_write_b32 a47, v255
    v_accvgpr_read_b32 v252, a48
    s_nop 0
    v_mul_f32 v252, v252, v251
    s_nop 0
    v_accvgpr_write_b32 a48, v252
    v_accvgpr_read_b32 v253, a49
    s_nop 0
    v_mul_f32 v253, v253, v251
    s_nop 0
    v_accvgpr_write_b32 a49, v253
    v_accvgpr_read_b32 v254, a50
    s_nop 0
    v_mul_f32 v254, v254, v251
    s_nop 0
    v_accvgpr_write_b32 a50, v254
    v_accvgpr_read_b32 v255, a51
    s_nop 0
    v_mul_f32 v255, v255, v251
    s_nop 0
    v_accvgpr_write_b32 a51, v255
    v_accvgpr_read_b32 v252, a52
    s_nop 0
    v_mul_f32 v252, v252, v251
    s_nop 0
    v_accvgpr_write_b32 a52, v252
    v_accvgpr_read_b32 v253, a53
    s_nop 0
    v_mul_f32 v253, v253, v251
    s_nop 0
    v_accvgpr_write_b32 a53, v253
    v_accvgpr_read_b32 v254, a54
    s_nop 0
    v_mul_f32 v254, v254, v251
    s_nop 0
    v_accvgpr_write_b32 a54, v254
    v_accvgpr_read_b32 v255, a55
    s_nop 0
    v_mul_f32 v255, v255, v251
    s_nop 0
    v_accvgpr_write_b32 a55, v255
    v_accvgpr_read_b32 v252, a56
    s_nop 0
    v_mul_f32 v252, v252, v251
    s_nop 0
    v_accvgpr_write_b32 a56, v252
    v_accvgpr_read_b32 v253, a57
    s_nop 0
    v_mul_f32 v253, v253, v251
    s_nop 0
    v_accvgpr_write_b32 a57, v253
    v_accvgpr_read_b32 v254, a58
    s_nop 0
    v_mul_f32 v254, v254, v251
    s_nop 0
    v_accvgpr_write_b32 a58, v254
    v_accvgpr_read_b32 v255, a59
    s_nop 0
    v_mul_f32 v255, v255, v251
    s_nop 0
    v_accvgpr_write_b32 a59, v255
    v_accvgpr_read_b32 v252, a60
    s_nop 0
    v_mul_f32 v252, v252, v251
    s_nop 0
    v_accvgpr_write_b32 a60, v252
    v_accvgpr_read_b32 v253, a61
    s_nop 0
    v_mul_f32 v253, v253, v251
    s_nop 0
    v_accvgpr_write_b32 a61, v253
    v_accvgpr_read_b32 v254, a62
    s_nop 0
    v_mul_f32 v254, v254, v251
    s_nop 0
    v_accvgpr_write_b32 a62, v254
    v_accvgpr_read_b32 v255, a63
    s_nop 0
    v_mul_f32 v255, v255, v251
    s_nop 0
    v_accvgpr_write_b32 a63, v255
    v_accvgpr_read_b32 v252, a64
    s_nop 0
    v_mul_f32 v252, v252, v250
    s_nop 0
    v_accvgpr_write_b32 a64, v252
    v_accvgpr_read_b32 v253, a65
    s_nop 0
    v_mul_f32 v253, v253, v250
    s_nop 0
    v_accvgpr_write_b32 a65, v253
    v_accvgpr_read_b32 v254, a66
    s_nop 0
    v_mul_f32 v254, v254, v250
    s_nop 0
    v_accvgpr_write_b32 a66, v254
    v_accvgpr_read_b32 v255, a67
    s_nop 0
    v_mul_f32 v255, v255, v250
    s_nop 0
    v_accvgpr_write_b32 a67, v255
    v_accvgpr_read_b32 v252, a68
    s_nop 0
    v_mul_f32 v252, v252, v250
    s_nop 0
    v_accvgpr_write_b32 a68, v252
    v_accvgpr_read_b32 v253, a69
    s_nop 0
    v_mul_f32 v253, v253, v250
    s_nop 0
    v_accvgpr_write_b32 a69, v253
    v_accvgpr_read_b32 v254, a70
    s_nop 0
    v_mul_f32 v254, v254, v250
    s_nop 0
    v_accvgpr_write_b32 a70, v254
    v_accvgpr_read_b32 v255, a71
    s_nop 0
    v_mul_f32 v255, v255, v250
    s_nop 0
    v_accvgpr_write_b32 a71, v255
    v_accvgpr_read_b32 v252, a72
    s_nop 0
    v_mul_f32 v252, v252, v250
    s_nop 0
    v_accvgpr_write_b32 a72, v252
    v_accvgpr_read_b32 v253, a73
    s_nop 0
    v_mul_f32 v253, v253, v250
    s_nop 0
    v_accvgpr_write_b32 a73, v253
    v_accvgpr_read_b32 v254, a74
    s_nop 0
    v_mul_f32 v254, v254, v250
    s_nop 0
    v_accvgpr_write_b32 a74, v254
    v_accvgpr_read_b32 v255, a75
    s_nop 0
    v_mul_f32 v255, v255, v250
    s_nop 0
    v_accvgpr_write_b32 a75, v255
    v_accvgpr_read_b32 v252, a76
    s_nop 0
    v_mul_f32 v252, v252, v250
    s_nop 0
    v_accvgpr_write_b32 a76, v252
    v_accvgpr_read_b32 v253, a77
    s_nop 0
    v_mul_f32 v253, v253, v250
    s_nop 0
    v_accvgpr_write_b32 a77, v253
    v_accvgpr_read_b32 v254, a78
    s_nop 0
    v_mul_f32 v254, v254, v250
    s_nop 0
    v_accvgpr_write_b32 a78, v254
    v_accvgpr_read_b32 v255, a79
    s_nop 0
    v_mul_f32 v255, v255, v250
    s_nop 0
    v_accvgpr_write_b32 a79, v255
    v_accvgpr_read_b32 v252, a80
    s_nop 0
    v_mul_f32 v252, v252, v251
    s_nop 0
    v_accvgpr_write_b32 a80, v252
    v_accvgpr_read_b32 v253, a81
    s_nop 0
    v_mul_f32 v253, v253, v251
    s_nop 0
    v_accvgpr_write_b32 a81, v253
    v_accvgpr_read_b32 v254, a82
    s_nop 0
    v_mul_f32 v254, v254, v251
    s_nop 0
    v_accvgpr_write_b32 a82, v254
    v_accvgpr_read_b32 v255, a83
    s_nop 0
    v_mul_f32 v255, v255, v251
    s_nop 0
    v_accvgpr_write_b32 a83, v255
    v_accvgpr_read_b32 v252, a84
    s_nop 0
    v_mul_f32 v252, v252, v251
    s_nop 0
    v_accvgpr_write_b32 a84, v252
    v_accvgpr_read_b32 v253, a85
    s_nop 0
    v_mul_f32 v253, v253, v251
    s_nop 0
    v_accvgpr_write_b32 a85, v253
    v_accvgpr_read_b32 v254, a86
    s_nop 0
    v_mul_f32 v254, v254, v251
    s_nop 0
    v_accvgpr_write_b32 a86, v254
    v_accvgpr_read_b32 v255, a87
    s_nop 0
    v_mul_f32 v255, v255, v251
    s_nop 0
    v_accvgpr_write_b32 a87, v255
    v_accvgpr_read_b32 v252, a88
    s_nop 0
    v_mul_f32 v252, v252, v251
    s_nop 0
    v_accvgpr_write_b32 a88, v252
    v_accvgpr_read_b32 v253, a89
    s_nop 0
    v_mul_f32 v253, v253, v251
    s_nop 0
    v_accvgpr_write_b32 a89, v253
    v_accvgpr_read_b32 v254, a90
    s_nop 0
    v_mul_f32 v254, v254, v251
    s_nop 0
    v_accvgpr_write_b32 a90, v254
    v_accvgpr_read_b32 v255, a91
    s_nop 0
    v_mul_f32 v255, v255, v251
    s_nop 0
    v_accvgpr_write_b32 a91, v255
    v_accvgpr_read_b32 v252, a92
    s_nop 0
    v_mul_f32 v252, v252, v251
    s_nop 0
    v_accvgpr_write_b32 a92, v252
    v_accvgpr_read_b32 v253, a93
    s_nop 0
    v_mul_f32 v253, v253, v251
    s_nop 0
    v_accvgpr_write_b32 a93, v253
    v_accvgpr_read_b32 v254, a94
    s_nop 0
    v_mul_f32 v254, v254, v251
    s_nop 0
    v_accvgpr_write_b32 a94, v254
    v_accvgpr_read_b32 v255, a95
    s_nop 0
    v_mul_f32 v255, v255, v251
    s_nop 0
    v_accvgpr_write_b32 a95, v255
    v_accvgpr_read_b32 v252, a96
    s_nop 0
    v_mul_f32 v252, v252, v250
    s_nop 0
    v_accvgpr_write_b32 a96, v252
    v_accvgpr_read_b32 v253, a97
    s_nop 0
    v_mul_f32 v253, v253, v250
    s_nop 0
    v_accvgpr_write_b32 a97, v253
    v_accvgpr_read_b32 v254, a98
    s_nop 0
    v_mul_f32 v254, v254, v250
    s_nop 0
    v_accvgpr_write_b32 a98, v254
    v_accvgpr_read_b32 v255, a99
    s_nop 0
    v_mul_f32 v255, v255, v250
    s_nop 0
    v_accvgpr_write_b32 a99, v255
    v_accvgpr_read_b32 v252, a100
    s_nop 0
    v_mul_f32 v252, v252, v250
    s_nop 0
    v_accvgpr_write_b32 a100, v252
    v_accvgpr_read_b32 v253, a101
    s_nop 0
    v_mul_f32 v253, v253, v250
    s_nop 0
    v_accvgpr_write_b32 a101, v253
    v_accvgpr_read_b32 v254, a102
    s_nop 0
    v_mul_f32 v254, v254, v250
    s_nop 0
    v_accvgpr_write_b32 a102, v254
    v_accvgpr_read_b32 v255, a103
    s_nop 0
    v_mul_f32 v255, v255, v250
    s_nop 0
    v_accvgpr_write_b32 a103, v255
    v_accvgpr_read_b32 v252, a104
    s_nop 0
    v_mul_f32 v252, v252, v250
    s_nop 0
    v_accvgpr_write_b32 a104, v252
    v_accvgpr_read_b32 v253, a105
    s_nop 0
    v_mul_f32 v253, v253, v250
    s_nop 0
    v_accvgpr_write_b32 a105, v253
    v_accvgpr_read_b32 v254, a106
    s_nop 0
    v_mul_f32 v254, v254, v250
    s_nop 0
    v_accvgpr_write_b32 a106, v254
    v_accvgpr_read_b32 v255, a107
    s_nop 0
    v_mul_f32 v255, v255, v250
    s_nop 0
    v_accvgpr_write_b32 a107, v255
    v_accvgpr_read_b32 v252, a108
    s_nop 0
    v_mul_f32 v252, v252, v250
    s_nop 0
    v_accvgpr_write_b32 a108, v252
    v_accvgpr_read_b32 v253, a109
    s_nop 0
    v_mul_f32 v253, v253, v250
    s_nop 0
    v_accvgpr_write_b32 a109, v253
    v_accvgpr_read_b32 v254, a110
    s_nop 0
    v_mul_f32 v254, v254, v250
    s_nop 0
    v_accvgpr_write_b32 a110, v254
    v_accvgpr_read_b32 v255, a111
    s_nop 0
    v_mul_f32 v255, v255, v250
    s_nop 0
    v_accvgpr_write_b32 a111, v255
    v_accvgpr_read_b32 v252, a112
    s_nop 0
    v_mul_f32 v252, v252, v251
    s_nop 0
    v_accvgpr_write_b32 a112, v252
    v_accvgpr_read_b32 v253, a113
    s_nop 0
    v_mul_f32 v253, v253, v251
    s_nop 0
    v_accvgpr_write_b32 a113, v253
    v_accvgpr_read_b32 v254, a114
    s_nop 0
    v_mul_f32 v254, v254, v251
    s_nop 0
    v_accvgpr_write_b32 a114, v254
    v_accvgpr_read_b32 v255, a115
    s_nop 0
    v_mul_f32 v255, v255, v251
    s_nop 0
    v_accvgpr_write_b32 a115, v255
    v_accvgpr_read_b32 v252, a116
    s_nop 0
    v_mul_f32 v252, v252, v251
    s_nop 0
    v_accvgpr_write_b32 a116, v252
    v_accvgpr_read_b32 v253, a117
    s_nop 0
    v_mul_f32 v253, v253, v251
    s_nop 0
    v_accvgpr_write_b32 a117, v253
    v_accvgpr_read_b32 v254, a118
    s_nop 0
    v_mul_f32 v254, v254, v251
    s_nop 0
    v_accvgpr_write_b32 a118, v254
    v_accvgpr_read_b32 v255, a119
    s_nop 0
    v_mul_f32 v255, v255, v251
    s_nop 0
    v_accvgpr_write_b32 a119, v255
    v_accvgpr_read_b32 v252, a120
    s_nop 0
    v_mul_f32 v252, v252, v251
    s_nop 0
    v_accvgpr_write_b32 a120, v252
    v_accvgpr_read_b32 v253, a121
    s_nop 0
    v_mul_f32 v253, v253, v251
    s_nop 0
    v_accvgpr_write_b32 a121, v253
    v_accvgpr_read_b32 v254, a122
    s_nop 0
    v_mul_f32 v254, v254, v251
    s_nop 0
    v_accvgpr_write_b32 a122, v254
    v_accvgpr_read_b32 v255, a123
    s_nop 0
    v_mul_f32 v255, v255, v251
    s_nop 0
    v_accvgpr_write_b32 a123, v255
    v_accvgpr_read_b32 v252, a124
    s_nop 0
    v_mul_f32 v252, v252, v251
    s_nop 0
    v_accvgpr_write_b32 a124, v252
    v_accvgpr_read_b32 v253, a125
    s_nop 0
    v_mul_f32 v253, v253, v251
    s_nop 0
    v_accvgpr_write_b32 a125, v253
    v_accvgpr_read_b32 v254, a126
    s_nop 0
    v_mul_f32 v254, v254, v251
    s_nop 0
    v_accvgpr_write_b32 a126, v254
    v_accvgpr_read_b32 v255, a127
    s_nop 0
    v_mul_f32 v255, v255, v251
    s_nop 0
    v_accvgpr_write_b32 a127, v255
    v_sub_f32 v192, v192, v246
    v_sub_f32 v193, v193, v246
    v_sub_f32 v194, v194, v246
    v_sub_f32 v195, v195, v246
    v_sub_f32 v196, v196, v246
    v_sub_f32 v197, v197, v246
    v_sub_f32 v198, v198, v246
    v_sub_f32 v199, v199, v246
    v_sub_f32 v200, v200, v246
    v_sub_f32 v201, v201, v246
    v_sub_f32 v202, v202, v246
    v_sub_f32 v203, v203, v246
    v_sub_f32 v204, v204, v246
    v_sub_f32 v205, v205, v246
    v_sub_f32 v206, v206, v246
    v_sub_f32 v207, v207, v246
    v_sub_f32 v208, v208, v247
    v_sub_f32 v209, v209, v247
    v_sub_f32 v210, v210, v247
    v_sub_f32 v211, v211, v247
    v_sub_f32 v212, v212, v247
    v_sub_f32 v213, v213, v247
    v_sub_f32 v214, v214, v247
    v_sub_f32 v215, v215, v247
    v_sub_f32 v216, v216, v247
    v_sub_f32 v217, v217, v247
    v_sub_f32 v218, v218, v247
    v_sub_f32 v219, v219, v247
    v_sub_f32 v220, v220, v247
    v_sub_f32 v221, v221, v247
    v_sub_f32 v222, v222, v247
    v_sub_f32 v223, v223, v247
    v_sub_f32 v0, v0, v246
    v_sub_f32 v1, v1, v246
    v_sub_f32 v2, v2, v246
    v_sub_f32 v3, v3, v246
    v_sub_f32 v4, v4, v246
    v_sub_f32 v5, v5, v246
    v_sub_f32 v6, v6, v246
    v_sub_f32 v7, v7, v246
    v_sub_f32 v8, v8, v246
    v_sub_f32 v9, v9, v246
    v_sub_f32 v10, v10, v246
    v_sub_f32 v11, v11, v246
    v_sub_f32 v12, v12, v246
    v_sub_f32 v13, v13, v246
    v_sub_f32 v14, v14, v246
    v_sub_f32 v15, v15, v246
    v_sub_f32 v16, v16, v247
    v_sub_f32 v17, v17, v247
    v_sub_f32 v18, v18, v247
    v_sub_f32 v19, v19, v247
    v_sub_f32 v20, v20, v247
    v_sub_f32 v21, v21, v247
    v_sub_f32 v22, v22, v247
    v_sub_f32 v23, v23, v247
    v_sub_f32 v24, v24, v247
    v_sub_f32 v25, v25, v247
    v_sub_f32 v26, v26, v247
    v_sub_f32 v27, v27, v247
    v_sub_f32 v28, v28, v247
    v_sub_f32 v29, v29, v247
    v_sub_f32 v30, v30, v247
    v_sub_f32 v31, v31, v247
    v_sub_f32 v32, v32, v246
    v_sub_f32 v33, v33, v246
    v_sub_f32 v34, v34, v246
    v_sub_f32 v35, v35, v246
    v_sub_f32 v36, v36, v246
    v_sub_f32 v37, v37, v246
    v_sub_f32 v38, v38, v246
    v_sub_f32 v39, v39, v246
    v_sub_f32 v40, v40, v246
    v_sub_f32 v41, v41, v246
    v_sub_f32 v42, v42, v246
    v_sub_f32 v43, v43, v246
    v_sub_f32 v44, v44, v246
    v_sub_f32 v45, v45, v246
    v_sub_f32 v46, v46, v246
    v_sub_f32 v47, v47, v246
    v_sub_f32 v48, v48, v247
    v_sub_f32 v49, v49, v247
    v_sub_f32 v50, v50, v247
    v_sub_f32 v51, v51, v247
    v_sub_f32 v52, v52, v247
    v_sub_f32 v53, v53, v247
    v_sub_f32 v54, v54, v247
    v_sub_f32 v55, v55, v247
    v_sub_f32 v56, v56, v247
    v_sub_f32 v57, v57, v247
    v_sub_f32 v58, v58, v247
    v_sub_f32 v59, v59, v247
    v_sub_f32 v60, v60, v247
    v_sub_f32 v61, v61, v247
    v_sub_f32 v62, v62, v247
    v_sub_f32 v63, v63, v247
    v_exp_f32 v0, v0
    v_exp_f32 v1, v1
    v_exp_f32 v2, v2
    v_exp_f32 v3, v3
    v_exp_f32 v4, v4
    v_exp_f32 v5, v5
    v_exp_f32 v6, v6
    v_exp_f32 v7, v7
    v_exp_f32 v8, v8
    v_exp_f32 v9, v9
    v_exp_f32 v10, v10
    v_exp_f32 v11, v11
    v_exp_f32 v12, v12
    v_exp_f32 v13, v13
    v_exp_f32 v14, v14
    v_exp_f32 v15, v15
    v_exp_f32 v16, v16
    v_exp_f32 v17, v17
    v_exp_f32 v18, v18
    v_exp_f32 v19, v19
    v_exp_f32 v20, v20
    v_exp_f32 v21, v21
    v_exp_f32 v22, v22
    v_exp_f32 v23, v23
    v_exp_f32 v24, v24
    v_exp_f32 v25, v25
    v_exp_f32 v26, v26
    v_exp_f32 v27, v27
    v_exp_f32 v28, v28
    v_exp_f32 v29, v29
    v_exp_f32 v30, v30
    v_exp_f32 v31, v31
    v_exp_f32 v32, v32
    v_exp_f32 v33, v33
    v_exp_f32 v34, v34
    v_exp_f32 v35, v35
    v_exp_f32 v36, v36
    v_exp_f32 v37, v37
    v_exp_f32 v38, v38
    v_exp_f32 v39, v39
    v_exp_f32 v40, v40
    v_exp_f32 v41, v41
    v_exp_f32 v42, v42
    v_exp_f32 v43, v43
    v_exp_f32 v44, v44
    v_exp_f32 v45, v45
    v_exp_f32 v46, v46
    v_exp_f32 v47, v47
    v_exp_f32 v48, v48
    v_exp_f32 v49, v49
    v_exp_f32 v50, v50
    v_exp_f32 v51, v51
    v_exp_f32 v52, v52
    v_exp_f32 v53, v53
    v_exp_f32 v54, v54
    v_exp_f32 v55, v55
    v_exp_f32 v56, v56
    v_exp_f32 v57, v57
    v_exp_f32 v58, v58
    v_exp_f32 v59, v59
    v_exp_f32 v60, v60
    v_exp_f32 v61, v61
    v_exp_f32 v62, v62
    v_exp_f32 v63, v63
    s_nop 0
    v_add_f32 v243, v0, v1
    v_add_f32 v243, v243, v2
    v_add_f32 v243, v243, v3
    v_add_f32 v243, v243, v4
    v_add_f32 v243, v243, v5
    v_add_f32 v243, v243, v6
    v_add_f32 v243, v243, v7
    v_add_f32 v243, v243, v8
    v_add_f32 v243, v243, v9
    v_add_f32 v243, v243, v10
    v_add_f32 v243, v243, v11
    v_add_f32 v243, v243, v12
    v_add_f32 v243, v243, v13
    v_add_f32 v243, v243, v14
    v_add_f32 v243, v243, v15
    v_add_f32 v243, v243, v32
    v_add_f32 v243, v243, v33
    v_add_f32 v243, v243, v34
    v_add_f32 v243, v243, v35
    v_add_f32 v243, v243, v36
    v_add_f32 v243, v243, v37
    v_add_f32 v243, v243, v38
    v_add_f32 v243, v243, v39
    v_add_f32 v243, v243, v40
    v_add_f32 v243, v243, v41
    v_add_f32 v243, v243, v42
    v_add_f32 v243, v243, v43
    v_add_f32 v243, v243, v44
    v_add_f32 v243, v243, v45
    v_add_f32 v243, v243, v46
    v_add_f32 v243, v243, v47
    v_add_f32 v244, v16, v17
    v_add_f32 v244, v244, v18
    v_add_f32 v244, v244, v19
    v_add_f32 v244, v244, v20
    v_add_f32 v244, v244, v21
    v_add_f32 v244, v244, v22
    v_add_f32 v244, v244, v23
    v_add_f32 v244, v244, v24
    v_add_f32 v244, v244, v25
    v_add_f32 v244, v244, v26
    v_add_f32 v244, v244, v27
    v_add_f32 v244, v244, v28
    v_add_f32 v244, v244, v29
    v_add_f32 v244, v244, v30
    v_add_f32 v244, v244, v31
    v_add_f32 v244, v244, v48
    v_add_f32 v244, v244, v49
    v_add_f32 v244, v244, v50
    v_add_f32 v244, v244, v51
    v_add_f32 v244, v244, v52
    v_add_f32 v244, v244, v53
    v_add_f32 v244, v244, v54
    v_add_f32 v244, v244, v55
    v_add_f32 v244, v244, v56
    v_add_f32 v244, v244, v57
    v_add_f32 v244, v244, v58
    v_add_f32 v244, v244, v59
    v_add_f32 v244, v244, v60
    v_add_f32 v244, v244, v61
    v_add_f32 v244, v244, v62
    v_add_f32 v244, v244, v63
    v_cvt_pk_bf16_f32 v128, v0, v1
    v_cvt_pk_bf16_f32 v129, v2, v3
    v_cvt_pk_bf16_f32 v130, v4, v5
    v_cvt_pk_bf16_f32 v131, v6, v7
    v_cvt_pk_bf16_f32 v136, v8, v9
    v_cvt_pk_bf16_f32 v137, v10, v11
    v_cvt_pk_bf16_f32 v138, v12, v13
    v_cvt_pk_bf16_f32 v139, v14, v15
    v_cvt_pk_bf16_f32 v132, v16, v17
    v_cvt_pk_bf16_f32 v133, v18, v19
    v_cvt_pk_bf16_f32 v134, v20, v21
    v_cvt_pk_bf16_f32 v135, v22, v23
    v_cvt_pk_bf16_f32 v140, v24, v25
    v_cvt_pk_bf16_f32 v141, v26, v27
    v_cvt_pk_bf16_f32 v142, v28, v29
    v_cvt_pk_bf16_f32 v143, v30, v31
    v_cvt_pk_bf16_f32 v144, v32, v33
    v_cvt_pk_bf16_f32 v145, v34, v35
    v_cvt_pk_bf16_f32 v146, v36, v37
    v_cvt_pk_bf16_f32 v147, v38, v39
    v_cvt_pk_bf16_f32 v152, v40, v41
    v_cvt_pk_bf16_f32 v153, v42, v43
    v_cvt_pk_bf16_f32 v154, v44, v45
    v_cvt_pk_bf16_f32 v155, v46, v47
    v_cvt_pk_bf16_f32 v148, v48, v49
    v_cvt_pk_bf16_f32 v149, v50, v51
    v_cvt_pk_bf16_f32 v150, v52, v53
    v_cvt_pk_bf16_f32 v151, v54, v55
    v_cvt_pk_bf16_f32 v156, v56, v57
    v_cvt_pk_bf16_f32 v157, v58, v59
    v_cvt_pk_bf16_f32 v158, v60, v61
    v_cvt_pk_bf16_f32 v159, v62, v63
    v_sub_f32 v64, v64, v246
    v_sub_f32 v65, v65, v246
    v_sub_f32 v66, v66, v246
    v_sub_f32 v67, v67, v246
    v_sub_f32 v68, v68, v246
    v_sub_f32 v69, v69, v246
    v_sub_f32 v70, v70, v246
    v_sub_f32 v71, v71, v246
    v_sub_f32 v72, v72, v246
    v_sub_f32 v73, v73, v246
    v_sub_f32 v74, v74, v246
    v_sub_f32 v75, v75, v246
    v_sub_f32 v76, v76, v246
    v_sub_f32 v77, v77, v246
    v_sub_f32 v78, v78, v246
    v_sub_f32 v79, v79, v246
    v_sub_f32 v80, v80, v247
    v_sub_f32 v81, v81, v247
    v_sub_f32 v82, v82, v247
    v_sub_f32 v83, v83, v247
    v_sub_f32 v84, v84, v247
    v_sub_f32 v85, v85, v247
    v_sub_f32 v86, v86, v247
    v_sub_f32 v87, v87, v247
    v_sub_f32 v88, v88, v247
    v_sub_f32 v89, v89, v247
    v_sub_f32 v90, v90, v247
    v_sub_f32 v91, v91, v247
    v_sub_f32 v92, v92, v247
    v_sub_f32 v93, v93, v247
    v_sub_f32 v94, v94, v247
    v_sub_f32 v95, v95, v247
    v_sub_f32 v96, v96, v246
    v_sub_f32 v97, v97, v246
    v_sub_f32 v98, v98, v246
    v_sub_f32 v99, v99, v246
    v_sub_f32 v100, v100, v246
    v_sub_f32 v101, v101, v246
    v_sub_f32 v102, v102, v246
    v_sub_f32 v103, v103, v246
    v_sub_f32 v104, v104, v246
    v_sub_f32 v105, v105, v246
    v_sub_f32 v106, v106, v246
    v_sub_f32 v107, v107, v246
    v_sub_f32 v108, v108, v246
    v_sub_f32 v109, v109, v246
    v_sub_f32 v110, v110, v246
    v_sub_f32 v111, v111, v246
    v_sub_f32 v112, v112, v247
    v_sub_f32 v113, v113, v247
    v_sub_f32 v114, v114, v247
    v_sub_f32 v115, v115, v247
    v_sub_f32 v116, v116, v247
    v_sub_f32 v117, v117, v247
    v_sub_f32 v118, v118, v247
    v_sub_f32 v119, v119, v247
    v_sub_f32 v120, v120, v247
    v_sub_f32 v121, v121, v247
    v_sub_f32 v122, v122, v247
    v_sub_f32 v123, v123, v247
    v_sub_f32 v124, v124, v247
    v_sub_f32 v125, v125, v247
    v_sub_f32 v126, v126, v247
    v_sub_f32 v127, v127, v247
    s_nop 7
    ds_read_b128 a[192:195], v224 offset:0
    ds_read_b128 a[196:199], v225 offset:0
    ds_read_b128 a[200:203], v226 offset:0
    ds_read_b128 a[204:207], v227 offset:0
    s_branch L_ret3
L_rare4:
    s_nop 15
    s_nop 3
    s_waitcnt vmcnt(0) lgkmcnt(0)
    s_add_u32 s46, s35, 8192
    buffer_load_dwordx4 a[192:195], v245, s[8:11], s35 offen
    buffer_load_dwordx4 a[196:199], v245, s[8:11], s35 offen offset:32
    buffer_load_dwordx4 a[200:203], v245, s[8:11], s35 offen offset:64
    buffer_load_dwordx4 a[204:207], v245, s[8:11], s35 offen offset:96
    buffer_load_dwordx4 a[208:211], v245, s[8:11], s35 offen offset:128
    buffer_load_dwordx4 a[212:215], v245, s[8:11], s35 offen offset:160
    buffer_load_dwordx4 a[216:219], v245, s[8:11], s35 offen offset:192
    buffer_load_dwordx4 a[220:223], v245, s[8:11], s35 offen offset:224
    buffer_load_dwordx4 a[224:227], v245, s[8:11], s46 offen
    buffer_load_dwordx4 a[228:231], v245, s[8:11], s46 offen offset:32
    buffer_load_dwordx4 a[232:235], v245, s[8:11], s46 offen offset:64
    buffer_load_dwordx4 a[236:239], v245, s[8:11], s46 offen offset:96
    buffer_load_dwordx4 a[240:243], v245, s[8:11], s46 offen offset:128
    buffer_load_dwordx4 a[244:247], v245, s[8:11], s46 offen offset:160
    buffer_load_dwordx4 a[248:251], v245, s[8:11], s46 offen offset:192
    buffer_load_dwordx4 a[252:255], v245, s[8:11], s46 offen offset:224
    s_waitcnt vmcnt(0)
    s_nop 1
    v_mfma_f32_32x32x16_bf16 v[64:79], a[192:195], a[128:131], v[192:207]
    v_mfma_f32_32x32x16_bf16 v[80:95], a[192:195], a[160:163], v[208:223]
    v_mfma_f32_32x32x16_bf16 v[64:79], a[196:199], a[132:135], v[64:79]
    v_mfma_f32_32x32x16_bf16 v[80:95], a[196:199], a[164:167], v[80:95]
    v_mfma_f32_32x32x16_bf16 v[64:79], a[200:203], a[136:139], v[64:79]
    v_mfma_f32_32x32x16_bf16 v[80:95], a[200:203], a[168:171], v[80:95]
    v_mfma_f32_32x32x16_bf16 v[64:79], a[204:207], a[140:143], v[64:79]
    v_mfma_f32_32x32x16_bf16 v[80:95], a[204:207], a[172:175], v[80:95]
    v_mfma_f32_32x32x16_bf16 v[64:79], a[208:211], a[144:147], v[64:79]
    v_mfma_f32_32x32x16_bf16 v[80:95], a[208:211], a[176:179], v[80:95]
    v_mfma_f32_32x32x16_bf16 v[64:79], a[212:215], a[148:151], v[64:79]
    v_mfma_f32_32x32x16_bf16 v[80:95], a[212:215], a[180:183], v[80:95]
    v_mfma_f32_32x32x16_bf16 v[64:79], a[216:219], a[152:155], v[64:79]
    v_mfma_f32_32x32x16_bf16 v[80:95], a[216:219], a[184:187], v[80:95]
    v_mfma_f32_32x32x16_bf16 v[64:79], a[220:223], a[156:159], v[64:79]
    v_mfma_f32_32x32x16_bf16 v[80:95], a[220:223], a[188:191], v[80:95]
    v_mfma_f32_32x32x16_bf16 v[96:111], a[224:227], a[128:131], v[192:207]
    v_mfma_f32_32x32x16_bf16 v[112:127], a[224:227], a[160:163], v[208:223]
    v_mfma_f32_32x32x16_bf16 v[96:111], a[228:231], a[132:135], v[96:111]
    v_mfma_f32_32x32x16_bf16 v[112:127], a[228:231], a[164:167], v[112:127]
    v_mfma_f32_32x32x16_bf16 v[96:111], a[232:235], a[136:139], v[96:111]
    v_mfma_f32_32x32x16_bf16 v[112:127], a[232:235], a[168:171], v[112:127]
    v_mfma_f32_32x32x16_bf16 v[96:111], a[236:239], a[140:143], v[96:111]
    v_mfma_f32_32x32x16_bf16 v[112:127], a[236:239], a[172:175], v[112:127]
    v_mfma_f32_32x32x16_bf16 v[96:111], a[240:243], a[144:147], v[96:111]
    v_mfma_f32_32x32x16_bf16 v[112:127], a[240:243], a[176:179], v[112:127]
    v_mfma_f32_32x32x16_bf16 v[96:111], a[244:247], a[148:151], v[96:111]
    v_mfma_f32_32x32x16_bf16 v[112:127], a[244:247], a[180:183], v[112:127]
    v_mfma_f32_32x32x16_bf16 v[96:111], a[248:251], a[152:155], v[96:111]
    v_mfma_f32_32x32x16_bf16 v[112:127], a[248:251], a[184:187], v[112:127]
    v_mfma_f32_32x32x16_bf16 v[96:111], a[252:255], a[156:159], v[96:111]
    v_mfma_f32_32x32x16_bf16 v[112:127], a[252:255], a[188:191], v[112:127]
    s_nop 15
    s_nop 3
    v_max3_f32 v246, v64, v65, v66
    v_max3_f32 v246, v246, v67, v68
    v_max3_f32 v246, v246, v69, v70
    v_max3_f32 v246, v246, v71, v72
    v_max3_f32 v246, v246, v73, v74
    v_max3_f32 v246, v246, v75, v76
    v_max3_f32 v246, v246, v77, v78
    v_max3_f32 v246, v246, v79, v96
    v_max3_f32 v246, v246, v97, v98
    v_max3_f32 v246, v246, v99, v100
    v_max3_f32 v246, v246, v101, v102
    v_max3_f32 v246, v246, v103, v104
    v_max3_f32 v246, v246, v105, v106
    v_max3_f32 v246, v246, v107, v108
    v_max3_f32 v246, v246, v109, v110
    v_max_f32 v246, v246, v111
    v_mov_b32 v248, v246
    v_mov_b32 v249, v246
    s_nop 1
    v_permlane32_swap_b32 v248, v249
    s_nop 1
    v_max_f32 v246, v248, v249
    v_max_f32 v246, 0, v246
    v_max3_f32 v247, v80, v81, v82
    v_max3_f32 v247, v247, v83, v84
    v_max3_f32 v247, v247, v85, v86
    v_max3_f32 v247, v247, v87, v88
    v_max3_f32 v247, v247, v89, v90
    v_max3_f32 v247, v247, v91, v92
    v_max3_f32 v247, v247, v93, v94
    v_max3_f32 v247, v247, v95, v112
    v_max3_f32 v247, v247, v113, v114
    v_max3_f32 v247, v247, v115, v116
    v_max3_f32 v247, v247, v117, v118
    v_max3_f32 v247, v247, v119, v120
    v_max3_f32 v247, v247, v121, v122
    v_max3_f32 v247, v247, v123, v124
    v_max3_f32 v247, v247, v125, v126
    v_max_f32 v247, v247, v127
    v_mov_b32 v248, v247
    v_mov_b32 v249, v247
    s_nop 1
    v_permlane32_swap_b32 v248, v249
    s_nop 1
    v_max_f32 v247, v248, v249
    v_max_f32 v247, 0, v247
    v_exp_f32_e64 v250, -v246
    v_exp_f32_e64 v251, -v247
    s_nop 1
    v_mul_f32 v241, v241, v250
    v_mul_f32 v242, v242, v251
    v_accvgpr_read_b32 v252, a0
    s_nop 0
    v_mul_f32 v252, v252, v250
    s_nop 0
    v_accvgpr_write_b32 a0, v252
    v_accvgpr_read_b32 v253, a1
    s_nop 0
    v_mul_f32 v253, v253, v250
    s_nop 0
    v_accvgpr_write_b32 a1, v253
    v_accvgpr_read_b32 v254, a2
    s_nop 0
    v_mul_f32 v254, v254, v250
    s_nop 0
    v_accvgpr_write_b32 a2, v254
    v_accvgpr_read_b32 v255, a3
    s_nop 0
    v_mul_f32 v255, v255, v250
    s_nop 0
    v_accvgpr_write_b32 a3, v255
    v_accvgpr_read_b32 v252, a4
    s_nop 0
    v_mul_f32 v252, v252, v250
    s_nop 0
    v_accvgpr_write_b32 a4, v252
    v_accvgpr_read_b32 v253, a5
    s_nop 0
    v_mul_f32 v253, v253, v250
    s_nop 0
    v_accvgpr_write_b32 a5, v253
    v_accvgpr_read_b32 v254, a6
    s_nop 0
    v_mul_f32 v254, v254, v250
    s_nop 0
    v_accvgpr_write_b32 a6, v254
    v_accvgpr_read_b32 v255, a7
    s_nop 0
    v_mul_f32 v255, v255, v250
    s_nop 0
    v_accvgpr_write_b32 a7, v255
    v_accvgpr_read_b32 v252, a8
    s_nop 0
    v_mul_f32 v252, v252, v250
    s_nop 0
    v_accvgpr_write_b32 a8, v252
    v_accvgpr_read_b32 v253, a9
    s_nop 0
    v_mul_f32 v253, v253, v250
    s_nop 0
    v_accvgpr_write_b32 a9, v253
    v_accvgpr_read_b32 v254, a10
    s_nop 0
    v_mul_f32 v254, v254, v250
    s_nop 0
    v_accvgpr_write_b32 a10, v254
    v_accvgpr_read_b32 v255, a11
    s_nop 0
    v_mul_f32 v255, v255, v250
    s_nop 0
    v_accvgpr_write_b32 a11, v255
    v_accvgpr_read_b32 v252, a12
    s_nop 0
    v_mul_f32 v252, v252, v250
    s_nop 0
    v_accvgpr_write_b32 a12, v252
    v_accvgpr_read_b32 v253, a13
    s_nop 0
    v_mul_f32 v253, v253, v250
    s_nop 0
    v_accvgpr_write_b32 a13, v253
    v_accvgpr_read_b32 v254, a14
    s_nop 0
    v_mul_f32 v254, v254, v250
    s_nop 0
    v_accvgpr_write_b32 a14, v254
    v_accvgpr_read_b32 v255, a15
    s_nop 0
    v_mul_f32 v255, v255, v250
    s_nop 0
    v_accvgpr_write_b32 a15, v255
    v_accvgpr_read_b32 v252, a16
    s_nop 0
    v_mul_f32 v252, v252, v251
    s_nop 0
    v_accvgpr_write_b32 a16, v252
    v_accvgpr_read_b32 v253, a17
    s_nop 0
    v_mul_f32 v253, v253, v251
    s_nop 0
    v_accvgpr_write_b32 a17, v253
    v_accvgpr_read_b32 v254, a18
    s_nop 0
    v_mul_f32 v254, v254, v251
    s_nop 0
    v_accvgpr_write_b32 a18, v254
    v_accvgpr_read_b32 v255, a19
    s_nop 0
    v_mul_f32 v255, v255, v251
    s_nop 0
    v_accvgpr_write_b32 a19, v255
    v_accvgpr_read_b32 v252, a20
    s_nop 0
    v_mul_f32 v252, v252, v251
    s_nop 0
    v_accvgpr_write_b32 a20, v252
    v_accvgpr_read_b32 v253, a21
    s_nop 0
    v_mul_f32 v253, v253, v251
    s_nop 0
    v_accvgpr_write_b32 a21, v253
    v_accvgpr_read_b32 v254, a22
    s_nop 0
    v_mul_f32 v254, v254, v251
    s_nop 0
    v_accvgpr_write_b32 a22, v254
    v_accvgpr_read_b32 v255, a23
    s_nop 0
    v_mul_f32 v255, v255, v251
    s_nop 0
    v_accvgpr_write_b32 a23, v255
    v_accvgpr_read_b32 v252, a24
    s_nop 0
    v_mul_f32 v252, v252, v251
    s_nop 0
    v_accvgpr_write_b32 a24, v252
    v_accvgpr_read_b32 v253, a25
    s_nop 0
    v_mul_f32 v253, v253, v251
    s_nop 0
    v_accvgpr_write_b32 a25, v253
    v_accvgpr_read_b32 v254, a26
    s_nop 0
    v_mul_f32 v254, v254, v251
    s_nop 0
    v_accvgpr_write_b32 a26, v254
    v_accvgpr_read_b32 v255, a27
    s_nop 0
    v_mul_f32 v255, v255, v251
    s_nop 0
    v_accvgpr_write_b32 a27, v255
    v_accvgpr_read_b32 v252, a28
    s_nop 0
    v_mul_f32 v252, v252, v251
    s_nop 0
    v_accvgpr_write_b32 a28, v252
    v_accvgpr_read_b32 v253, a29
    s_nop 0
    v_mul_f32 v253, v253, v251
    s_nop 0
    v_accvgpr_write_b32 a29, v253
    v_accvgpr_read_b32 v254, a30
    s_nop 0
    v_mul_f32 v254, v254, v251
    s_nop 0
    v_accvgpr_write_b32 a30, v254
    v_accvgpr_read_b32 v255, a31
    s_nop 0
    v_mul_f32 v255, v255, v251
    s_nop 0
    v_accvgpr_write_b32 a31, v255
    v_accvgpr_read_b32 v252, a32
    s_nop 0
    v_mul_f32 v252, v252, v250
    s_nop 0
    v_accvgpr_write_b32 a32, v252
    v_accvgpr_read_b32 v253, a33
    s_nop 0
    v_mul_f32 v253, v253, v250
    s_nop 0
    v_accvgpr_write_b32 a33, v253
    v_accvgpr_read_b32 v254, a34
    s_nop 0
    v_mul_f32 v254, v254, v250
    s_nop 0
    v_accvgpr_write_b32 a34, v254
    v_accvgpr_read_b32 v255, a35
    s_nop 0
    v_mul_f32 v255, v255, v250
    s_nop 0
    v_accvgpr_write_b32 a35, v255
    v_accvgpr_read_b32 v252, a36
    s_nop 0
    v_mul_f32 v252, v252, v250
    s_nop 0
    v_accvgpr_write_b32 a36, v252
    v_accvgpr_read_b32 v253, a37
    s_nop 0
    v_mul_f32 v253, v253, v250
    s_nop 0
    v_accvgpr_write_b32 a37, v253
    v_accvgpr_read_b32 v254, a38
    s_nop 0
    v_mul_f32 v254, v254, v250
    s_nop 0
    v_accvgpr_write_b32 a38, v254
    v_accvgpr_read_b32 v255, a39
    s_nop 0
    v_mul_f32 v255, v255, v250
    s_nop 0
    v_accvgpr_write_b32 a39, v255
    v_accvgpr_read_b32 v252, a40
    s_nop 0
    v_mul_f32 v252, v252, v250
    s_nop 0
    v_accvgpr_write_b32 a40, v252
    v_accvgpr_read_b32 v253, a41
    s_nop 0
    v_mul_f32 v253, v253, v250
    s_nop 0
    v_accvgpr_write_b32 a41, v253
    v_accvgpr_read_b32 v254, a42
    s_nop 0
    v_mul_f32 v254, v254, v250
    s_nop 0
    v_accvgpr_write_b32 a42, v254
    v_accvgpr_read_b32 v255, a43
    s_nop 0
    v_mul_f32 v255, v255, v250
    s_nop 0
    v_accvgpr_write_b32 a43, v255
    v_accvgpr_read_b32 v252, a44
    s_nop 0
    v_mul_f32 v252, v252, v250
    s_nop 0
    v_accvgpr_write_b32 a44, v252
    v_accvgpr_read_b32 v253, a45
    s_nop 0
    v_mul_f32 v253, v253, v250
    s_nop 0
    v_accvgpr_write_b32 a45, v253
    v_accvgpr_read_b32 v254, a46
    s_nop 0
    v_mul_f32 v254, v254, v250
    s_nop 0
    v_accvgpr_write_b32 a46, v254
    v_accvgpr_read_b32 v255, a47
    s_nop 0
    v_mul_f32 v255, v255, v250
    s_nop 0
    v_accvgpr_write_b32 a47, v255
    v_accvgpr_read_b32 v252, a48
    s_nop 0
    v_mul_f32 v252, v252, v251
    s_nop 0
    v_accvgpr_write_b32 a48, v252
    v_accvgpr_read_b32 v253, a49
    s_nop 0
    v_mul_f32 v253, v253, v251
    s_nop 0
    v_accvgpr_write_b32 a49, v253
    v_accvgpr_read_b32 v254, a50
    s_nop 0
    v_mul_f32 v254, v254, v251
    s_nop 0
    v_accvgpr_write_b32 a50, v254
    v_accvgpr_read_b32 v255, a51
    s_nop 0
    v_mul_f32 v255, v255, v251
    s_nop 0
    v_accvgpr_write_b32 a51, v255
    v_accvgpr_read_b32 v252, a52
    s_nop 0
    v_mul_f32 v252, v252, v251
    s_nop 0
    v_accvgpr_write_b32 a52, v252
    v_accvgpr_read_b32 v253, a53
    s_nop 0
    v_mul_f32 v253, v253, v251
    s_nop 0
    v_accvgpr_write_b32 a53, v253
    v_accvgpr_read_b32 v254, a54
    s_nop 0
    v_mul_f32 v254, v254, v251
    s_nop 0
    v_accvgpr_write_b32 a54, v254
    v_accvgpr_read_b32 v255, a55
    s_nop 0
    v_mul_f32 v255, v255, v251
    s_nop 0
    v_accvgpr_write_b32 a55, v255
    v_accvgpr_read_b32 v252, a56
    s_nop 0
    v_mul_f32 v252, v252, v251
    s_nop 0
    v_accvgpr_write_b32 a56, v252
    v_accvgpr_read_b32 v253, a57
    s_nop 0
    v_mul_f32 v253, v253, v251
    s_nop 0
    v_accvgpr_write_b32 a57, v253
    v_accvgpr_read_b32 v254, a58
    s_nop 0
    v_mul_f32 v254, v254, v251
    s_nop 0
    v_accvgpr_write_b32 a58, v254
    v_accvgpr_read_b32 v255, a59
    s_nop 0
    v_mul_f32 v255, v255, v251
    s_nop 0
    v_accvgpr_write_b32 a59, v255
    v_accvgpr_read_b32 v252, a60
    s_nop 0
    v_mul_f32 v252, v252, v251
    s_nop 0
    v_accvgpr_write_b32 a60, v252
    v_accvgpr_read_b32 v253, a61
    s_nop 0
    v_mul_f32 v253, v253, v251
    s_nop 0
    v_accvgpr_write_b32 a61, v253
    v_accvgpr_read_b32 v254, a62
    s_nop 0
    v_mul_f32 v254, v254, v251
    s_nop 0
    v_accvgpr_write_b32 a62, v254
    v_accvgpr_read_b32 v255, a63
    s_nop 0
    v_mul_f32 v255, v255, v251
    s_nop 0
    v_accvgpr_write_b32 a63, v255
    v_accvgpr_read_b32 v252, a64
    s_nop 0
    v_mul_f32 v252, v252, v250
    s_nop 0
    v_accvgpr_write_b32 a64, v252
    v_accvgpr_read_b32 v253, a65
    s_nop 0
    v_mul_f32 v253, v253, v250
    s_nop 0
    v_accvgpr_write_b32 a65, v253
    v_accvgpr_read_b32 v254, a66
    s_nop 0
    v_mul_f32 v254, v254, v250
    s_nop 0
    v_accvgpr_write_b32 a66, v254
    v_accvgpr_read_b32 v255, a67
    s_nop 0
    v_mul_f32 v255, v255, v250
    s_nop 0
    v_accvgpr_write_b32 a67, v255
    v_accvgpr_read_b32 v252, a68
    s_nop 0
    v_mul_f32 v252, v252, v250
    s_nop 0
    v_accvgpr_write_b32 a68, v252
    v_accvgpr_read_b32 v253, a69
    s_nop 0
    v_mul_f32 v253, v253, v250
    s_nop 0
    v_accvgpr_write_b32 a69, v253
    v_accvgpr_read_b32 v254, a70
    s_nop 0
    v_mul_f32 v254, v254, v250
    s_nop 0
    v_accvgpr_write_b32 a70, v254
    v_accvgpr_read_b32 v255, a71
    s_nop 0
    v_mul_f32 v255, v255, v250
    s_nop 0
    v_accvgpr_write_b32 a71, v255
    v_accvgpr_read_b32 v252, a72
    s_nop 0
    v_mul_f32 v252, v252, v250
    s_nop 0
    v_accvgpr_write_b32 a72, v252
    v_accvgpr_read_b32 v253, a73
    s_nop 0
    v_mul_f32 v253, v253, v250
    s_nop 0
    v_accvgpr_write_b32 a73, v253
    v_accvgpr_read_b32 v254, a74
    s_nop 0
    v_mul_f32 v254, v254, v250
    s_nop 0
    v_accvgpr_write_b32 a74, v254
    v_accvgpr_read_b32 v255, a75
    s_nop 0
    v_mul_f32 v255, v255, v250
    s_nop 0
    v_accvgpr_write_b32 a75, v255
    v_accvgpr_read_b32 v252, a76
    s_nop 0
    v_mul_f32 v252, v252, v250
    s_nop 0
    v_accvgpr_write_b32 a76, v252
    v_accvgpr_read_b32 v253, a77
    s_nop 0
    v_mul_f32 v253, v253, v250
    s_nop 0
    v_accvgpr_write_b32 a77, v253
    v_accvgpr_read_b32 v254, a78
    s_nop 0
    v_mul_f32 v254, v254, v250
    s_nop 0
    v_accvgpr_write_b32 a78, v254
    v_accvgpr_read_b32 v255, a79
    s_nop 0
    v_mul_f32 v255, v255, v250
    s_nop 0
    v_accvgpr_write_b32 a79, v255
    v_accvgpr_read_b32 v252, a80
    s_nop 0
    v_mul_f32 v252, v252, v251
    s_nop 0
    v_accvgpr_write_b32 a80, v252
    v_accvgpr_read_b32 v253, a81
    s_nop 0
    v_mul_f32 v253, v253, v251
    s_nop 0
    v_accvgpr_write_b32 a81, v253
    v_accvgpr_read_b32 v254, a82
    s_nop 0
    v_mul_f32 v254, v254, v251
    s_nop 0
    v_accvgpr_write_b32 a82, v254
    v_accvgpr_read_b32 v255, a83
    s_nop 0
    v_mul_f32 v255, v255, v251
    s_nop 0
    v_accvgpr_write_b32 a83, v255
    v_accvgpr_read_b32 v252, a84
    s_nop 0
    v_mul_f32 v252, v252, v251
    s_nop 0
    v_accvgpr_write_b32 a84, v252
    v_accvgpr_read_b32 v253, a85
    s_nop 0
    v_mul_f32 v253, v253, v251
    s_nop 0
    v_accvgpr_write_b32 a85, v253
    v_accvgpr_read_b32 v254, a86
    s_nop 0
    v_mul_f32 v254, v254, v251
    s_nop 0
    v_accvgpr_write_b32 a86, v254
    v_accvgpr_read_b32 v255, a87
    s_nop 0
    v_mul_f32 v255, v255, v251
    s_nop 0
    v_accvgpr_write_b32 a87, v255
    v_accvgpr_read_b32 v252, a88
    s_nop 0
    v_mul_f32 v252, v252, v251
    s_nop 0
    v_accvgpr_write_b32 a88, v252
    v_accvgpr_read_b32 v253, a89
    s_nop 0
    v_mul_f32 v253, v253, v251
    s_nop 0
    v_accvgpr_write_b32 a89, v253
    v_accvgpr_read_b32 v254, a90
    s_nop 0
    v_mul_f32 v254, v254, v251
    s_nop 0
    v_accvgpr_write_b32 a90, v254
    v_accvgpr_read_b32 v255, a91
    s_nop 0
    v_mul_f32 v255, v255, v251
    s_nop 0
    v_accvgpr_write_b32 a91, v255
    v_accvgpr_read_b32 v252, a92
    s_nop 0
    v_mul_f32 v252, v252, v251
    s_nop 0
    v_accvgpr_write_b32 a92, v252
    v_accvgpr_read_b32 v253, a93
    s_nop 0
    v_mul_f32 v253, v253, v251
    s_nop 0
    v_accvgpr_write_b32 a93, v253
    v_accvgpr_read_b32 v254, a94
    s_nop 0
    v_mul_f32 v254, v254, v251
    s_nop 0
    v_accvgpr_write_b32 a94, v254
    v_accvgpr_read_b32 v255, a95
    s_nop 0
    v_mul_f32 v255, v255, v251
    s_nop 0
    v_accvgpr_write_b32 a95, v255
    v_accvgpr_read_b32 v252, a96
    s_nop 0
    v_mul_f32 v252, v252, v250
    s_nop 0
    v_accvgpr_write_b32 a96, v252
    v_accvgpr_read_b32 v253, a97
    s_nop 0
    v_mul_f32 v253, v253, v250
    s_nop 0
    v_accvgpr_write_b32 a97, v253
    v_accvgpr_read_b32 v254, a98
    s_nop 0
    v_mul_f32 v254, v254, v250
    s_nop 0
    v_accvgpr_write_b32 a98, v254
    v_accvgpr_read_b32 v255, a99
    s_nop 0
    v_mul_f32 v255, v255, v250
    s_nop 0
    v_accvgpr_write_b32 a99, v255
    v_accvgpr_read_b32 v252, a100
    s_nop 0
    v_mul_f32 v252, v252, v250
    s_nop 0
    v_accvgpr_write_b32 a100, v252
    v_accvgpr_read_b32 v253, a101
    s_nop 0
    v_mul_f32 v253, v253, v250
    s_nop 0
    v_accvgpr_write_b32 a101, v253
    v_accvgpr_read_b32 v254, a102
    s_nop 0
    v_mul_f32 v254, v254, v250
    s_nop 0
    v_accvgpr_write_b32 a102, v254
    v_accvgpr_read_b32 v255, a103
    s_nop 0
    v_mul_f32 v255, v255, v250
    s_nop 0
    v_accvgpr_write_b32 a103, v255
    v_accvgpr_read_b32 v252, a104
    s_nop 0
    v_mul_f32 v252, v252, v250
    s_nop 0
    v_accvgpr_write_b32 a104, v252
    v_accvgpr_read_b32 v253, a105
    s_nop 0
    v_mul_f32 v253, v253, v250
    s_nop 0
    v_accvgpr_write_b32 a105, v253
    v_accvgpr_read_b32 v254, a106
    s_nop 0
    v_mul_f32 v254, v254, v250
    s_nop 0
    v_accvgpr_write_b32 a106, v254
    v_accvgpr_read_b32 v255, a107
    s_nop 0
    v_mul_f32 v255, v255, v250
    s_nop 0
    v_accvgpr_write_b32 a107, v255
    v_accvgpr_read_b32 v252, a108
    s_nop 0
    v_mul_f32 v252, v252, v250
    s_nop 0
    v_accvgpr_write_b32 a108, v252
    v_accvgpr_read_b32 v253, a109
    s_nop 0
    v_mul_f32 v253, v253, v250
    s_nop 0
    v_accvgpr_write_b32 a109, v253
    v_accvgpr_read_b32 v254, a110
    s_nop 0
    v_mul_f32 v254, v254, v250
    s_nop 0
    v_accvgpr_write_b32 a110, v254
    v_accvgpr_read_b32 v255, a111
    s_nop 0
    v_mul_f32 v255, v255, v250
    s_nop 0
    v_accvgpr_write_b32 a111, v255
    v_accvgpr_read_b32 v252, a112
    s_nop 0
    v_mul_f32 v252, v252, v251
    s_nop 0
    v_accvgpr_write_b32 a112, v252
    v_accvgpr_read_b32 v253, a113
    s_nop 0
    v_mul_f32 v253, v253, v251
    s_nop 0
    v_accvgpr_write_b32 a113, v253
    v_accvgpr_read_b32 v254, a114
    s_nop 0
    v_mul_f32 v254, v254, v251
    s_nop 0
    v_accvgpr_write_b32 a114, v254
    v_accvgpr_read_b32 v255, a115
    s_nop 0
    v_mul_f32 v255, v255, v251
    s_nop 0
    v_accvgpr_write_b32 a115, v255
    v_accvgpr_read_b32 v252, a116
    s_nop 0
    v_mul_f32 v252, v252, v251
    s_nop 0
    v_accvgpr_write_b32 a116, v252
    v_accvgpr_read_b32 v253, a117
    s_nop 0
    v_mul_f32 v253, v253, v251
    s_nop 0
    v_accvgpr_write_b32 a117, v253
    v_accvgpr_read_b32 v254, a118
    s_nop 0
    v_mul_f32 v254, v254, v251
    s_nop 0
    v_accvgpr_write_b32 a118, v254
    v_accvgpr_read_b32 v255, a119
    s_nop 0
    v_mul_f32 v255, v255, v251
    s_nop 0
    v_accvgpr_write_b32 a119, v255
    v_accvgpr_read_b32 v252, a120
    s_nop 0
    v_mul_f32 v252, v252, v251
    s_nop 0
    v_accvgpr_write_b32 a120, v252
    v_accvgpr_read_b32 v253, a121
    s_nop 0
    v_mul_f32 v253, v253, v251
    s_nop 0
    v_accvgpr_write_b32 a121, v253
    v_accvgpr_read_b32 v254, a122
    s_nop 0
    v_mul_f32 v254, v254, v251
    s_nop 0
    v_accvgpr_write_b32 a122, v254
    v_accvgpr_read_b32 v255, a123
    s_nop 0
    v_mul_f32 v255, v255, v251
    s_nop 0
    v_accvgpr_write_b32 a123, v255
    v_accvgpr_read_b32 v252, a124
    s_nop 0
    v_mul_f32 v252, v252, v251
    s_nop 0
    v_accvgpr_write_b32 a124, v252
    v_accvgpr_read_b32 v253, a125
    s_nop 0
    v_mul_f32 v253, v253, v251
    s_nop 0
    v_accvgpr_write_b32 a125, v253
    v_accvgpr_read_b32 v254, a126
    s_nop 0
    v_mul_f32 v254, v254, v251
    s_nop 0
    v_accvgpr_write_b32 a126, v254
    v_accvgpr_read_b32 v255, a127
    s_nop 0
    v_mul_f32 v255, v255, v251
    s_nop 0
    v_accvgpr_write_b32 a127, v255
    v_sub_f32 v192, v192, v246
    v_sub_f32 v193, v193, v246
    v_sub_f32 v194, v194, v246
    v_sub_f32 v195, v195, v246
    v_sub_f32 v196, v196, v246
    v_sub_f32 v197, v197, v246
    v_sub_f32 v198, v198, v246
    v_sub_f32 v199, v199, v246
    v_sub_f32 v200, v200, v246
    v_sub_f32 v201, v201, v246
    v_sub_f32 v202, v202, v246
    v_sub_f32 v203, v203, v246
    v_sub_f32 v204, v204, v246
    v_sub_f32 v205, v205, v246
    v_sub_f32 v206, v206, v246
    v_sub_f32 v207, v207, v246
    v_sub_f32 v208, v208, v247
    v_sub_f32 v209, v209, v247
    v_sub_f32 v210, v210, v247
    v_sub_f32 v211, v211, v247
    v_sub_f32 v212, v212, v247
    v_sub_f32 v213, v213, v247
    v_sub_f32 v214, v214, v247
    v_sub_f32 v215, v215, v247
    v_sub_f32 v216, v216, v247
    v_sub_f32 v217, v217, v247
    v_sub_f32 v218, v218, v247
    v_sub_f32 v219, v219, v247
    v_sub_f32 v220, v220, v247
    v_sub_f32 v221, v221, v247
    v_sub_f32 v222, v222, v247
    v_sub_f32 v223, v223, v247
    v_sub_f32 v64, v64, v246
    v_sub_f32 v65, v65, v246
    v_sub_f32 v66, v66, v246
    v_sub_f32 v67, v67, v246
    v_sub_f32 v68, v68, v246
    v_sub_f32 v69, v69, v246
    v_sub_f32 v70, v70, v246
    v_sub_f32 v71, v71, v246
    v_sub_f32 v72, v72, v246
    v_sub_f32 v73, v73, v246
    v_sub_f32 v74, v74, v246
    v_sub_f32 v75, v75, v246
    v_sub_f32 v76, v76, v246
    v_sub_f32 v77, v77, v246
    v_sub_f32 v78, v78, v246
    v_sub_f32 v79, v79, v246
    v_sub_f32 v80, v80, v247
    v_sub_f32 v81, v81, v247
    v_sub_f32 v82, v82, v247
    v_sub_f32 v83, v83, v247
    v_sub_f32 v84, v84, v247
    v_sub_f32 v85, v85, v247
    v_sub_f32 v86, v86, v247
    v_sub_f32 v87, v87, v247
    v_sub_f32 v88, v88, v247
    v_sub_f32 v89, v89, v247
    v_sub_f32 v90, v90, v247
    v_sub_f32 v91, v91, v247
    v_sub_f32 v92, v92, v247
    v_sub_f32 v93, v93, v247
    v_sub_f32 v94, v94, v247
    v_sub_f32 v95, v95, v247
    v_sub_f32 v96, v96, v246
    v_sub_f32 v97, v97, v246
    v_sub_f32 v98, v98, v246
    v_sub_f32 v99, v99, v246
    v_sub_f32 v100, v100, v246
    v_sub_f32 v101, v101, v246
    v_sub_f32 v102, v102, v246
    v_sub_f32 v103, v103, v246
    v_sub_f32 v104, v104, v246
    v_sub_f32 v105, v105, v246
    v_sub_f32 v106, v106, v246
    v_sub_f32 v107, v107, v246
    v_sub_f32 v108, v108, v246
    v_sub_f32 v109, v109, v246
    v_sub_f32 v110, v110, v246
    v_sub_f32 v111, v111, v246
    v_sub_f32 v112, v112, v247
    v_sub_f32 v113, v113, v247
    v_sub_f32 v114, v114, v247
    v_sub_f32 v115, v115, v247
    v_sub_f32 v116, v116, v247
    v_sub_f32 v117, v117, v247
    v_sub_f32 v118, v118, v247
    v_sub_f32 v119, v119, v247
    v_sub_f32 v120, v120, v247
    v_sub_f32 v121, v121, v247
    v_sub_f32 v122, v122, v247
    v_sub_f32 v123, v123, v247
    v_sub_f32 v124, v124, v247
    v_sub_f32 v125, v125, v247
    v_sub_f32 v126, v126, v247
    v_sub_f32 v127, v127, v247
    v_exp_f32 v64, v64
    v_exp_f32 v65, v65
    v_exp_f32 v66, v66
    v_exp_f32 v67, v67
    v_exp_f32 v68, v68
    v_exp_f32 v69, v69
    v_exp_f32 v70, v70
    v_exp_f32 v71, v71
    v_exp_f32 v72, v72
    v_exp_f32 v73, v73
    v_exp_f32 v74, v74
    v_exp_f32 v75, v75
    v_exp_f32 v76, v76
    v_exp_f32 v77, v77
    v_exp_f32 v78, v78
    v_exp_f32 v79, v79
    v_exp_f32 v80, v80
    v_exp_f32 v81, v81
    v_exp_f32 v82, v82
    v_exp_f32 v83, v83
    v_exp_f32 v84, v84
    v_exp_f32 v85, v85
    v_exp_f32 v86, v86
    v_exp_f32 v87, v87
    v_exp_f32 v88, v88
    v_exp_f32 v89, v89
    v_exp_f32 v90, v90
    v_exp_f32 v91, v91
    v_exp_f32 v92, v92
    v_exp_f32 v93, v93
    v_exp_f32 v94, v94
    v_exp_f32 v95, v95
    v_exp_f32 v96, v96
    v_exp_f32 v97, v97
    v_exp_f32 v98, v98
    v_exp_f32 v99, v99
    v_exp_f32 v100, v100
    v_exp_f32 v101, v101
    v_exp_f32 v102, v102
    v_exp_f32 v103, v103
    v_exp_f32 v104, v104
    v_exp_f32 v105, v105
    v_exp_f32 v106, v106
    v_exp_f32 v107, v107
    v_exp_f32 v108, v108
    v_exp_f32 v109, v109
    v_exp_f32 v110, v110
    v_exp_f32 v111, v111
    v_exp_f32 v112, v112
    v_exp_f32 v113, v113
    v_exp_f32 v114, v114
    v_exp_f32 v115, v115
    v_exp_f32 v116, v116
    v_exp_f32 v117, v117
    v_exp_f32 v118, v118
    v_exp_f32 v119, v119
    v_exp_f32 v120, v120
    v_exp_f32 v121, v121
    v_exp_f32 v122, v122
    v_exp_f32 v123, v123
    v_exp_f32 v124, v124
    v_exp_f32 v125, v125
    v_exp_f32 v126, v126
    v_exp_f32 v127, v127
    s_nop 0
    v_add_f32 v243, v64, v65
    v_add_f32 v243, v243, v66
    v_add_f32 v243, v243, v67
    v_add_f32 v243, v243, v68
    v_add_f32 v243, v243, v69
    v_add_f32 v243, v243, v70
    v_add_f32 v243, v243, v71
    v_add_f32 v243, v243, v72
    v_add_f32 v243, v243, v73
    v_add_f32 v243, v243, v74
    v_add_f32 v243, v243, v75
    v_add_f32 v243, v243, v76
    v_add_f32 v243, v243, v77
    v_add_f32 v243, v243, v78
    v_add_f32 v243, v243, v79
    v_add_f32 v243, v243, v96
    v_add_f32 v243, v243, v97
    v_add_f32 v243, v243, v98
    v_add_f32 v243, v243, v99
    v_add_f32 v243, v243, v100
    v_add_f32 v243, v243, v101
    v_add_f32 v243, v243, v102
    v_add_f32 v243, v243, v103
    v_add_f32 v243, v243, v104
    v_add_f32 v243, v243, v105
    v_add_f32 v243, v243, v106
    v_add_f32 v243, v243, v107
    v_add_f32 v243, v243, v108
    v_add_f32 v243, v243, v109
    v_add_f32 v243, v243, v110
    v_add_f32 v243, v243, v111
    v_add_f32 v244, v80, v81
    v_add_f32 v244, v244, v82
    v_add_f32 v244, v244, v83
    v_add_f32 v244, v244, v84
    v_add_f32 v244, v244, v85
    v_add_f32 v244, v244, v86
    v_add_f32 v244, v244, v87
    v_add_f32 v244, v244, v88
    v_add_f32 v244, v244, v89
    v_add_f32 v244, v244, v90
    v_add_f32 v244, v244, v91
    v_add_f32 v244, v244, v92
    v_add_f32 v244, v244, v93
    v_add_f32 v244, v244, v94
    v_add_f32 v244, v244, v95
    v_add_f32 v244, v244, v112
    v_add_f32 v244, v244, v113
    v_add_f32 v244, v244, v114
    v_add_f32 v244, v244, v115
    v_add_f32 v244, v244, v116
    v_add_f32 v244, v244, v117
    v_add_f32 v244, v244, v118
    v_add_f32 v244, v244, v119
    v_add_f32 v244, v244, v120
    v_add_f32 v244, v244, v121
    v_add_f32 v244, v244, v122
    v_add_f32 v244, v244, v123
    v_add_f32 v244, v244, v124
    v_add_f32 v244, v244, v125
    v_add_f32 v244, v244, v126
    v_add_f32 v244, v244, v127
    v_cvt_pk_bf16_f32 v160, v64, v65
    v_cvt_pk_bf16_f32 v161, v66, v67
    v_cvt_pk_bf16_f32 v162, v68, v69
    v_cvt_pk_bf16_f32 v163, v70, v71
    v_cvt_pk_bf16_f32 v168, v72, v73
    v_cvt_pk_bf16_f32 v169, v74, v75
    v_cvt_pk_bf16_f32 v170, v76, v77
    v_cvt_pk_bf16_f32 v171, v78, v79
    v_cvt_pk_bf16_f32 v164, v80, v81
    v_cvt_pk_bf16_f32 v165, v82, v83
    v_cvt_pk_bf16_f32 v166, v84, v85
    v_cvt_pk_bf16_f32 v167, v86, v87
    v_cvt_pk_bf16_f32 v172, v88, v89
    v_cvt_pk_bf16_f32 v173, v90, v91
    v_cvt_pk_bf16_f32 v174, v92, v93
    v_cvt_pk_bf16_f32 v175, v94, v95
    v_cvt_pk_bf16_f32 v176, v96, v97
    v_cvt_pk_bf16_f32 v177, v98, v99
    v_cvt_pk_bf16_f32 v178, v100, v101
    v_cvt_pk_bf16_f32 v179, v102, v103
    v_cvt_pk_bf16_f32 v184, v104, v105
    v_cvt_pk_bf16_f32 v185, v106, v107
    v_cvt_pk_bf16_f32 v186, v108, v109
    v_cvt_pk_bf16_f32 v187, v110, v111
    v_cvt_pk_bf16_f32 v180, v112, v113
    v_cvt_pk_bf16_f32 v181, v114, v115
    v_cvt_pk_bf16_f32 v182, v116, v117
    v_cvt_pk_bf16_f32 v183, v118, v119
    v_cvt_pk_bf16_f32 v188, v120, v121
    v_cvt_pk_bf16_f32 v189, v122, v123
    v_cvt_pk_bf16_f32 v190, v124, v125
    v_cvt_pk_bf16_f32 v191, v126, v127
    v_sub_f32 v0, v0, v246
    v_sub_f32 v1, v1, v246
    v_sub_f32 v2, v2, v246
    v_sub_f32 v3, v3, v246
    v_sub_f32 v4, v4, v246
    v_sub_f32 v5, v5, v246
    v_sub_f32 v6, v6, v246
    v_sub_f32 v7, v7, v246
    v_sub_f32 v8, v8, v246
    v_sub_f32 v9, v9, v246
    v_sub_f32 v10, v10, v246
    v_sub_f32 v11, v11, v246
    v_sub_f32 v12, v12, v246
    v_sub_f32 v13, v13, v246
    v_sub_f32 v14, v14, v246
    v_sub_f32 v15, v15, v246
    v_sub_f32 v16, v16, v247
    v_sub_f32 v17, v17, v247
    v_sub_f32 v18, v18, v247
    v_sub_f32 v19, v19, v247
    v_sub_f32 v20, v20, v247
    v_sub_f32 v21, v21, v247
    v_sub_f32 v22, v22, v247
    v_sub_f32 v23, v23, v247
    v_sub_f32 v24, v24, v247
    v_sub_f32 v25, v25, v247
    v_sub_f32 v26, v26, v247
    v_sub_f32 v27, v27, v247
    v_sub_f32 v28, v28, v247
    v_sub_f32 v29, v29, v247
    v_sub_f32 v30, v30, v247
    v_sub_f32 v31, v31, v247
    v_sub_f32 v32, v32, v246
    v_sub_f32 v33, v33, v246
    v_sub_f32 v34, v34, v246
    v_sub_f32 v35, v35, v246
    v_sub_f32 v36, v36, v246
    v_sub_f32 v37, v37, v246
    v_sub_f32 v38, v38, v246
    v_sub_f32 v39, v39, v246
    v_sub_f32 v40, v40, v246
    v_sub_f32 v41, v41, v246
    v_sub_f32 v42, v42, v246
    v_sub_f32 v43, v43, v246
    v_sub_f32 v44, v44, v246
    v_sub_f32 v45, v45, v246
    v_sub_f32 v46, v46, v246
    v_sub_f32 v47, v47, v246
    v_sub_f32 v48, v48, v247
    v_sub_f32 v49, v49, v247
    v_sub_f32 v50, v50, v247
    v_sub_f32 v51, v51, v247
    v_sub_f32 v52, v52, v247
    v_sub_f32 v53, v53, v247
    v_sub_f32 v54, v54, v247
    v_sub_f32 v55, v55, v247
    v_sub_f32 v56, v56, v247
    v_sub_f32 v57, v57, v247
    v_sub_f32 v58, v58, v247
    v_sub_f32 v59, v59, v247
    v_sub_f32 v60, v60, v247
    v_sub_f32 v61, v61, v247
    v_sub_f32 v62, v62, v247
    v_sub_f32 v63, v63, v247
    s_nop 7
    ds_read_b128 a[192:195], v224 offset:16384
    ds_read_b128 a[196:199], v225 offset:16384
    ds_read_b128 a[200:203], v226 offset:16384
    ds_read_b128 a[204:207], v227 offset:16384
    s_branch L_ret4
L_rare5:
    s_nop 15
    s_nop 3
    s_waitcnt vmcnt(0) lgkmcnt(0)
    s_add_u32 s46, s35, 8192
    buffer_load_dwordx4 a[192:195], v245, s[8:11], s35 offen
    buffer_load_dwordx4 a[196:199], v245, s[8:11], s35 offen offset:32
    buffer_load_dwordx4 a[200:203], v245, s[8:11], s35 offen offset:64
    buffer_load_dwordx4 a[204:207], v245, s[8:11], s35 offen offset:96
    buffer_load_dwordx4 a[208:211], v245, s[8:11], s35 offen offset:128
    buffer_load_dwordx4 a[212:215], v245, s[8:11], s35 offen offset:160
    buffer_load_dwordx4 a[216:219], v245, s[8:11], s35 offen offset:192
    buffer_load_dwordx4 a[220:223], v245, s[8:11], s35 offen offset:224
    buffer_load_dwordx4 a[224:227], v245, s[8:11], s46 offen
    buffer_load_dwordx4 a[228:231], v245, s[8:11], s46 offen offset:32
    buffer_load_dwordx4 a[232:235], v245, s[8:11], s46 offen offset:64
    buffer_load_dwordx4 a[236:239], v245, s[8:11], s46 offen offset:96
    buffer_load_dwordx4 a[240:243], v245, s[8:11], s46 offen offset:128
    buffer_load_dwordx4 a[244:247], v245, s[8:11], s46 offen offset:160
    buffer_load_dwordx4 a[248:251], v245, s[8:11], s46 offen offset:192
    buffer_load_dwordx4 a[252:255], v245, s[8:11], s46 offen offset:224
    s_waitcnt vmcnt(0)
    s_nop 1
    v_mfma_f32_32x32x16_bf16 v[0:15], a[192:195], a[128:131], v[192:207]
    v_mfma_f32_32x32x16_bf16 v[16:31], a[192:195], a[160:163], v[208:223]
    v_mfma_f32_32x32x16_bf16 v[0:15], a[196:199], a[132:135], v[0:15]
    v_mfma_f32_32x32x16_bf16 v[16:31], a[196:199], a[164:167], v[16:31]
    v_mfma_f32_32x32x16_bf16 v[0:15], a[200:203], a[136:139], v[0:15]
    v_mfma_f32_32x32x16_bf16 v[16:31], a[200:203], a[168:171], v[16:31]
    v_mfma_f32_32x32x16_bf16 v[0:15], a[204:207], a[140:143], v[0:15]
    v_mfma_f32_32x32x16_bf16 v[16:31], a[204:207], a[172:175], v[16:31]
    v_mfma_f32_32x32x16_bf16 v[0:15], a[208:211], a[144:147], v[0:15]
    v_mfma_f32_32x32x16_bf16 v[16:31], a[208:211], a[176:179], v[16:31]
    v_mfma_f32_32x32x16_bf16 v[0:15], a[212:215], a[148:151], v[0:15]
    v_mfma_f32_32x32x16_bf16 v[16:31], a[212:215], a[180:183], v[16:31]
    v_mfma_f32_32x32x16_bf16 v[0:15], a[216:219], a[152:155], v[0:15]
    v_mfma_f32_32x32x16_bf16 v[16:31], a[216:219], a[184:187], v[16:31]
    v_mfma_f32_32x32x16_bf16 v[0:15], a[220:223], a[156:159], v[0:15]
    v_mfma_f32_32x32x16_bf16 v[16:31], a[220:223], a[188:191], v[16:31]
    v_mfma_f32_32x32x16_bf16 v[32:47], a[224:227], a[128:131], v[192:207]
    v_mfma_f32_32x32x16_bf16 v[48:63], a[224:227], a[160:163], v[208:223]
    v_mfma_f32_32x32x16_bf16 v[32:47], a[228:231], a[132:135], v[32:47]
    v_mfma_f32_32x32x16_bf16 v[48:63], a[228:231], a[164:167], v[48:63]
    v_mfma_f32_32x32x16_bf16 v[32:47], a[232:235], a[136:139], v[32:47]
    v_mfma_f32_32x32x16_bf16 v[48:63], a[232:235], a[168:171], v[48:63]
    v_mfma_f32_32x32x16_bf16 v[32:47], a[236:239], a[140:143], v[32:47]
    v_mfma_f32_32x32x16_bf16 v[48:63], a[236:239], a[172:175], v[48:63]
    v_mfma_f32_32x32x16_bf16 v[32:47], a[240:243], a[144:147], v[32:47]
    v_mfma_f32_32x32x16_bf16 v[48:63], a[240:243], a[176:179], v[48:63]
    v_mfma_f32_32x32x16_bf16 v[32:47], a[244:247], a[148:151], v[32:47]
    v_mfma_f32_32x32x16_bf16 v[48:63], a[244:247], a[180:183], v[48:63]
    v_mfma_f32_32x32x16_bf16 v[32:47], a[248:251], a[152:155], v[32:47]
    v_mfma_f32_32x32x16_bf16 v[48:63], a[248:251], a[184:187], v[48:63]
    v_mfma_f32_32x32x16_bf16 v[32:47], a[252:255], a[156:159], v[32:47]
    v_mfma_f32_32x32x16_bf16 v[48:63], a[252:255], a[188:191], v[48:63]
    s_nop 15
    s_nop 3
    v_max3_f32 v246, v0, v1, v2
    v_max3_f32 v246, v246, v3, v4
    v_max3_f32 v246, v246, v5, v6
    v_max3_f32 v246, v246, v7, v8
    v_max3_f32 v246, v246, v9, v10
    v_max3_f32 v246, v246, v11, v12
    v_max3_f32 v246, v246, v13, v14
    v_max3_f32 v246, v246, v15, v32
    v_max3_f32 v246, v246, v33, v34
    v_max3_f32 v246, v246, v35, v36
    v_max3_f32 v246, v246, v37, v38
    v_max3_f32 v246, v246, v39, v40
    v_max3_f32 v246, v246, v41, v42
    v_max3_f32 v246, v246, v43, v44
    v_max3_f32 v246, v246, v45, v46
    v_max_f32 v246, v246, v47
    v_mov_b32 v248, v246
    v_mov_b32 v249, v246
    s_nop 1
    v_permlane32_swap_b32 v248, v249
    s_nop 1
    v_max_f32 v246, v248, v249
    v_max_f32 v246, 0, v246
    v_max3_f32 v247, v16, v17, v18
    v_max3_f32 v247, v247, v19, v20
    v_max3_f32 v247, v247, v21, v22
    v_max3_f32 v247, v247, v23, v24
    v_max3_f32 v247, v247, v25, v26
    v_max3_f32 v247, v247, v27, v28
    v_max3_f32 v247, v247, v29, v30
    v_max3_f32 v247, v247, v31, v48
    v_max3_f32 v247, v247, v49, v50
    v_max3_f32 v247, v247, v51, v52
    v_max3_f32 v247, v247, v53, v54
    v_max3_f32 v247, v247, v55, v56
    v_max3_f32 v247, v247, v57, v58
    v_max3_f32 v247, v247, v59, v60
    v_max3_f32 v247, v247, v61, v62
    v_max_f32 v247, v247, v63
    v_mov_b32 v248, v247
    v_mov_b32 v249, v247
    s_nop 1
    v_permlane32_swap_b32 v248, v249
    s_nop 1
    v_max_f32 v247, v248, v249
    v_max_f32 v247, 0, v247
    v_exp_f32_e64 v250, -v246
    v_exp_f32_e64 v251, -v247
    s_nop 1
    v_mul_f32 v241, v241, v250
    v_mul_f32 v242, v242, v251
    v_accvgpr_read_b32 v252, a0
    s_nop 0
    v_mul_f32 v252, v252, v250
    s_nop 0
    v_accvgpr_write_b32 a0, v252
    v_accvgpr_read_b32 v253, a1
    s_nop 0
    v_mul_f32 v253, v253, v250
    s_nop 0
    v_accvgpr_write_b32 a1, v253
    v_accvgpr_read_b32 v254, a2
    s_nop 0
    v_mul_f32 v254, v254, v250
    s_nop 0
    v_accvgpr_write_b32 a2, v254
    v_accvgpr_read_b32 v255, a3
    s_nop 0
    v_mul_f32 v255, v255, v250
    s_nop 0
    v_accvgpr_write_b32 a3, v255
    v_accvgpr_read_b32 v252, a4
    s_nop 0
    v_mul_f32 v252, v252, v250
    s_nop 0
    v_accvgpr_write_b32 a4, v252
    v_accvgpr_read_b32 v253, a5
    s_nop 0
    v_mul_f32 v253, v253, v250
    s_nop 0
    v_accvgpr_write_b32 a5, v253
    v_accvgpr_read_b32 v254, a6
    s_nop 0
    v_mul_f32 v254, v254, v250
    s_nop 0
    v_accvgpr_write_b32 a6, v254
    v_accvgpr_read_b32 v255, a7
    s_nop 0
    v_mul_f32 v255, v255, v250
    s_nop 0
    v_accvgpr_write_b32 a7, v255
    v_accvgpr_read_b32 v252, a8
    s_nop 0
    v_mul_f32 v252, v252, v250
    s_nop 0
    v_accvgpr_write_b32 a8, v252
    v_accvgpr_read_b32 v253, a9
    s_nop 0
    v_mul_f32 v253, v253, v250
    s_nop 0
    v_accvgpr_write_b32 a9, v253
    v_accvgpr_read_b32 v254, a10
    s_nop 0
    v_mul_f32 v254, v254, v250
    s_nop 0
    v_accvgpr_write_b32 a10, v254
    v_accvgpr_read_b32 v255, a11
    s_nop 0
    v_mul_f32 v255, v255, v250
    s_nop 0
    v_accvgpr_write_b32 a11, v255
    v_accvgpr_read_b32 v252, a12
    s_nop 0
    v_mul_f32 v252, v252, v250
    s_nop 0
    v_accvgpr_write_b32 a12, v252
    v_accvgpr_read_b32 v253, a13
    s_nop 0
    v_mul_f32 v253, v253, v250
    s_nop 0
    v_accvgpr_write_b32 a13, v253
    v_accvgpr_read_b32 v254, a14
    s_nop 0
    v_mul_f32 v254, v254, v250
    s_nop 0
    v_accvgpr_write_b32 a14, v254
    v_accvgpr_read_b32 v255, a15
    s_nop 0
    v_mul_f32 v255, v255, v250
    s_nop 0
    v_accvgpr_write_b32 a15, v255
    v_accvgpr_read_b32 v252, a16
    s_nop 0
    v_mul_f32 v252, v252, v251
    s_nop 0
    v_accvgpr_write_b32 a16, v252
    v_accvgpr_read_b32 v253, a17
    s_nop 0
    v_mul_f32 v253, v253, v251
    s_nop 0
    v_accvgpr_write_b32 a17, v253
    v_accvgpr_read_b32 v254, a18
    s_nop 0
    v_mul_f32 v254, v254, v251
    s_nop 0
    v_accvgpr_write_b32 a18, v254
    v_accvgpr_read_b32 v255, a19
    s_nop 0
    v_mul_f32 v255, v255, v251
    s_nop 0
    v_accvgpr_write_b32 a19, v255
    v_accvgpr_read_b32 v252, a20
    s_nop 0
    v_mul_f32 v252, v252, v251
    s_nop 0
    v_accvgpr_write_b32 a20, v252
    v_accvgpr_read_b32 v253, a21
    s_nop 0
    v_mul_f32 v253, v253, v251
    s_nop 0
    v_accvgpr_write_b32 a21, v253
    v_accvgpr_read_b32 v254, a22
    s_nop 0
    v_mul_f32 v254, v254, v251
    s_nop 0
    v_accvgpr_write_b32 a22, v254
    v_accvgpr_read_b32 v255, a23
    s_nop 0
    v_mul_f32 v255, v255, v251
    s_nop 0
    v_accvgpr_write_b32 a23, v255
    v_accvgpr_read_b32 v252, a24
    s_nop 0
    v_mul_f32 v252, v252, v251
    s_nop 0
    v_accvgpr_write_b32 a24, v252
    v_accvgpr_read_b32 v253, a25
    s_nop 0
    v_mul_f32 v253, v253, v251
    s_nop 0
    v_accvgpr_write_b32 a25, v253
    v_accvgpr_read_b32 v254, a26
    s_nop 0
    v_mul_f32 v254, v254, v251
    s_nop 0
    v_accvgpr_write_b32 a26, v254
    v_accvgpr_read_b32 v255, a27
    s_nop 0
    v_mul_f32 v255, v255, v251
    s_nop 0
    v_accvgpr_write_b32 a27, v255
    v_accvgpr_read_b32 v252, a28
    s_nop 0
    v_mul_f32 v252, v252, v251
    s_nop 0
    v_accvgpr_write_b32 a28, v252
    v_accvgpr_read_b32 v253, a29
    s_nop 0
    v_mul_f32 v253, v253, v251
    s_nop 0
    v_accvgpr_write_b32 a29, v253
    v_accvgpr_read_b32 v254, a30
    s_nop 0
    v_mul_f32 v254, v254, v251
    s_nop 0
    v_accvgpr_write_b32 a30, v254
    v_accvgpr_read_b32 v255, a31
    s_nop 0
    v_mul_f32 v255, v255, v251
    s_nop 0
    v_accvgpr_write_b32 a31, v255
    v_accvgpr_read_b32 v252, a32
    s_nop 0
    v_mul_f32 v252, v252, v250
    s_nop 0
    v_accvgpr_write_b32 a32, v252
    v_accvgpr_read_b32 v253, a33
    s_nop 0
    v_mul_f32 v253, v253, v250
    s_nop 0
    v_accvgpr_write_b32 a33, v253
    v_accvgpr_read_b32 v254, a34
    s_nop 0
    v_mul_f32 v254, v254, v250
    s_nop 0
    v_accvgpr_write_b32 a34, v254
    v_accvgpr_read_b32 v255, a35
    s_nop 0
    v_mul_f32 v255, v255, v250
    s_nop 0
    v_accvgpr_write_b32 a35, v255
    v_accvgpr_read_b32 v252, a36
    s_nop 0
    v_mul_f32 v252, v252, v250
    s_nop 0
    v_accvgpr_write_b32 a36, v252
    v_accvgpr_read_b32 v253, a37
    s_nop 0
    v_mul_f32 v253, v253, v250
    s_nop 0
    v_accvgpr_write_b32 a37, v253
    v_accvgpr_read_b32 v254, a38
    s_nop 0
    v_mul_f32 v254, v254, v250
    s_nop 0
    v_accvgpr_write_b32 a38, v254
    v_accvgpr_read_b32 v255, a39
    s_nop 0
    v_mul_f32 v255, v255, v250
    s_nop 0
    v_accvgpr_write_b32 a39, v255
    v_accvgpr_read_b32 v252, a40
    s_nop 0
    v_mul_f32 v252, v252, v250
    s_nop 0
    v_accvgpr_write_b32 a40, v252
    v_accvgpr_read_b32 v253, a41
    s_nop 0
    v_mul_f32 v253, v253, v250
    s_nop 0
    v_accvgpr_write_b32 a41, v253
    v_accvgpr_read_b32 v254, a42
    s_nop 0
    v_mul_f32 v254, v254, v250
    s_nop 0
    v_accvgpr_write_b32 a42, v254
    v_accvgpr_read_b32 v255, a43
    s_nop 0
    v_mul_f32 v255, v255, v250
    s_nop 0
    v_accvgpr_write_b32 a43, v255
    v_accvgpr_read_b32 v252, a44
    s_nop 0
    v_mul_f32 v252, v252, v250
    s_nop 0
    v_accvgpr_write_b32 a44, v252
    v_accvgpr_read_b32 v253, a45
    s_nop 0
    v_mul_f32 v253, v253, v250
    s_nop 0
    v_accvgpr_write_b32 a45, v253
    v_accvgpr_read_b32 v254, a46
    s_nop 0
    v_mul_f32 v254, v254, v250
    s_nop 0
    v_accvgpr_write_b32 a46, v254
    v_accvgpr_read_b32 v255, a47
    s_nop 0
    v_mul_f32 v255, v255, v250
    s_nop 0
    v_accvgpr_write_b32 a47, v255
    v_accvgpr_read_b32 v252, a48
    s_nop 0
    v_mul_f32 v252, v252, v251
    s_nop 0
    v_accvgpr_write_b32 a48, v252
    v_accvgpr_read_b32 v253, a49
    s_nop 0
    v_mul_f32 v253, v253, v251
    s_nop 0
    v_accvgpr_write_b32 a49, v253
    v_accvgpr_read_b32 v254, a50
    s_nop 0
    v_mul_f32 v254, v254, v251
    s_nop 0
    v_accvgpr_write_b32 a50, v254
    v_accvgpr_read_b32 v255, a51
    s_nop 0
    v_mul_f32 v255, v255, v251
    s_nop 0
    v_accvgpr_write_b32 a51, v255
    v_accvgpr_read_b32 v252, a52
    s_nop 0
    v_mul_f32 v252, v252, v251
    s_nop 0
    v_accvgpr_write_b32 a52, v252
    v_accvgpr_read_b32 v253, a53
    s_nop 0
    v_mul_f32 v253, v253, v251
    s_nop 0
    v_accvgpr_write_b32 a53, v253
    v_accvgpr_read_b32 v254, a54
    s_nop 0
    v_mul_f32 v254, v254, v251
    s_nop 0
    v_accvgpr_write_b32 a54, v254
    v_accvgpr_read_b32 v255, a55
    s_nop 0
    v_mul_f32 v255, v255, v251
    s_nop 0
    v_accvgpr_write_b32 a55, v255
    v_accvgpr_read_b32 v252, a56
    s_nop 0
    v_mul_f32 v252, v252, v251
    s_nop 0
    v_accvgpr_write_b32 a56, v252
    v_accvgpr_read_b32 v253, a57
    s_nop 0
    v_mul_f32 v253, v253, v251
    s_nop 0
    v_accvgpr_write_b32 a57, v253
    v_accvgpr_read_b32 v254, a58
    s_nop 0
    v_mul_f32 v254, v254, v251
    s_nop 0
    v_accvgpr_write_b32 a58, v254
    v_accvgpr_read_b32 v255, a59
    s_nop 0
    v_mul_f32 v255, v255, v251
    s_nop 0
    v_accvgpr_write_b32 a59, v255
    v_accvgpr_read_b32 v252, a60
    s_nop 0
    v_mul_f32 v252, v252, v251
    s_nop 0
    v_accvgpr_write_b32 a60, v252
    v_accvgpr_read_b32 v253, a61
    s_nop 0
    v_mul_f32 v253, v253, v251
    s_nop 0
    v_accvgpr_write_b32 a61, v253
    v_accvgpr_read_b32 v254, a62
    s_nop 0
    v_mul_f32 v254, v254, v251
    s_nop 0
    v_accvgpr_write_b32 a62, v254
    v_accvgpr_read_b32 v255, a63
    s_nop 0
    v_mul_f32 v255, v255, v251
    s_nop 0
    v_accvgpr_write_b32 a63, v255
    v_accvgpr_read_b32 v252, a64
    s_nop 0
    v_mul_f32 v252, v252, v250
    s_nop 0
    v_accvgpr_write_b32 a64, v252
    v_accvgpr_read_b32 v253, a65
    s_nop 0
    v_mul_f32 v253, v253, v250
    s_nop 0
    v_accvgpr_write_b32 a65, v253
    v_accvgpr_read_b32 v254, a66
    s_nop 0
    v_mul_f32 v254, v254, v250
    s_nop 0
    v_accvgpr_write_b32 a66, v254
    v_accvgpr_read_b32 v255, a67
    s_nop 0
    v_mul_f32 v255, v255, v250
    s_nop 0
    v_accvgpr_write_b32 a67, v255
    v_accvgpr_read_b32 v252, a68
    s_nop 0
    v_mul_f32 v252, v252, v250
    s_nop 0
    v_accvgpr_write_b32 a68, v252
    v_accvgpr_read_b32 v253, a69
    s_nop 0
    v_mul_f32 v253, v253, v250
    s_nop 0
    v_accvgpr_write_b32 a69, v253
    v_accvgpr_read_b32 v254, a70
    s_nop 0
    v_mul_f32 v254, v254, v250
    s_nop 0
    v_accvgpr_write_b32 a70, v254
    v_accvgpr_read_b32 v255, a71
    s_nop 0
    v_mul_f32 v255, v255, v250
    s_nop 0
    v_accvgpr_write_b32 a71, v255
    v_accvgpr_read_b32 v252, a72
    s_nop 0
    v_mul_f32 v252, v252, v250
    s_nop 0
    v_accvgpr_write_b32 a72, v252
    v_accvgpr_read_b32 v253, a73
    s_nop 0
    v_mul_f32 v253, v253, v250
    s_nop 0
    v_accvgpr_write_b32 a73, v253
    v_accvgpr_read_b32 v254, a74
    s_nop 0
    v_mul_f32 v254, v254, v250
    s_nop 0
    v_accvgpr_write_b32 a74, v254
    v_accvgpr_read_b32 v255, a75
    s_nop 0
    v_mul_f32 v255, v255, v250
    s_nop 0
    v_accvgpr_write_b32 a75, v255
    v_accvgpr_read_b32 v252, a76
    s_nop 0
    v_mul_f32 v252, v252, v250
    s_nop 0
    v_accvgpr_write_b32 a76, v252
    v_accvgpr_read_b32 v253, a77
    s_nop 0
    v_mul_f32 v253, v253, v250
    s_nop 0
    v_accvgpr_write_b32 a77, v253
    v_accvgpr_read_b32 v254, a78
    s_nop 0
    v_mul_f32 v254, v254, v250
    s_nop 0
    v_accvgpr_write_b32 a78, v254
    v_accvgpr_read_b32 v255, a79
    s_nop 0
    v_mul_f32 v255, v255, v250
    s_nop 0
    v_accvgpr_write_b32 a79, v255
    v_accvgpr_read_b32 v252, a80
    s_nop 0
    v_mul_f32 v252, v252, v251
    s_nop 0
    v_accvgpr_write_b32 a80, v252
    v_accvgpr_read_b32 v253, a81
    s_nop 0
    v_mul_f32 v253, v253, v251
    s_nop 0
    v_accvgpr_write_b32 a81, v253
    v_accvgpr_read_b32 v254, a82
    s_nop 0
    v_mul_f32 v254, v254, v251
    s_nop 0
    v_accvgpr_write_b32 a82, v254
    v_accvgpr_read_b32 v255, a83
    s_nop 0
    v_mul_f32 v255, v255, v251
    s_nop 0
    v_accvgpr_write_b32 a83, v255
    v_accvgpr_read_b32 v252, a84
    s_nop 0
    v_mul_f32 v252, v252, v251
    s_nop 0
    v_accvgpr_write_b32 a84, v252
    v_accvgpr_read_b32 v253, a85
    s_nop 0
    v_mul_f32 v253, v253, v251
    s_nop 0
    v_accvgpr_write_b32 a85, v253
    v_accvgpr_read_b32 v254, a86
    s_nop 0
    v_mul_f32 v254, v254, v251
    s_nop 0
    v_accvgpr_write_b32 a86, v254
    v_accvgpr_read_b32 v255, a87
    s_nop 0
    v_mul_f32 v255, v255, v251
    s_nop 0
    v_accvgpr_write_b32 a87, v255
    v_accvgpr_read_b32 v252, a88
    s_nop 0
    v_mul_f32 v252, v252, v251
    s_nop 0
    v_accvgpr_write_b32 a88, v252
    v_accvgpr_read_b32 v253, a89
    s_nop 0
    v_mul_f32 v253, v253, v251
    s_nop 0
    v_accvgpr_write_b32 a89, v253
    v_accvgpr_read_b32 v254, a90
    s_nop 0
    v_mul_f32 v254, v254, v251
    s_nop 0
    v_accvgpr_write_b32 a90, v254
    v_accvgpr_read_b32 v255, a91
    s_nop 0
    v_mul_f32 v255, v255, v251
    s_nop 0
    v_accvgpr_write_b32 a91, v255
    v_accvgpr_read_b32 v252, a92
    s_nop 0
    v_mul_f32 v252, v252, v251
    s_nop 0
    v_accvgpr_write_b32 a92, v252
    v_accvgpr_read_b32 v253, a93
    s_nop 0
    v_mul_f32 v253, v253, v251
    s_nop 0
    v_accvgpr_write_b32 a93, v253
    v_accvgpr_read_b32 v254, a94
    s_nop 0
    v_mul_f32 v254, v254, v251
    s_nop 0
    v_accvgpr_write_b32 a94, v254
    v_accvgpr_read_b32 v255, a95
    s_nop 0
    v_mul_f32 v255, v255, v251
    s_nop 0
    v_accvgpr_write_b32 a95, v255
    v_accvgpr_read_b32 v252, a96
    s_nop 0
    v_mul_f32 v252, v252, v250
    s_nop 0
    v_accvgpr_write_b32 a96, v252
    v_accvgpr_read_b32 v253, a97
    s_nop 0
    v_mul_f32 v253, v253, v250
    s_nop 0
    v_accvgpr_write_b32 a97, v253
    v_accvgpr_read_b32 v254, a98
    s_nop 0
    v_mul_f32 v254, v254, v250
    s_nop 0
    v_accvgpr_write_b32 a98, v254
    v_accvgpr_read_b32 v255, a99
    s_nop 0
    v_mul_f32 v255, v255, v250
    s_nop 0
    v_accvgpr_write_b32 a99, v255
    v_accvgpr_read_b32 v252, a100
    s_nop 0
    v_mul_f32 v252, v252, v250
    s_nop 0
    v_accvgpr_write_b32 a100, v252
    v_accvgpr_read_b32 v253, a101
    s_nop 0
    v_mul_f32 v253, v253, v250
    s_nop 0
    v_accvgpr_write_b32 a101, v253
    v_accvgpr_read_b32 v254, a102
    s_nop 0
    v_mul_f32 v254, v254, v250
    s_nop 0
    v_accvgpr_write_b32 a102, v254
    v_accvgpr_read_b32 v255, a103
    s_nop 0
    v_mul_f32 v255, v255, v250
    s_nop 0
    v_accvgpr_write_b32 a103, v255
    v_accvgpr_read_b32 v252, a104
    s_nop 0
    v_mul_f32 v252, v252, v250
    s_nop 0
    v_accvgpr_write_b32 a104, v252
    v_accvgpr_read_b32 v253, a105
    s_nop 0
    v_mul_f32 v253, v253, v250
    s_nop 0
    v_accvgpr_write_b32 a105, v253
    v_accvgpr_read_b32 v254, a106
    s_nop 0
    v_mul_f32 v254, v254, v250
    s_nop 0
    v_accvgpr_write_b32 a106, v254
    v_accvgpr_read_b32 v255, a107
    s_nop 0
    v_mul_f32 v255, v255, v250
    s_nop 0
    v_accvgpr_write_b32 a107, v255
    v_accvgpr_read_b32 v252, a108
    s_nop 0
    v_mul_f32 v252, v252, v250
    s_nop 0
    v_accvgpr_write_b32 a108, v252
    v_accvgpr_read_b32 v253, a109
    s_nop 0
    v_mul_f32 v253, v253, v250
    s_nop 0
    v_accvgpr_write_b32 a109, v253
    v_accvgpr_read_b32 v254, a110
    s_nop 0
    v_mul_f32 v254, v254, v250
    s_nop 0
    v_accvgpr_write_b32 a110, v254
    v_accvgpr_read_b32 v255, a111
    s_nop 0
    v_mul_f32 v255, v255, v250
    s_nop 0
    v_accvgpr_write_b32 a111, v255
    v_accvgpr_read_b32 v252, a112
    s_nop 0
    v_mul_f32 v252, v252, v251
    s_nop 0
    v_accvgpr_write_b32 a112, v252
    v_accvgpr_read_b32 v253, a113
    s_nop 0
    v_mul_f32 v253, v253, v251
    s_nop 0
    v_accvgpr_write_b32 a113, v253
    v_accvgpr_read_b32 v254, a114
    s_nop 0
    v_mul_f32 v254, v254, v251
    s_nop 0
    v_accvgpr_write_b32 a114, v254
    v_accvgpr_read_b32 v255, a115
    s_nop 0
    v_mul_f32 v255, v255, v251
    s_nop 0
    v_accvgpr_write_b32 a115, v255
    v_accvgpr_read_b32 v252, a116
    s_nop 0
    v_mul_f32 v252, v252, v251
    s_nop 0
    v_accvgpr_write_b32 a116, v252
    v_accvgpr_read_b32 v253, a117
    s_nop 0
    v_mul_f32 v253, v253, v251
    s_nop 0
    v_accvgpr_write_b32 a117, v253
    v_accvgpr_read_b32 v254, a118
    s_nop 0
    v_mul_f32 v254, v254, v251
    s_nop 0
    v_accvgpr_write_b32 a118, v254
    v_accvgpr_read_b32 v255, a119
    s_nop 0
    v_mul_f32 v255, v255, v251
    s_nop 0
    v_accvgpr_write_b32 a119, v255
    v_accvgpr_read_b32 v252, a120
    s_nop 0
    v_mul_f32 v252, v252, v251
    s_nop 0
    v_accvgpr_write_b32 a120, v252
    v_accvgpr_read_b32 v253, a121
    s_nop 0
    v_mul_f32 v253, v253, v251
    s_nop 0
    v_accvgpr_write_b32 a121, v253
    v_accvgpr_read_b32 v254, a122
    s_nop 0
    v_mul_f32 v254, v254, v251
    s_nop 0
    v_accvgpr_write_b32 a122, v254
    v_accvgpr_read_b32 v255, a123
    s_nop 0
    v_mul_f32 v255, v255, v251
    s_nop 0
    v_accvgpr_write_b32 a123, v255
    v_accvgpr_read_b32 v252, a124
    s_nop 0
    v_mul_f32 v252, v252, v251
    s_nop 0
    v_accvgpr_write_b32 a124, v252
    v_accvgpr_read_b32 v253, a125
    s_nop 0
    v_mul_f32 v253, v253, v251
    s_nop 0
    v_accvgpr_write_b32 a125, v253
    v_accvgpr_read_b32 v254, a126
    s_nop 0
    v_mul_f32 v254, v254, v251
    s_nop 0
    v_accvgpr_write_b32 a126, v254
    v_accvgpr_read_b32 v255, a127
    s_nop 0
    v_mul_f32 v255, v255, v251
    s_nop 0
    v_accvgpr_write_b32 a127, v255
    v_sub_f32 v192, v192, v246
    v_sub_f32 v193, v193, v246
    v_sub_f32 v194, v194, v246
    v_sub_f32 v195, v195, v246
    v_sub_f32 v196, v196, v246
    v_sub_f32 v197, v197, v246
    v_sub_f32 v198, v198, v246
    v_sub_f32 v199, v199, v246
    v_sub_f32 v200, v200, v246
    v_sub_f32 v201, v201, v246
    v_sub_f32 v202, v202, v246
    v_sub_f32 v203, v203, v246
    v_sub_f32 v204, v204, v246
    v_sub_f32 v205, v205, v246
    v_sub_f32 v206, v206, v246
    v_sub_f32 v207, v207, v246
    v_sub_f32 v208, v208, v247
    v_sub_f32 v209, v209, v247
    v_sub_f32 v210, v210, v247
    v_sub_f32 v211, v211, v247
    v_sub_f32 v212, v212, v247
    v_sub_f32 v213, v213, v247
    v_sub_f32 v214, v214, v247
    v_sub_f32 v215, v215, v247
    v_sub_f32 v216, v216, v247
    v_sub_f32 v217, v217, v247
    v_sub_f32 v218, v218, v247
    v_sub_f32 v219, v219, v247
    v_sub_f32 v220, v220, v247
    v_sub_f32 v221, v221, v247
    v_sub_f32 v222, v222, v247
    v_sub_f32 v223, v223, v247
    v_sub_f32 v0, v0, v246
    v_sub_f32 v1, v1, v246
    v_sub_f32 v2, v2, v246
    v_sub_f32 v3, v3, v246
    v_sub_f32 v4, v4, v246
    v_sub_f32 v5, v5, v246
    v_sub_f32 v6, v6, v246
    v_sub_f32 v7, v7, v246
    v_sub_f32 v8, v8, v246
    v_sub_f32 v9, v9, v246
    v_sub_f32 v10, v10, v246
    v_sub_f32 v11, v11, v246
    v_sub_f32 v12, v12, v246
    v_sub_f32 v13, v13, v246
    v_sub_f32 v14, v14, v246
    v_sub_f32 v15, v15, v246
    v_sub_f32 v16, v16, v247
    v_sub_f32 v17, v17, v247
    v_sub_f32 v18, v18, v247
    v_sub_f32 v19, v19, v247
    v_sub_f32 v20, v20, v247
    v_sub_f32 v21, v21, v247
    v_sub_f32 v22, v22, v247
    v_sub_f32 v23, v23, v247
    v_sub_f32 v24, v24, v247
    v_sub_f32 v25, v25, v247
    v_sub_f32 v26, v26, v247
    v_sub_f32 v27, v27, v247
    v_sub_f32 v28, v28, v247
    v_sub_f32 v29, v29, v247
    v_sub_f32 v30, v30, v247
    v_sub_f32 v31, v31, v247
    v_sub_f32 v32, v32, v246
    v_sub_f32 v33, v33, v246
    v_sub_f32 v34, v34, v246
    v_sub_f32 v35, v35, v246
    v_sub_f32 v36, v36, v246
    v_sub_f32 v37, v37, v246
    v_sub_f32 v38, v38, v246
    v_sub_f32 v39, v39, v246
    v_sub_f32 v40, v40, v246
    v_sub_f32 v41, v41, v246
    v_sub_f32 v42, v42, v246
    v_sub_f32 v43, v43, v246
    v_sub_f32 v44, v44, v246
    v_sub_f32 v45, v45, v246
    v_sub_f32 v46, v46, v246
    v_sub_f32 v47, v47, v246
    v_sub_f32 v48, v48, v247
    v_sub_f32 v49, v49, v247
    v_sub_f32 v50, v50, v247
    v_sub_f32 v51, v51, v247
    v_sub_f32 v52, v52, v247
    v_sub_f32 v53, v53, v247
    v_sub_f32 v54, v54, v247
    v_sub_f32 v55, v55, v247
    v_sub_f32 v56, v56, v247
    v_sub_f32 v57, v57, v247
    v_sub_f32 v58, v58, v247
    v_sub_f32 v59, v59, v247
    v_sub_f32 v60, v60, v247
    v_sub_f32 v61, v61, v247
    v_sub_f32 v62, v62, v247
    v_sub_f32 v63, v63, v247
    v_exp_f32 v0, v0
    v_exp_f32 v1, v1
    v_exp_f32 v2, v2
    v_exp_f32 v3, v3
    v_exp_f32 v4, v4
    v_exp_f32 v5, v5
    v_exp_f32 v6, v6
    v_exp_f32 v7, v7
    v_exp_f32 v8, v8
    v_exp_f32 v9, v9
    v_exp_f32 v10, v10
    v_exp_f32 v11, v11
    v_exp_f32 v12, v12
    v_exp_f32 v13, v13
    v_exp_f32 v14, v14
    v_exp_f32 v15, v15
    v_exp_f32 v16, v16
    v_exp_f32 v17, v17
    v_exp_f32 v18, v18
    v_exp_f32 v19, v19
    v_exp_f32 v20, v20
    v_exp_f32 v21, v21
    v_exp_f32 v22, v22
    v_exp_f32 v23, v23
    v_exp_f32 v24, v24
    v_exp_f32 v25, v25
    v_exp_f32 v26, v26
    v_exp_f32 v27, v27
    v_exp_f32 v28, v28
    v_exp_f32 v29, v29
    v_exp_f32 v30, v30
    v_exp_f32 v31, v31
    v_exp_f32 v32, v32
    v_exp_f32 v33, v33
    v_exp_f32 v34, v34
    v_exp_f32 v35, v35
    v_exp_f32 v36, v36
    v_exp_f32 v37, v37
    v_exp_f32 v38, v38
    v_exp_f32 v39, v39
    v_exp_f32 v40, v40
    v_exp_f32 v41, v41
    v_exp_f32 v42, v42
    v_exp_f32 v43, v43
    v_exp_f32 v44, v44
    v_exp_f32 v45, v45
    v_exp_f32 v46, v46
    v_exp_f32 v47, v47
    v_exp_f32 v48, v48
    v_exp_f32 v49, v49
    v_exp_f32 v50, v50
    v_exp_f32 v51, v51
    v_exp_f32 v52, v52
    v_exp_f32 v53, v53
    v_exp_f32 v54, v54
    v_exp_f32 v55, v55
    v_exp_f32 v56, v56
    v_exp_f32 v57, v57
    v_exp_f32 v58, v58
    v_exp_f32 v59, v59
    v_exp_f32 v60, v60
    v_exp_f32 v61, v61
    v_exp_f32 v62, v62
    v_exp_f32 v63, v63
    s_nop 0
    v_add_f32 v243, v0, v1
    v_add_f32 v243, v243, v2
    v_add_f32 v243, v243, v3
    v_add_f32 v243, v243, v4
    v_add_f32 v243, v243, v5
    v_add_f32 v243, v243, v6
    v_add_f32 v243, v243, v7
    v_add_f32 v243, v243, v8
    v_add_f32 v243, v243, v9
    v_add_f32 v243, v243, v10
    v_add_f32 v243, v243, v11
    v_add_f32 v243, v243, v12
    v_add_f32 v243, v243, v13
    v_add_f32 v243, v243, v14
    v_add_f32 v243, v243, v15
    v_add_f32 v243, v243, v32
    v_add_f32 v243, v243, v33
    v_add_f32 v243, v243, v34
    v_add_f32 v243, v243, v35
    v_add_f32 v243, v243, v36
    v_add_f32 v243, v243, v37
    v_add_f32 v243, v243, v38
    v_add_f32 v243, v243, v39
    v_add_f32 v243, v243, v40
    v_add_f32 v243, v243, v41
    v_add_f32 v243, v243, v42
    v_add_f32 v243, v243, v43
    v_add_f32 v243, v243, v44
    v_add_f32 v243, v243, v45
    v_add_f32 v243, v243, v46
    v_add_f32 v243, v243, v47
    v_add_f32 v244, v16, v17
    v_add_f32 v244, v244, v18
    v_add_f32 v244, v244, v19
    v_add_f32 v244, v244, v20
    v_add_f32 v244, v244, v21
    v_add_f32 v244, v244, v22
    v_add_f32 v244, v244, v23
    v_add_f32 v244, v244, v24
    v_add_f32 v244, v244, v25
    v_add_f32 v244, v244, v26
    v_add_f32 v244, v244, v27
    v_add_f32 v244, v244, v28
    v_add_f32 v244, v244, v29
    v_add_f32 v244, v244, v30
    v_add_f32 v244, v244, v31
    v_add_f32 v244, v244, v48
    v_add_f32 v244, v244, v49
    v_add_f32 v244, v244, v50
    v_add_f32 v244, v244, v51
    v_add_f32 v244, v244, v52
    v_add_f32 v244, v244, v53
    v_add_f32 v244, v244, v54
    v_add_f32 v244, v244, v55
    v_add_f32 v244, v244, v56
    v_add_f32 v244, v244, v57
    v_add_f32 v244, v244, v58
    v_add_f32 v244, v244, v59
    v_add_f32 v244, v244, v60
    v_add_f32 v244, v244, v61
    v_add_f32 v244, v244, v62
    v_add_f32 v244, v244, v63
    v_cvt_pk_bf16_f32 v128, v0, v1
    v_cvt_pk_bf16_f32 v129, v2, v3
    v_cvt_pk_bf16_f32 v130, v4, v5
    v_cvt_pk_bf16_f32 v131, v6, v7
    v_cvt_pk_bf16_f32 v136, v8, v9
    v_cvt_pk_bf16_f32 v137, v10, v11
    v_cvt_pk_bf16_f32 v138, v12, v13
    v_cvt_pk_bf16_f32 v139, v14, v15
    v_cvt_pk_bf16_f32 v132, v16, v17
    v_cvt_pk_bf16_f32 v133, v18, v19
    v_cvt_pk_bf16_f32 v134, v20, v21
    v_cvt_pk_bf16_f32 v135, v22, v23
    v_cvt_pk_bf16_f32 v140, v24, v25
    v_cvt_pk_bf16_f32 v141, v26, v27
    v_cvt_pk_bf16_f32 v142, v28, v29
    v_cvt_pk_bf16_f32 v143, v30, v31
    v_cvt_pk_bf16_f32 v144, v32, v33
    v_cvt_pk_bf16_f32 v145, v34, v35
    v_cvt_pk_bf16_f32 v146, v36, v37
    v_cvt_pk_bf16_f32 v147, v38, v39
    v_cvt_pk_bf16_f32 v152, v40, v41
    v_cvt_pk_bf16_f32 v153, v42, v43
    v_cvt_pk_bf16_f32 v154, v44, v45
    v_cvt_pk_bf16_f32 v155, v46, v47
    v_cvt_pk_bf16_f32 v148, v48, v49
    v_cvt_pk_bf16_f32 v149, v50, v51
    v_cvt_pk_bf16_f32 v150, v52, v53
    v_cvt_pk_bf16_f32 v151, v54, v55
    v_cvt_pk_bf16_f32 v156, v56, v57
    v_cvt_pk_bf16_f32 v157, v58, v59
    v_cvt_pk_bf16_f32 v158, v60, v61
    v_cvt_pk_bf16_f32 v159, v62, v63
    v_sub_f32 v64, v64, v246
    v_sub_f32 v65, v65, v246
    v_sub_f32 v66, v66, v246
    v_sub_f32 v67, v67, v246
    v_sub_f32 v68, v68, v246
    v_sub_f32 v69, v69, v246
    v_sub_f32 v70, v70, v246
    v_sub_f32 v71, v71, v246
    v_sub_f32 v72, v72, v246
    v_sub_f32 v73, v73, v246
    v_sub_f32 v74, v74, v246
    v_sub_f32 v75, v75, v246
    v_sub_f32 v76, v76, v246
    v_sub_f32 v77, v77, v246
    v_sub_f32 v78, v78, v246
    v_sub_f32 v79, v79, v246
    v_sub_f32 v80, v80, v247
    v_sub_f32 v81, v81, v247
    v_sub_f32 v82, v82, v247
    v_sub_f32 v83, v83, v247
    v_sub_f32 v84, v84, v247
    v_sub_f32 v85, v85, v247
    v_sub_f32 v86, v86, v247
    v_sub_f32 v87, v87, v247
    v_sub_f32 v88, v88, v247
    v_sub_f32 v89, v89, v247
    v_sub_f32 v90, v90, v247
    v_sub_f32 v91, v91, v247
    v_sub_f32 v92, v92, v247
    v_sub_f32 v93, v93, v247
    v_sub_f32 v94, v94, v247
    v_sub_f32 v95, v95, v247
    v_sub_f32 v96, v96, v246
    v_sub_f32 v97, v97, v246
    v_sub_f32 v98, v98, v246
    v_sub_f32 v99, v99, v246
    v_sub_f32 v100, v100, v246
    v_sub_f32 v101, v101, v246
    v_sub_f32 v102, v102, v246
    v_sub_f32 v103, v103, v246
    v_sub_f32 v104, v104, v246
    v_sub_f32 v105, v105, v246
    v_sub_f32 v106, v106, v246
    v_sub_f32 v107, v107, v246
    v_sub_f32 v108, v108, v246
    v_sub_f32 v109, v109, v246
    v_sub_f32 v110, v110, v246
    v_sub_f32 v111, v111, v246
    v_sub_f32 v112, v112, v247
    v_sub_f32 v113, v113, v247
    v_sub_f32 v114, v114, v247
    v_sub_f32 v115, v115, v247
    v_sub_f32 v116, v116, v247
    v_sub_f32 v117, v117, v247
    v_sub_f32 v118, v118, v247
    v_sub_f32 v119, v119, v247
    v_sub_f32 v120, v120, v247
    v_sub_f32 v121, v121, v247
    v_sub_f32 v122, v122, v247
    v_sub_f32 v123, v123, v247
    v_sub_f32 v124, v124, v247
    v_sub_f32 v125, v125, v247
    v_sub_f32 v126, v126, v247
    v_sub_f32 v127, v127, v247
    s_nop 7
    ds_read_b128 a[192:195], v224 offset:32768
    ds_read_b128 a[196:199], v225 offset:32768
    ds_read_b128 a[200:203], v226 offset:32768
    ds_read_b128 a[204:207], v227 offset:32768
    s_branch L_ret5
L_rareT:
    s_nop 15
    s_nop 3
    s_waitcnt vmcnt(0) lgkmcnt(0)
    s_add_u32 s46, s35, 8192
    buffer_load_dwordx4 a[192:195], v245, s[8:11], s35 offen
    buffer_load_dwordx4 a[196:199], v245, s[8:11], s35 offen offset:32
    buffer_load_dwordx4 a[200:203], v245, s[8:11], s35 offen offset:64
    buffer_load_dwordx4 a[204:207], v245, s[8:11], s35 offen offset:96
    buffer_load_dwordx4 a[208:211], v245, s[8:11], s35 offen offset:128
    buffer_load_dwordx4 a[212:215], v245, s[8:11], s35 offen offset:160
    buffer_load_dwordx4 a[216:219], v245, s[8:11], s35 offen offset:192
    buffer_load_dwordx4 a[220:223], v245, s[8:11], s35 offen offset:224
    buffer_load_dwordx4 a[224:227], v245, s[8:11], s46 offen
    buffer_load_dwordx4 a[228:231], v245, s[8:11], s46 offen offset:32
    buffer_load_dwordx4 a[232:235], v245, s[8:11], s46 offen offset:64
    buffer_load_dwordx4 a[236:239], v245, s[8:11], s46 offen offset:96
    buffer_load_dwordx4 a[240:243], v245, s[8:11], s46 offen offset:128
    buffer_load_dwordx4 a[244:247], v245, s[8:11], s46 offen offset:160
    buffer_load_dwordx4 a[248:251], v245, s[8:11], s46 offen offset:192
    buffer_load_dwordx4 a[252:255], v245, s[8:11], s46 offen offset:224
    s_waitcnt vmcnt(0)
    s_nop 1
    v_mfma_f32_32x32x16_bf16 v[64:79], a[192:195], a[128:131], v[192:207]
    v_mfma_f32_32x32x16_bf16 v[80:95], a[192:195], a[160:163], v[208:223]
    v_mfma_f32_32x32x16_bf16 v[64:79], a[196:199], a[132:135], v[64:79]
    v_mfma_f32_32x32x16_bf16 v[80:95], a[196:199], a[164:167], v[80:95]
    v_mfma_f32_32x32x16_bf16 v[64:79], a[200:203], a[136:139], v[64:79]
    v_mfma_f32_32x32x16_bf16 v[80:95], a[200:203], a[168:171], v[80:95]
    v_mfma_f32_32x32x16_bf16 v[64:79], a[204:207], a[140:143], v[64:79]
    v_mfma_f32_32x32x16_bf16 v[80:95], a[204:207], a[172:175], v[80:95]
    v_mfma_f32_32x32x16_bf16 v[64:79], a[208:211], a[144:147], v[64:79]
    v_mfma_f32_32x32x16_bf16 v[80:95], a[208:211], a[176:179], v[80:95]
    v_mfma_f32_32x32x16_bf16 v[64:79], a[212:215], a[148:151], v[64:79]
    v_mfma_f32_32x32x16_bf16 v[80:95], a[212:215], a[180:183], v[80:95]
    v_mfma_f32_32x32x16_bf16 v[64:79], a[216:219], a[152:155], v[64:79]
    v_mfma_f32_32x32x16_bf16 v[80:95], a[216:219], a[184:187], v[80:95]
    v_mfma_f32_32x32x16_bf16 v[64:79], a[220:223], a[156:159], v[64:79]
    v_mfma_f32_32x32x16_bf16 v[80:95], a[220:223], a[188:191], v[80:95]
    v_mfma_f32_32x32x16_bf16 v[96:111], a[224:227], a[128:131], v[192:207]
    v_mfma_f32_32x32x16_bf16 v[112:127], a[224:227], a[160:163], v[208:223]
    v_mfma_f32_32x32x16_bf16 v[96:111], a[228:231], a[132:135], v[96:111]
    v_mfma_f32_32x32x16_bf16 v[112:127], a[228:231], a[164:167], v[112:127]
    v_mfma_f32_32x32x16_bf16 v[96:111], a[232:235], a[136:139], v[96:111]
    v_mfma_f32_32x32x16_bf16 v[112:127], a[232:235], a[168:171], v[112:127]
    v_mfma_f32_32x32x16_bf16 v[96:111], a[236:239], a[140:143], v[96:111]
    v_mfma_f32_32x32x16_bf16 v[112:127], a[236:239], a[172:175], v[112:127]
    v_mfma_f32_32x32x16_bf16 v[96:111], a[240:243], a[144:147], v[96:111]
    v_mfma_f32_32x32x16_bf16 v[112:127], a[240:243], a[176:179], v[112:127]
    v_mfma_f32_32x32x16_bf16 v[96:111], a[244:247], a[148:151], v[96:111]
    v_mfma_f32_32x32x16_bf16 v[112:127], a[244:247], a[180:183], v[112:127]
    v_mfma_f32_32x32x16_bf16 v[96:111], a[248:251], a[152:155], v[96:111]
    v_mfma_f32_32x32x16_bf16 v[112:127], a[248:251], a[184:187], v[112:127]
    v_mfma_f32_32x32x16_bf16 v[96:111], a[252:255], a[156:159], v[96:111]
    v_mfma_f32_32x32x16_bf16 v[112:127], a[252:255], a[188:191], v[112:127]
    s_nop 15
    s_nop 3
    v_max3_f32 v246, v64, v65, v66
    v_max3_f32 v246, v246, v67, v68
    v_max3_f32 v246, v246, v69, v70
    v_max3_f32 v246, v246, v71, v72
    v_max3_f32 v246, v246, v73, v74
    v_max3_f32 v246, v246, v75, v76
    v_max3_f32 v246, v246, v77, v78
    v_max3_f32 v246, v246, v79, v96
    v_max3_f32 v246, v246, v97, v98
    v_max3_f32 v246, v246, v99, v100
    v_max3_f32 v246, v246, v101, v102
    v_max3_f32 v246, v246, v103, v104
    v_max3_f32 v246, v246, v105, v106
    v_max3_f32 v246, v246, v107, v108
    v_max3_f32 v246, v246, v109, v110
    v_max_f32 v246, v246, v111
    v_mov_b32 v248, v246
    v_mov_b32 v249, v246
    s_nop 1
    v_permlane32_swap_b32 v248, v249
    s_nop 1
    v_max_f32 v246, v248, v249
    v_max_f32 v246, 0, v246
    v_max3_f32 v247, v80, v81, v82
    v_max3_f32 v247, v247, v83, v84
    v_max3_f32 v247, v247, v85, v86
    v_max3_f32 v247, v247, v87, v88
    v_max3_f32 v247, v247, v89, v90
    v_max3_f32 v247, v247, v91, v92
    v_max3_f32 v247, v247, v93, v94
    v_max3_f32 v247, v247, v95, v112
    v_max3_f32 v247, v247, v113, v114
    v_max3_f32 v247, v247, v115, v116
    v_max3_f32 v247, v247, v117, v118
    v_max3_f32 v247, v247, v119, v120
    v_max3_f32 v247, v247, v121, v122
    v_max3_f32 v247, v247, v123, v124
    v_max3_f32 v247, v247, v125, v126
    v_max_f32 v247, v247, v127
    v_mov_b32 v248, v247
    v_mov_b32 v249, v247
    s_nop 1
    v_permlane32_swap_b32 v248, v249
    s_nop 1
    v_max_f32 v247, v248, v249
    v_max_f32 v247, 0, v247
    v_exp_f32_e64 v250, -v246
    v_exp_f32_e64 v251, -v247
    s_nop 1
    v_mul_f32 v241, v241, v250
    v_mul_f32 v242, v242, v251
    v_accvgpr_read_b32 v252, a0
    s_nop 0
    v_mul_f32 v252, v252, v250
    s_nop 0
    v_accvgpr_write_b32 a0, v252
    v_accvgpr_read_b32 v253, a1
    s_nop 0
    v_mul_f32 v253, v253, v250
    s_nop 0
    v_accvgpr_write_b32 a1, v253
    v_accvgpr_read_b32 v254, a2
    s_nop 0
    v_mul_f32 v254, v254, v250
    s_nop 0
    v_accvgpr_write_b32 a2, v254
    v_accvgpr_read_b32 v255, a3
    s_nop 0
    v_mul_f32 v255, v255, v250
    s_nop 0
    v_accvgpr_write_b32 a3, v255
    v_accvgpr_read_b32 v252, a4
    s_nop 0
    v_mul_f32 v252, v252, v250
    s_nop 0
    v_accvgpr_write_b32 a4, v252
    v_accvgpr_read_b32 v253, a5
    s_nop 0
    v_mul_f32 v253, v253, v250
    s_nop 0
    v_accvgpr_write_b32 a5, v253
    v_accvgpr_read_b32 v254, a6
    s_nop 0
    v_mul_f32 v254, v254, v250
    s_nop 0
    v_accvgpr_write_b32 a6, v254
    v_accvgpr_read_b32 v255, a7
    s_nop 0
    v_mul_f32 v255, v255, v250
    s_nop 0
    v_accvgpr_write_b32 a7, v255
    v_accvgpr_read_b32 v252, a8
    s_nop 0
    v_mul_f32 v252, v252, v250
    s_nop 0
    v_accvgpr_write_b32 a8, v252
    v_accvgpr_read_b32 v253, a9
    s_nop 0
    v_mul_f32 v253, v253, v250
    s_nop 0
    v_accvgpr_write_b32 a9, v253
    v_accvgpr_read_b32 v254, a10
    s_nop 0
    v_mul_f32 v254, v254, v250
    s_nop 0
    v_accvgpr_write_b32 a10, v254
    v_accvgpr_read_b32 v255, a11
    s_nop 0
    v_mul_f32 v255, v255, v250
    s_nop 0
    v_accvgpr_write_b32 a11, v255
    v_accvgpr_read_b32 v252, a12
    s_nop 0
    v_mul_f32 v252, v252, v250
    s_nop 0
    v_accvgpr_write_b32 a12, v252
    v_accvgpr_read_b32 v253, a13
    s_nop 0
    v_mul_f32 v253, v253, v250
    s_nop 0
    v_accvgpr_write_b32 a13, v253
    v_accvgpr_read_b32 v254, a14
    s_nop 0
    v_mul_f32 v254, v254, v250
    s_nop 0
    v_accvgpr_write_b32 a14, v254
    v_accvgpr_read_b32 v255, a15
    s_nop 0
    v_mul_f32 v255, v255, v250
    s_nop 0
    v_accvgpr_write_b32 a15, v255
    v_accvgpr_read_b32 v252, a16
    s_nop 0
    v_mul_f32 v252, v252, v251
    s_nop 0
    v_accvgpr_write_b32 a16, v252
    v_accvgpr_read_b32 v253, a17
    s_nop 0
    v_mul_f32 v253, v253, v251
    s_nop 0
    v_accvgpr_write_b32 a17, v253
    v_accvgpr_read_b32 v254, a18
    s_nop 0
    v_mul_f32 v254, v254, v251
    s_nop 0
    v_accvgpr_write_b32 a18, v254
    v_accvgpr_read_b32 v255, a19
    s_nop 0
    v_mul_f32 v255, v255, v251
    s_nop 0
    v_accvgpr_write_b32 a19, v255
    v_accvgpr_read_b32 v252, a20
    s_nop 0
    v_mul_f32 v252, v252, v251
    s_nop 0
    v_accvgpr_write_b32 a20, v252
    v_accvgpr_read_b32 v253, a21
    s_nop 0
    v_mul_f32 v253, v253, v251
    s_nop 0
    v_accvgpr_write_b32 a21, v253
    v_accvgpr_read_b32 v254, a22
    s_nop 0
    v_mul_f32 v254, v254, v251
    s_nop 0
    v_accvgpr_write_b32 a22, v254
    v_accvgpr_read_b32 v255, a23
    s_nop 0
    v_mul_f32 v255, v255, v251
    s_nop 0
    v_accvgpr_write_b32 a23, v255
    v_accvgpr_read_b32 v252, a24
    s_nop 0
    v_mul_f32 v252, v252, v251
    s_nop 0
    v_accvgpr_write_b32 a24, v252
    v_accvgpr_read_b32 v253, a25
    s_nop 0
    v_mul_f32 v253, v253, v251
    s_nop 0
    v_accvgpr_write_b32 a25, v253
    v_accvgpr_read_b32 v254, a26
    s_nop 0
    v_mul_f32 v254, v254, v251
    s_nop 0
    v_accvgpr_write_b32 a26, v254
    v_accvgpr_read_b32 v255, a27
    s_nop 0
    v_mul_f32 v255, v255, v251
    s_nop 0
    v_accvgpr_write_b32 a27, v255
    v_accvgpr_read_b32 v252, a28
    s_nop 0
    v_mul_f32 v252, v252, v251
    s_nop 0
    v_accvgpr_write_b32 a28, v252
    v_accvgpr_read_b32 v253, a29
    s_nop 0
    v_mul_f32 v253, v253, v251
    s_nop 0
    v_accvgpr_write_b32 a29, v253
    v_accvgpr_read_b32 v254, a30
    s_nop 0
    v_mul_f32 v254, v254, v251
    s_nop 0
    v_accvgpr_write_b32 a30, v254
    v_accvgpr_read_b32 v255, a31
    s_nop 0
    v_mul_f32 v255, v255, v251
    s_nop 0
    v_accvgpr_write_b32 a31, v255
    v_accvgpr_read_b32 v252, a32
    s_nop 0
    v_mul_f32 v252, v252, v250
    s_nop 0
    v_accvgpr_write_b32 a32, v252
    v_accvgpr_read_b32 v253, a33
    s_nop 0
    v_mul_f32 v253, v253, v250
    s_nop 0
    v_accvgpr_write_b32 a33, v253
    v_accvgpr_read_b32 v254, a34
    s_nop 0
    v_mul_f32 v254, v254, v250
    s_nop 0
    v_accvgpr_write_b32 a34, v254
    v_accvgpr_read_b32 v255, a35
    s_nop 0
    v_mul_f32 v255, v255, v250
    s_nop 0
    v_accvgpr_write_b32 a35, v255
    v_accvgpr_read_b32 v252, a36
    s_nop 0
    v_mul_f32 v252, v252, v250
    s_nop 0
    v_accvgpr_write_b32 a36, v252
    v_accvgpr_read_b32 v253, a37
    s_nop 0
    v_mul_f32 v253, v253, v250
    s_nop 0
    v_accvgpr_write_b32 a37, v253
    v_accvgpr_read_b32 v254, a38
    s_nop 0
    v_mul_f32 v254, v254, v250
    s_nop 0
    v_accvgpr_write_b32 a38, v254
    v_accvgpr_read_b32 v255, a39
    s_nop 0
    v_mul_f32 v255, v255, v250
    s_nop 0
    v_accvgpr_write_b32 a39, v255
    v_accvgpr_read_b32 v252, a40
    s_nop 0
    v_mul_f32 v252, v252, v250
    s_nop 0
    v_accvgpr_write_b32 a40, v252
    v_accvgpr_read_b32 v253, a41
    s_nop 0
    v_mul_f32 v253, v253, v250
    s_nop 0
    v_accvgpr_write_b32 a41, v253
    v_accvgpr_read_b32 v254, a42
    s_nop 0
    v_mul_f32 v254, v254, v250
    s_nop 0
    v_accvgpr_write_b32 a42, v254
    v_accvgpr_read_b32 v255, a43
    s_nop 0
    v_mul_f32 v255, v255, v250
    s_nop 0
    v_accvgpr_write_b32 a43, v255
    v_accvgpr_read_b32 v252, a44
    s_nop 0
    v_mul_f32 v252, v252, v250
    s_nop 0
    v_accvgpr_write_b32 a44, v252
    v_accvgpr_read_b32 v253, a45
    s_nop 0
    v_mul_f32 v253, v253, v250
    s_nop 0
    v_accvgpr_write_b32 a45, v253
    v_accvgpr_read_b32 v254, a46
    s_nop 0
    v_mul_f32 v254, v254, v250
    s_nop 0
    v_accvgpr_write_b32 a46, v254
    v_accvgpr_read_b32 v255, a47
    s_nop 0
    v_mul_f32 v255, v255, v250
    s_nop 0
    v_accvgpr_write_b32 a47, v255
    v_accvgpr_read_b32 v252, a48
    s_nop 0
    v_mul_f32 v252, v252, v251
    s_nop 0
    v_accvgpr_write_b32 a48, v252
    v_accvgpr_read_b32 v253, a49
    s_nop 0
    v_mul_f32 v253, v253, v251
    s_nop 0
    v_accvgpr_write_b32 a49, v253
    v_accvgpr_read_b32 v254, a50
    s_nop 0
    v_mul_f32 v254, v254, v251
    s_nop 0
    v_accvgpr_write_b32 a50, v254
    v_accvgpr_read_b32 v255, a51
    s_nop 0
    v_mul_f32 v255, v255, v251
    s_nop 0
    v_accvgpr_write_b32 a51, v255
    v_accvgpr_read_b32 v252, a52
    s_nop 0
    v_mul_f32 v252, v252, v251
    s_nop 0
    v_accvgpr_write_b32 a52, v252
    v_accvgpr_read_b32 v253, a53
    s_nop 0
    v_mul_f32 v253, v253, v251
    s_nop 0
    v_accvgpr_write_b32 a53, v253
    v_accvgpr_read_b32 v254, a54
    s_nop 0
    v_mul_f32 v254, v254, v251
    s_nop 0
    v_accvgpr_write_b32 a54, v254
    v_accvgpr_read_b32 v255, a55
    s_nop 0
    v_mul_f32 v255, v255, v251
    s_nop 0
    v_accvgpr_write_b32 a55, v255
    v_accvgpr_read_b32 v252, a56
    s_nop 0
    v_mul_f32 v252, v252, v251
    s_nop 0
    v_accvgpr_write_b32 a56, v252
    v_accvgpr_read_b32 v253, a57
    s_nop 0
    v_mul_f32 v253, v253, v251
    s_nop 0
    v_accvgpr_write_b32 a57, v253
    v_accvgpr_read_b32 v254, a58
    s_nop 0
    v_mul_f32 v254, v254, v251
    s_nop 0
    v_accvgpr_write_b32 a58, v254
    v_accvgpr_read_b32 v255, a59
    s_nop 0
    v_mul_f32 v255, v255, v251
    s_nop 0
    v_accvgpr_write_b32 a59, v255
    v_accvgpr_read_b32 v252, a60
    s_nop 0
    v_mul_f32 v252, v252, v251
    s_nop 0
    v_accvgpr_write_b32 a60, v252
    v_accvgpr_read_b32 v253, a61
    s_nop 0
    v_mul_f32 v253, v253, v251
    s_nop 0
    v_accvgpr_write_b32 a61, v253
    v_accvgpr_read_b32 v254, a62
    s_nop 0
    v_mul_f32 v254, v254, v251
    s_nop 0
    v_accvgpr_write_b32 a62, v254
    v_accvgpr_read_b32 v255, a63
    s_nop 0
    v_mul_f32 v255, v255, v251
    s_nop 0
    v_accvgpr_write_b32 a63, v255
    v_accvgpr_read_b32 v252, a64
    s_nop 0
    v_mul_f32 v252, v252, v250
    s_nop 0
    v_accvgpr_write_b32 a64, v252
    v_accvgpr_read_b32 v253, a65
    s_nop 0
    v_mul_f32 v253, v253, v250
    s_nop 0
    v_accvgpr_write_b32 a65, v253
    v_accvgpr_read_b32 v254, a66
    s_nop 0
    v_mul_f32 v254, v254, v250
    s_nop 0
    v_accvgpr_write_b32 a66, v254
    v_accvgpr_read_b32 v255, a67
    s_nop 0
    v_mul_f32 v255, v255, v250
    s_nop 0
    v_accvgpr_write_b32 a67, v255
    v_accvgpr_read_b32 v252, a68
    s_nop 0
    v_mul_f32 v252, v252, v250
    s_nop 0
    v_accvgpr_write_b32 a68, v252
    v_accvgpr_read_b32 v253, a69
    s_nop 0
    v_mul_f32 v253, v253, v250
    s_nop 0
    v_accvgpr_write_b32 a69, v253
    v_accvgpr_read_b32 v254, a70
    s_nop 0
    v_mul_f32 v254, v254, v250
    s_nop 0
    v_accvgpr_write_b32 a70, v254
    v_accvgpr_read_b32 v255, a71
    s_nop 0
    v_mul_f32 v255, v255, v250
    s_nop 0
    v_accvgpr_write_b32 a71, v255
    v_accvgpr_read_b32 v252, a72
    s_nop 0
    v_mul_f32 v252, v252, v250
    s_nop 0
    v_accvgpr_write_b32 a72, v252
    v_accvgpr_read_b32 v253, a73
    s_nop 0
    v_mul_f32 v253, v253, v250
    s_nop 0
    v_accvgpr_write_b32 a73, v253
    v_accvgpr_read_b32 v254, a74
    s_nop 0
    v_mul_f32 v254, v254, v250
    s_nop 0
    v_accvgpr_write_b32 a74, v254
    v_accvgpr_read_b32 v255, a75
    s_nop 0
    v_mul_f32 v255, v255, v250
    s_nop 0
    v_accvgpr_write_b32 a75, v255
    v_accvgpr_read_b32 v252, a76
    s_nop 0
    v_mul_f32 v252, v252, v250
    s_nop 0
    v_accvgpr_write_b32 a76, v252
    v_accvgpr_read_b32 v253, a77
    s_nop 0
    v_mul_f32 v253, v253, v250
    s_nop 0
    v_accvgpr_write_b32 a77, v253
    v_accvgpr_read_b32 v254, a78
    s_nop 0
    v_mul_f32 v254, v254, v250
    s_nop 0
    v_accvgpr_write_b32 a78, v254
    v_accvgpr_read_b32 v255, a79
    s_nop 0
    v_mul_f32 v255, v255, v250
    s_nop 0
    v_accvgpr_write_b32 a79, v255
    v_accvgpr_read_b32 v252, a80
    s_nop 0
    v_mul_f32 v252, v252, v251
    s_nop 0
    v_accvgpr_write_b32 a80, v252
    v_accvgpr_read_b32 v253, a81
    s_nop 0
    v_mul_f32 v253, v253, v251
    s_nop 0
    v_accvgpr_write_b32 a81, v253
    v_accvgpr_read_b32 v254, a82
    s_nop 0
    v_mul_f32 v254, v254, v251
    s_nop 0
    v_accvgpr_write_b32 a82, v254
    v_accvgpr_read_b32 v255, a83
    s_nop 0
    v_mul_f32 v255, v255, v251
    s_nop 0
    v_accvgpr_write_b32 a83, v255
    v_accvgpr_read_b32 v252, a84
    s_nop 0
    v_mul_f32 v252, v252, v251
    s_nop 0
    v_accvgpr_write_b32 a84, v252
    v_accvgpr_read_b32 v253, a85
    s_nop 0
    v_mul_f32 v253, v253, v251
    s_nop 0
    v_accvgpr_write_b32 a85, v253
    v_accvgpr_read_b32 v254, a86
    s_nop 0
    v_mul_f32 v254, v254, v251
    s_nop 0
    v_accvgpr_write_b32 a86, v254
    v_accvgpr_read_b32 v255, a87
    s_nop 0
    v_mul_f32 v255, v255, v251
    s_nop 0
    v_accvgpr_write_b32 a87, v255
    v_accvgpr_read_b32 v252, a88
    s_nop 0
    v_mul_f32 v252, v252, v251
    s_nop 0
    v_accvgpr_write_b32 a88, v252
    v_accvgpr_read_b32 v253, a89
    s_nop 0
    v_mul_f32 v253, v253, v251
    s_nop 0
    v_accvgpr_write_b32 a89, v253
    v_accvgpr_read_b32 v254, a90
    s_nop 0
    v_mul_f32 v254, v254, v251
    s_nop 0
    v_accvgpr_write_b32 a90, v254
    v_accvgpr_read_b32 v255, a91
    s_nop 0
    v_mul_f32 v255, v255, v251
    s_nop 0
    v_accvgpr_write_b32 a91, v255
    v_accvgpr_read_b32 v252, a92
    s_nop 0
    v_mul_f32 v252, v252, v251
    s_nop 0
    v_accvgpr_write_b32 a92, v252
    v_accvgpr_read_b32 v253, a93
    s_nop 0
    v_mul_f32 v253, v253, v251
    s_nop 0
    v_accvgpr_write_b32 a93, v253
    v_accvgpr_read_b32 v254, a94
    s_nop 0
    v_mul_f32 v254, v254, v251
    s_nop 0
    v_accvgpr_write_b32 a94, v254
    v_accvgpr_read_b32 v255, a95
    s_nop 0
    v_mul_f32 v255, v255, v251
    s_nop 0
    v_accvgpr_write_b32 a95, v255
    v_accvgpr_read_b32 v252, a96
    s_nop 0
    v_mul_f32 v252, v252, v250
    s_nop 0
    v_accvgpr_write_b32 a96, v252
    v_accvgpr_read_b32 v253, a97
    s_nop 0
    v_mul_f32 v253, v253, v250
    s_nop 0
    v_accvgpr_write_b32 a97, v253
    v_accvgpr_read_b32 v254, a98
    s_nop 0
    v_mul_f32 v254, v254, v250
    s_nop 0
    v_accvgpr_write_b32 a98, v254
    v_accvgpr_read_b32 v255, a99
    s_nop 0
    v_mul_f32 v255, v255, v250
    s_nop 0
    v_accvgpr_write_b32 a99, v255
    v_accvgpr_read_b32 v252, a100
    s_nop 0
    v_mul_f32 v252, v252, v250
    s_nop 0
    v_accvgpr_write_b32 a100, v252
    v_accvgpr_read_b32 v253, a101
    s_nop 0
    v_mul_f32 v253, v253, v250
    s_nop 0
    v_accvgpr_write_b32 a101, v253
    v_accvgpr_read_b32 v254, a102
    s_nop 0
    v_mul_f32 v254, v254, v250
    s_nop 0
    v_accvgpr_write_b32 a102, v254
    v_accvgpr_read_b32 v255, a103
    s_nop 0
    v_mul_f32 v255, v255, v250
    s_nop 0
    v_accvgpr_write_b32 a103, v255
    v_accvgpr_read_b32 v252, a104
    s_nop 0
    v_mul_f32 v252, v252, v250
    s_nop 0
    v_accvgpr_write_b32 a104, v252
    v_accvgpr_read_b32 v253, a105
    s_nop 0
    v_mul_f32 v253, v253, v250
    s_nop 0
    v_accvgpr_write_b32 a105, v253
    v_accvgpr_read_b32 v254, a106
    s_nop 0
    v_mul_f32 v254, v254, v250
    s_nop 0
    v_accvgpr_write_b32 a106, v254
    v_accvgpr_read_b32 v255, a107
    s_nop 0
    v_mul_f32 v255, v255, v250
    s_nop 0
    v_accvgpr_write_b32 a107, v255
    v_accvgpr_read_b32 v252, a108
    s_nop 0
    v_mul_f32 v252, v252, v250
    s_nop 0
    v_accvgpr_write_b32 a108, v252
    v_accvgpr_read_b32 v253, a109
    s_nop 0
    v_mul_f32 v253, v253, v250
    s_nop 0
    v_accvgpr_write_b32 a109, v253
    v_accvgpr_read_b32 v254, a110
    s_nop 0
    v_mul_f32 v254, v254, v250
    s_nop 0
    v_accvgpr_write_b32 a110, v254
    v_accvgpr_read_b32 v255, a111
    s_nop 0
    v_mul_f32 v255, v255, v250
    s_nop 0
    v_accvgpr_write_b32 a111, v255
    v_accvgpr_read_b32 v252, a112
    s_nop 0
    v_mul_f32 v252, v252, v251
    s_nop 0
    v_accvgpr_write_b32 a112, v252
    v_accvgpr_read_b32 v253, a113
    s_nop 0
    v_mul_f32 v253, v253, v251
    s_nop 0
    v_accvgpr_write_b32 a113, v253
    v_accvgpr_read_b32 v254, a114
    s_nop 0
    v_mul_f32 v254, v254, v251
    s_nop 0
    v_accvgpr_write_b32 a114, v254
    v_accvgpr_read_b32 v255, a115
    s_nop 0
    v_mul_f32 v255, v255, v251
    s_nop 0
    v_accvgpr_write_b32 a115, v255
    v_accvgpr_read_b32 v252, a116
    s_nop 0
    v_mul_f32 v252, v252, v251
    s_nop 0
    v_accvgpr_write_b32 a116, v252
    v_accvgpr_read_b32 v253, a117
    s_nop 0
    v_mul_f32 v253, v253, v251
    s_nop 0
    v_accvgpr_write_b32 a117, v253
    v_accvgpr_read_b32 v254, a118
    s_nop 0
    v_mul_f32 v254, v254, v251
    s_nop 0
    v_accvgpr_write_b32 a118, v254
    v_accvgpr_read_b32 v255, a119
    s_nop 0
    v_mul_f32 v255, v255, v251
    s_nop 0
    v_accvgpr_write_b32 a119, v255
    v_accvgpr_read_b32 v252, a120
    s_nop 0
    v_mul_f32 v252, v252, v251
    s_nop 0
    v_accvgpr_write_b32 a120, v252
    v_accvgpr_read_b32 v253, a121
    s_nop 0
    v_mul_f32 v253, v253, v251
    s_nop 0
    v_accvgpr_write_b32 a121, v253
    v_accvgpr_read_b32 v254, a122
    s_nop 0
    v_mul_f32 v254, v254, v251
    s_nop 0
    v_accvgpr_write_b32 a122, v254
    v_accvgpr_read_b32 v255, a123
    s_nop 0
    v_mul_f32 v255, v255, v251
    s_nop 0
    v_accvgpr_write_b32 a123, v255
    v_accvgpr_read_b32 v252, a124
    s_nop 0
    v_mul_f32 v252, v252, v251
    s_nop 0
    v_accvgpr_write_b32 a124, v252
    v_accvgpr_read_b32 v253, a125
    s_nop 0
    v_mul_f32 v253, v253, v251
    s_nop 0
    v_accvgpr_write_b32 a125, v253
    v_accvgpr_read_b32 v254, a126
    s_nop 0
    v_mul_f32 v254, v254, v251
    s_nop 0
    v_accvgpr_write_b32 a126, v254
    v_accvgpr_read_b32 v255, a127
    s_nop 0
    v_mul_f32 v255, v255, v251
    s_nop 0
    v_accvgpr_write_b32 a127, v255
    v_sub_f32 v192, v192, v246
    v_sub_f32 v193, v193, v246
    v_sub_f32 v194, v194, v246
    v_sub_f32 v195, v195, v246
    v_sub_f32 v196, v196, v246
    v_sub_f32 v197, v197, v246
    v_sub_f32 v198, v198, v246
    v_sub_f32 v199, v199, v246
    v_sub_f32 v200, v200, v246
    v_sub_f32 v201, v201, v246
    v_sub_f32 v202, v202, v246
    v_sub_f32 v203, v203, v246
    v_sub_f32 v204, v204, v246
    v_sub_f32 v205, v205, v246
    v_sub_f32 v206, v206, v246
    v_sub_f32 v207, v207, v246
    v_sub_f32 v208, v208, v247
    v_sub_f32 v209, v209, v247
    v_sub_f32 v210, v210, v247
    v_sub_f32 v211, v211, v247
    v_sub_f32 v212, v212, v247
    v_sub_f32 v213, v213, v247
    v_sub_f32 v214, v214, v247
    v_sub_f32 v215, v215, v247
    v_sub_f32 v216, v216, v247
    v_sub_f32 v217, v217, v247
    v_sub_f32 v218, v218, v247
    v_sub_f32 v219, v219, v247
    v_sub_f32 v220, v220, v247
    v_sub_f32 v221, v221, v247
    v_sub_f32 v222, v222, v247
    v_sub_f32 v223, v223, v247
    v_sub_f32 v64, v64, v246
    v_sub_f32 v65, v65, v246
    v_sub_f32 v66, v66, v246
    v_sub_f32 v67, v67, v246
    v_sub_f32 v68, v68, v246
    v_sub_f32 v69, v69, v246
    v_sub_f32 v70, v70, v246
    v_sub_f32 v71, v71, v246
    v_sub_f32 v72, v72, v246
    v_sub_f32 v73, v73, v246
    v_sub_f32 v74, v74, v246
    v_sub_f32 v75, v75, v246
    v_sub_f32 v76, v76, v246
    v_sub_f32 v77, v77, v246
    v_sub_f32 v78, v78, v246
    v_sub_f32 v79, v79, v246
    v_sub_f32 v80, v80, v247
    v_sub_f32 v81, v81, v247
    v_sub_f32 v82, v82, v247
    v_sub_f32 v83, v83, v247
    v_sub_f32 v84, v84, v247
    v_sub_f32 v85, v85, v247
    v_sub_f32 v86, v86, v247
    v_sub_f32 v87, v87, v247
    v_sub_f32 v88, v88, v247
    v_sub_f32 v89, v89, v247
    v_sub_f32 v90, v90, v247
    v_sub_f32 v91, v91, v247
    v_sub_f32 v92, v92, v247
    v_sub_f32 v93, v93, v247
    v_sub_f32 v94, v94, v247
    v_sub_f32 v95, v95, v247
    v_sub_f32 v96, v96, v246
    v_sub_f32 v97, v97, v246
    v_sub_f32 v98, v98, v246
    v_sub_f32 v99, v99, v246
    v_sub_f32 v100, v100, v246
    v_sub_f32 v101, v101, v246
    v_sub_f32 v102, v102, v246
    v_sub_f32 v103, v103, v246
    v_sub_f32 v104, v104, v246
    v_sub_f32 v105, v105, v246
    v_sub_f32 v106, v106, v246
    v_sub_f32 v107, v107, v246
    v_sub_f32 v108, v108, v246
    v_sub_f32 v109, v109, v246
    v_sub_f32 v110, v110, v246
    v_sub_f32 v111, v111, v246
    v_sub_f32 v112, v112, v247
    v_sub_f32 v113, v113, v247
    v_sub_f32 v114, v114, v247
    v_sub_f32 v115, v115, v247
    v_sub_f32 v116, v116, v247
    v_sub_f32 v117, v117, v247
    v_sub_f32 v118, v118, v247
    v_sub_f32 v119, v119, v247
    v_sub_f32 v120, v120, v247
    v_sub_f32 v121, v121, v247
    v_sub_f32 v122, v122, v247
    v_sub_f32 v123, v123, v247
    v_sub_f32 v124, v124, v247
    v_sub_f32 v125, v125, v247
    v_sub_f32 v126, v126, v247
    v_sub_f32 v127, v127, v247
    v_exp_f32 v64, v64
    v_exp_f32 v65, v65
    v_exp_f32 v66, v66
    v_exp_f32 v67, v67
    v_exp_f32 v68, v68
    v_exp_f32 v69, v69
    v_exp_f32 v70, v70
    v_exp_f32 v71, v71
    v_exp_f32 v72, v72
    v_exp_f32 v73, v73
    v_exp_f32 v74, v74
    v_exp_f32 v75, v75
    v_exp_f32 v76, v76
    v_exp_f32 v77, v77
    v_exp_f32 v78, v78
    v_exp_f32 v79, v79
    v_exp_f32 v80, v80
    v_exp_f32 v81, v81
    v_exp_f32 v82, v82
    v_exp_f32 v83, v83
    v_exp_f32 v84, v84
    v_exp_f32 v85, v85
    v_exp_f32 v86, v86
    v_exp_f32 v87, v87
    v_exp_f32 v88, v88
    v_exp_f32 v89, v89
    v_exp_f32 v90, v90
    v_exp_f32 v91, v91
    v_exp_f32 v92, v92
    v_exp_f32 v93, v93
    v_exp_f32 v94, v94
    v_exp_f32 v95, v95
    v_exp_f32 v96, v96
    v_exp_f32 v97, v97
    v_exp_f32 v98, v98
    v_exp_f32 v99, v99
    v_exp_f32 v100, v100
    v_exp_f32 v101, v101
    v_exp_f32 v102, v102
    v_exp_f32 v103, v103
    v_exp_f32 v104, v104
    v_exp_f32 v105, v105
    v_exp_f32 v106, v106
    v_exp_f32 v107, v107
    v_exp_f32 v108, v108
    v_exp_f32 v109, v109
    v_exp_f32 v110, v110
    v_exp_f32 v111, v111
    v_exp_f32 v112, v112
    v_exp_f32 v113, v113
    v_exp_f32 v114, v114
    v_exp_f32 v115, v115
    v_exp_f32 v116, v116
    v_exp_f32 v117, v117
    v_exp_f32 v118, v118
    v_exp_f32 v119, v119
    v_exp_f32 v120, v120
    v_exp_f32 v121, v121
    v_exp_f32 v122, v122
    v_exp_f32 v123, v123
    v_exp_f32 v124, v124
    v_exp_f32 v125, v125
    v_exp_f32 v126, v126
    v_exp_f32 v127, v127
    s_nop 0
    v_add_f32 v243, v64, v65
    v_add_f32 v243, v243, v66
    v_add_f32 v243, v243, v67
    v_add_f32 v243, v243, v68
    v_add_f32 v243, v243, v69
    v_add_f32 v243, v243, v70
    v_add_f32 v243, v243, v71
    v_add_f32 v243, v243, v72
    v_add_f32 v243, v243, v73
    v_add_f32 v243, v243, v74
    v_add_f32 v243, v243, v75
    v_add_f32 v243, v243, v76
    v_add_f32 v243, v243, v77
    v_add_f32 v243, v243, v78
    v_add_f32 v243, v243, v79
    v_add_f32 v243, v243, v96
    v_add_f32 v243, v243, v97
    v_add_f32 v243, v243, v98
    v_add_f32 v243, v243, v99
    v_add_f32 v243, v243, v100
    v_add_f32 v243, v243, v101
    v_add_f32 v243, v243, v102
    v_add_f32 v243, v243, v103
    v_add_f32 v243, v243, v104
    v_add_f32 v243, v243, v105
    v_add_f32 v243, v243, v106
    v_add_f32 v243, v243, v107
    v_add_f32 v243, v243, v108
    v_add_f32 v243, v243, v109
    v_add_f32 v243, v243, v110
    v_add_f32 v243, v243, v111
    v_add_f32 v244, v80, v81
    v_add_f32 v244, v244, v82
    v_add_f32 v244, v244, v83
    v_add_f32 v244, v244, v84
    v_add_f32 v244, v244, v85
    v_add_f32 v244, v244, v86
    v_add_f32 v244, v244, v87
    v_add_f32 v244, v244, v88
    v_add_f32 v244, v244, v89
    v_add_f32 v244, v244, v90
    v_add_f32 v244, v244, v91
    v_add_f32 v244, v244, v92
    v_add_f32 v244, v244, v93
    v_add_f32 v244, v244, v94
    v_add_f32 v244, v244, v95
    v_add_f32 v244, v244, v112
    v_add_f32 v244, v244, v113
    v_add_f32 v244, v244, v114
    v_add_f32 v244, v244, v115
    v_add_f32 v244, v244, v116
    v_add_f32 v244, v244, v117
    v_add_f32 v244, v244, v118
    v_add_f32 v244, v244, v119
    v_add_f32 v244, v244, v120
    v_add_f32 v244, v244, v121
    v_add_f32 v244, v244, v122
    v_add_f32 v244, v244, v123
    v_add_f32 v244, v244, v124
    v_add_f32 v244, v244, v125
    v_add_f32 v244, v244, v126
    v_add_f32 v244, v244, v127
    v_cvt_pk_bf16_f32 v160, v64, v65
    v_cvt_pk_bf16_f32 v161, v66, v67
    v_cvt_pk_bf16_f32 v162, v68, v69
    v_cvt_pk_bf16_f32 v163, v70, v71
    v_cvt_pk_bf16_f32 v168, v72, v73
    v_cvt_pk_bf16_f32 v169, v74, v75
    v_cvt_pk_bf16_f32 v170, v76, v77
    v_cvt_pk_bf16_f32 v171, v78, v79
    v_cvt_pk_bf16_f32 v164, v80, v81
    v_cvt_pk_bf16_f32 v165, v82, v83
    v_cvt_pk_bf16_f32 v166, v84, v85
    v_cvt_pk_bf16_f32 v167, v86, v87
    v_cvt_pk_bf16_f32 v172, v88, v89
    v_cvt_pk_bf16_f32 v173, v90, v91
    v_cvt_pk_bf16_f32 v174, v92, v93
    v_cvt_pk_bf16_f32 v175, v94, v95
    v_cvt_pk_bf16_f32 v176, v96, v97
    v_cvt_pk_bf16_f32 v177, v98, v99
    v_cvt_pk_bf16_f32 v178, v100, v101
    v_cvt_pk_bf16_f32 v179, v102, v103
    v_cvt_pk_bf16_f32 v184, v104, v105
    v_cvt_pk_bf16_f32 v185, v106, v107
    v_cvt_pk_bf16_f32 v186, v108, v109
    v_cvt_pk_bf16_f32 v187, v110, v111
    v_cvt_pk_bf16_f32 v180, v112, v113
    v_cvt_pk_bf16_f32 v181, v114, v115
    v_cvt_pk_bf16_f32 v182, v116, v117
    v_cvt_pk_bf16_f32 v183, v118, v119
    v_cvt_pk_bf16_f32 v188, v120, v121
    v_cvt_pk_bf16_f32 v189, v122, v123
    v_cvt_pk_bf16_f32 v190, v124, v125
    v_cvt_pk_bf16_f32 v191, v126, v127
    s_nop 7
    s_branch L_retT

.section .rodata,"a"
.p2align 6
.amdhsa_kernel standalone__gqa_softmax__prompt_kernel
  .amdhsa_next_free_vgpr 512
  .amdhsa_next_free_sgpr 96
  .amdhsa_accum_offset 256
  .amdhsa_group_segment_fixed_size 0
  .amdhsa_kernarg_size 48
  .amdhsa_user_sgpr_count 2
  .amdhsa_user_sgpr_kernarg_segment_ptr 1
  .amdhsa_system_sgpr_workgroup_id_x 1
.end_amdhsa_kernel
```
